```python
import torch

def _softmax(x, axis=-1):
    return torch.softmax(x, dim=axis)
def _gelu(x):
    return torch.nn.functional.gelu(x, approximate="tanh")
def _silu(x):
    return torch.nn.functional.silu(x)
def _sigmoid(x):
    return torch.sigmoid(x)
def _layernorm(x, axis=-1, eps=1e-5):
    m = x.mean(dim=axis, keepdim=True)
    v = x.var(dim=axis, keepdim=True, unbiased=False)
    return (x - m) / torch.sqrt(v + eps)
def _scatter_add(tgt, idx, src, axis=0):
    return tgt.clone().index_add_(axis, idx, src)
def _segment_sum(src, seg, n):
    out = torch.zeros((n,) + src.shape[1:], dtype=src.dtype)
    return out.index_add_(0, seg, src)
def _pad(x, pw):
    flat = tuple(v for pair in reversed(pw) for v in pair)
    return torch.nn.functional.pad(x, flat)

kernel_name = 'concat_heads__linear_kernel_hedgehog__softmax_full_mha__prompt'

def setup_inputs():

    _w = (lambda a: (lambda t: t.to(torch.bfloat16) if t.is_floating_point() else t)(torch.as_tensor(a)))
    def _A_setup():
        B, S, D, H = 1, 2048, 512, 32
        Dh = D // H
        return {
            "x": _w((lambda *s: torch.randn(*s, dtype=torch.bfloat16) * 0.8)(B, S, D)),
            "wqkv": _w((lambda *s: torch.randn(*s, dtype=torch.bfloat16) * 1.6)(D, 3 * D)),
            "w_phi": _w((lambda *s: torch.randn(*s, dtype=torch.bfloat16) * 1.6)(H, Dh, Dh) * (Dh ** -0.5)),
            "wo": _w((lambda *s: torch.randn(*s, dtype=torch.bfloat16) * 0.1)(D, D)),
        }
    _A_in = _A_setup()

    def _B_setup():
        B, S, D = 1, 2048, 512
        return {
            "x": _w((lambda *s: torch.randn(*s, dtype=torch.bfloat16) * 0.4)(B, S, D)),
            "wqkv": _w((lambda *s: torch.randn(*s, dtype=torch.bfloat16) * 0.4)(D, 3 * D)),
            "wo": _w((lambda *s: torch.randn(*s, dtype=torch.bfloat16) * 0.05)(D, D)),
        }
    _B_in = _B_setup()

    return {
        "A_x": _A_in["x"],
        "A_wqkv": _A_in["wqkv"],
        "A_w_phi": _A_in["w_phi"],
        "A_wo": _A_in["wo"],
        "B_x": _B_in["x"],
        "B_wqkv": _B_in["wqkv"],
        "B_wo": _B_in["wo"],
    }

def reference(A_x, A_wqkv, A_w_phi, A_wo, B_x, B_wqkv, B_wo):
    def _A_ref(x, wqkv, w_phi, wo):
        B, S, D = x.shape
        H = 32; Dh = D // H
        qkv = (lambda x, *d: x.permute(*d))((x @ wqkv).reshape(B, S, 3, H, Dh), 2, 0, 3, 1, 4)
        q, k, v = qkv[0], qkv[1], qkv[2]
        pq = torch.einsum("bhsd,hdf->bhsf", q, w_phi)
        pk = torch.einsum("bhsd,hdf->bhsf", k, w_phi)
        phi_q = torch.concatenate([_softmax(pq, axis=-1), _softmax(-pq, axis=-1)], axis=-1)
        phi_k = torch.concatenate([_softmax(pk, axis=-1), _softmax(-pk, axis=-1)], axis=-1)
        kv = torch.einsum("bhsf,bhsd->bhfd", phi_k, v)
        z  = torch.einsum("bhsf->bhf", phi_k)
        num = torch.einsum("bhqf,bhfd->bhqd", phi_q, kv)
        den = torch.einsum("bhqf,bhf->bhq", phi_q, z)[..., None] + 1e-6
        o = num / den
        return (lambda x, *d: x.permute(*d))(o, 0, 2, 1, 3).reshape(B, S, D) @ wo

    def _B_ref(x, wqkv, wo):
        B, S, D = x.shape
        H = 32; Dh = D // H
        qkv = (lambda x, *d: x.permute(*d))((x @ wqkv).reshape(B, S, 3, H, Dh), 2, 0, 3, 1, 4)
        q, k, v = qkv[0], qkv[1], qkv[2]
        scale = Dh ** -0.5
        scores = torch.einsum("bhqd,bhkd->bhqk", q, k) * scale
        p = _softmax(scores, axis=-1)
        o = torch.einsum("bhqk,bhkd->bhqd", p, v)
        return (lambda x, *d: x.permute(*d))(o, 0, 2, 1, 3).reshape(B, S, D) @ wo

    a = _A_ref(A_x, A_wqkv, A_w_phi, A_wo)
    b = _B_ref(B_x, B_wqkv, B_wo)
    return torch.concatenate([a, b], axis=-1)
```

```asm
; @launch grid=(256,1,1) block=(512,1,1) lds=163840
.amdgcn_target "amdgcn-amd-amdhsa--gfx950"
.text
.globl concat_heads__linear_kernel_hedgehog__softmax_full_mha__prompt_kernel
.p2align 8
.type concat_heads__linear_kernel_hedgehog__softmax_full_mha__prompt_kernel,@function
concat_heads__linear_kernel_hedgehog__softmax_full_mha__prompt_kernel:
    s_cmp_ge_u32 s2, 256
    s_cbranch_scc1 L_end
    s_load_dwordx2 s[8:9], s[0:1], 32
    s_load_dwordx2 s[12:13], s[0:1], 40
    s_load_dwordx16 s[40:55], s[0:1], 0
    s_load_dwordx4 s[56:59], s[0:1], 64
    v_lshrrev_b32 v2, 6, v0
    v_and_b32 v1, 63, v0
    v_readfirstlane_b32 s3, v2
    s_and_b32 s74, s2, 1
    s_lshl_b32 s74, s74, 2
    s_bfe_u32 s75, s2, 0x20003
    s_add_u32 s6, s74, s75
    s_bfe_u32 s74, s2, 0x20001
    s_lshl_b32 s74, s74, 3
    s_lshr_b32 s75, s2, 5
    s_add_u32 s5, s74, s75
    s_and_b32 s4, s3, 3
    s_cmp_lt_u32 s3, 4
    s_cbranch_scc1 L_roleB
    s_lshl_b32 s60, s4, 11
    v_lshrrev_b32 v14, 3, v1
    v_and_b32 v15, 7, v1
    s_lshl_b32 s74, s5, 6
    s_lshl_b32 s75, s4, 4
    s_add_u32 s74, s74, s75
    v_add_u32 v2, s74, v14
    v_lshlrev_b32 v2, 10, v2
    v_lshrrev_b32 v3, 1, v14
    v_xor_b32 v3, v3, v15
    v_lshl_add_u32 v3, v3, 4, v2
    v_add_u32 v4, 0x2000, v3
    v_xor_b32 v4, 64, v4
    v_add_u32 v2, s75, v14
    v_mul_u32_u24 v2, 0xc00, v2
    s_lshl_b32 s76, s6, 7
    v_add_u32 v2, s76, v2
    v_bfe_u32 v14, v1, 4, 1
    v_lshlrev_b32 v5, 1, v14
    v_xor_b32 v5, v5, v15
    v_xor_b32 v6, 4, v5
    v_lshl_add_u32 v5, v5, 4, v2
    v_lshl_add_u32 v6, v6, 4, v2
    s_mul_i32 s82, s6, 4
    s_mul_i32 s74, s5, 4
    s_add_u32 s82, s82, s74
    s_lshr_b32 s74, s6, 2
    s_mul_i32 s74, s74, 2
    s_add_u32 s82, s82, s74
    s_mov_b32 s10, 2097152
    s_mov_b32 s11, 0x00020000
    s_mov_b32 s14, 1572864
    s_mov_b32 s15, 0x00020000
    s_waitcnt lgkmcnt(0)
    s_add_u32 s61, s82, 0
    s_and_b32 s61, s61, 7
    s_mul_i32 s62, s61, 196608
    s_lshl_b32 s61, s61, 7
    s_add_u32 s63, s62, 24576
    s_add_u32 m0, s60, 0
    s_nop 0
    buffer_load_dwordx4 v3, s[8:11], s61 offen lds
    s_add_u32 m0, s60, 8192
    s_nop 0
    buffer_load_dwordx4 v5, s[12:15], s62 offen offset:0 lds
    s_add_u32 m0, s60, 15360
    s_nop 0
    buffer_load_dwordx4 v5, s[12:15], s62 offen offset:1024 lds
    s_add_u32 m0, s60, 22528
    s_nop 0
    buffer_load_dwordx4 v5, s[12:15], s62 offen offset:2048 lds
    s_add_u32 m0, s60, 1024
    s_nop 0
    buffer_load_dwordx4 v4, s[8:11], s61 offen lds
    s_add_u32 m0, s60, 9216
    s_nop 0
    buffer_load_dwordx4 v6, s[12:15], s63 offen offset:0 lds
    s_add_u32 m0, s60, 16384
    s_nop 0
    buffer_load_dwordx4 v6, s[12:15], s63 offen offset:1024 lds
    s_add_u32 m0, s60, 23552
    s_nop 0
    buffer_load_dwordx4 v6, s[12:15], s63 offen offset:2048 lds
    s_lshl_b32 s7, s6, 2
    s_add_u32 s7, s7, s4
    v_lshlrev_b32 v0, 4, v1
    v_mov_b32 v254, 163584
    v_mov_b32 v253, 1
    s_mul_i32 s70, s6, 2
    s_mul_i32 s74, s5, 1
    s_add_u32 s70, s70, s74
    s_lshr_b32 s74, s6, 2
    s_mul_i32 s74, s74, 1
    s_add_u32 s70, s70, s74
    s_setprio 2
    s_mov_b32 s16, s40
    s_mov_b32 s17, s41
    s_mov_b32 s18, 2097152
    s_mov_b32 s19, 0x00020000
    s_mov_b32 s20, s42
    s_mov_b32 s21, s43
    s_mov_b32 s22, 1572864
    s_mov_b32 s23, 0x00020000
    s_mov_b32 s24, s58
    s_mov_b32 s25, s59
    s_mov_b32 s26, 16777216
    s_mov_b32 s27, 0x00020000
    s_mov_b32 s28, s54
    s_mov_b32 s29, s55
    s_mov_b32 s30, 4194304
    s_mov_b32 s31, 0x00020000
    s_mov_b32 s32, s44
    s_mov_b32 s33, s45
    s_mov_b32 s34, 16384
    s_mov_b32 s35, 0x00020000
    v_lshrrev_b32 v2, 5, v1
    v_and_b32 v14, 15, v1
    v_lshlrev_b32 v14, 1, v14
    v_lshl_add_u32 v2, v2, 8, v14
    s_lshl_b32 s74, s7, 9
    buffer_load_ushort v48, v2, s[32:35], s74 offen offset:0
    buffer_load_ushort v49, v2, s[32:35], s74 offen offset:32
    buffer_load_ushort v50, v2, s[32:35], s74 offen offset:64
    buffer_load_ushort v51, v2, s[32:35], s74 offen offset:96
    buffer_load_ushort v52, v2, s[32:35], s74 offen offset:128
    buffer_load_ushort v53, v2, s[32:35], s74 offen offset:160
    buffer_load_ushort v54, v2, s[32:35], s74 offen offset:192
    buffer_load_ushort v55, v2, s[32:35], s74 offen offset:224
    v_and_b32 v2, 15, v1
    v_lshrrev_b32 v14, 4, v1
    v_lshrrev_b32 v15, 1, v2
    v_xor_b32 v15, v15, v14
    v_lshlrev_b32 v15, 4, v15
    v_lshl_add_u32 v8, v2, 7, v15
    v_xor_b32 v9, 64, v8
    v_bfe_u32 v2, v1, 2, 2
    v_lshl_add_u32 v2, v14, 3, v2
    v_lshlrev_b32 v2, 7, v2
    v_and_b32 v15, 3, v1
    v_lshl_add_u32 v2, v15, 3, v2
    v_bfe_u32 v14, v1, 3, 2
    v_xor_b32 v14, s4, v14
    v_lshl_add_u32 v12, v14, 5, v2
    v_add_u32 v12, 0x2000, v12
    v_bfe_u32 v2, v1, 2, 1
    v_lshrrev_b32 v14, 5, v1
    v_xor_b32 v2, v2, v14
    v_lshlrev_b32 v2, 3, v2
    v_bfe_u32 v14, v1, 3, 2
    v_lshl_add_u32 v2, v14, 1, v2
    v_bfe_u32 v14, v1, 1, 1
    v_add_u32 v2, v2, v14
    v_and_b32 v14, 1, v1
    v_lshlrev_b32 v14, 4, v14
    v_mov_b32 v15, 0x3f80
    v_lshlrev_b32 v14, v14, v15
    v_cmp_eq_u32 vcc, 0, v2
    s_nop 1
    v_cndmask_b32 v40, 0, v14, vcc
    v_cmp_eq_u32 vcc, 1, v2
    s_nop 1
    v_cndmask_b32 v41, 0, v14, vcc
    v_cmp_eq_u32 vcc, 2, v2
    s_nop 1
    v_cndmask_b32 v42, 0, v14, vcc
    v_cmp_eq_u32 vcc, 3, v2
    s_nop 1
    v_cndmask_b32 v43, 0, v14, vcc
    v_cmp_eq_u32 vcc, 4, v2
    s_nop 1
    v_cndmask_b32 v44, 0, v14, vcc
    v_cmp_eq_u32 vcc, 5, v2
    s_nop 1
    v_cndmask_b32 v45, 0, v14, vcc
    v_cmp_eq_u32 vcc, 6, v2
    s_nop 1
    v_cndmask_b32 v46, 0, v14, vcc
    v_cmp_eq_u32 vcc, 7, v2
    s_nop 1
    v_cndmask_b32 v47, 0, v14, vcc
    s_lshr_b32 s74, s2, 3
    s_lshl_b32 s74, s74, 2
    s_add_u32 s74, s74, s4
    s_mul_i32 s74, s74, 12288
    s_and_b32 s75, s2, 1
    s_lshl_b32 s75, s75, 9
    s_add_u32 s74, s74, s75
    s_add_u32 s74, s74, 384
    s_add_u32 s86, s42, s74
    s_addc_u32 s87, s43, 0
    s_lshr_b32 s74, s2, 3
    s_lshl_b32 s74, s74, 2
    s_add_u32 s74, s74, s4
    s_lshl_b32 s74, s74, 12
    s_bfe_u32 s75, s2, 0x20001
    s_lshl_b32 s75, s75, 19
    s_add_u32 s74, s74, s75
    s_add_u32 s74, s74, 384
    s_add_u32 s84, s40, s74
    s_addc_u32 s85, s41, 0
    s_add_u32 s61, s82, 1
    s_and_b32 s61, s61, 7
    s_mul_i32 s62, s61, 196608
    s_lshl_b32 s61, s61, 7
    s_add_u32 s63, s62, 24576
    s_add_u32 m0, s60, 32768
    s_nop 0
    buffer_load_dwordx4 v3, s[8:11], s61 offen lds
    s_add_u32 m0, s60, 40960
    s_nop 0
    buffer_load_dwordx4 v5, s[12:15], s62 offen offset:0 lds
    s_add_u32 m0, s60, 48128
    s_nop 0
    buffer_load_dwordx4 v5, s[12:15], s62 offen offset:1024 lds
    s_add_u32 m0, s60, 55296
    s_nop 0
    buffer_load_dwordx4 v5, s[12:15], s62 offen offset:2048 lds
    s_add_u32 m0, s60, 33792
    s_nop 0
    buffer_load_dwordx4 v4, s[8:11], s61 offen lds
    s_add_u32 m0, s60, 41984
    s_nop 0
    buffer_load_dwordx4 v6, s[12:15], s63 offen offset:0 lds
    s_add_u32 m0, s60, 49152
    s_nop 0
    buffer_load_dwordx4 v6, s[12:15], s63 offen offset:1024 lds
    s_add_u32 m0, s60, 56320
    s_nop 0
    buffer_load_dwordx4 v6, s[12:15], s63 offen offset:2048 lds
    s_waitcnt vmcnt(16)
    s_barrier
    s_add_u32 s61, s82, 2
    s_and_b32 s61, s61, 7
    s_mul_i32 s62, s61, 196608
    s_lshl_b32 s61, s61, 7
    s_add_u32 s63, s62, 24576
    s_add_u32 m0, s60, 65536
    s_nop 0
    buffer_load_dwordx4 v3, s[8:11], s61 offen lds
    s_add_u32 m0, s60, 73728
    s_nop 0
    buffer_load_dwordx4 v5, s[12:15], s62 offen offset:0 lds
    s_add_u32 m0, s60, 80896
    s_nop 0
    buffer_load_dwordx4 v5, s[12:15], s62 offen offset:1024 lds
    s_add_u32 m0, s60, 88064
    s_nop 0
    buffer_load_dwordx4 v5, s[12:15], s62 offen offset:2048 lds
    s_add_u32 m0, s60, 66560
    s_nop 0
    buffer_load_dwordx4 v4, s[8:11], s61 offen lds
    s_add_u32 m0, s60, 74752
    s_nop 0
    buffer_load_dwordx4 v6, s[12:15], s63 offen offset:0 lds
    s_add_u32 m0, s60, 81920
    s_nop 0
    buffer_load_dwordx4 v6, s[12:15], s63 offen offset:1024 lds
    s_add_u32 m0, s60, 89088
    s_nop 0
    buffer_load_dwordx4 v6, s[12:15], s63 offen offset:2048 lds
    s_load_dword s88, s[86:87], 0
    s_load_dword s89, s[86:87], 64
    s_load_dword s88, s[86:87], 1024
    s_load_dword s89, s[86:87], 1088
    s_load_dword s88, s[86:87], 2048
    s_load_dword s89, s[86:87], 2112
    s_waitcnt vmcnt(8)
    s_barrier
    s_add_u32 s61, s82, 3
    s_and_b32 s61, s61, 7
    s_mul_i32 s62, s61, 196608
    s_lshl_b32 s61, s61, 7
    s_add_u32 s63, s62, 24576
    s_add_u32 m0, s60, 98304
    s_nop 0
    buffer_load_dwordx4 v3, s[8:11], s61 offen lds
    s_add_u32 m0, s60, 106496
    s_nop 0
    buffer_load_dwordx4 v5, s[12:15], s62 offen offset:0 lds
    s_add_u32 m0, s60, 113664
    s_nop 0
    buffer_load_dwordx4 v5, s[12:15], s62 offen offset:1024 lds
    s_add_u32 m0, s60, 120832
    s_nop 0
    buffer_load_dwordx4 v5, s[12:15], s62 offen offset:2048 lds
    s_add_u32 m0, s60, 99328
    s_nop 0
    buffer_load_dwordx4 v4, s[8:11], s61 offen lds
    s_add_u32 m0, s60, 107520
    s_nop 0
    buffer_load_dwordx4 v6, s[12:15], s63 offen offset:0 lds
    s_add_u32 m0, s60, 114688
    s_nop 0
    buffer_load_dwordx4 v6, s[12:15], s63 offen offset:1024 lds
    s_add_u32 m0, s60, 121856
    s_nop 0
    buffer_load_dwordx4 v6, s[12:15], s63 offen offset:2048 lds
    s_load_dword s88, s[86:87], 3072
    s_load_dword s89, s[86:87], 3136
    s_load_dword s88, s[86:87], 4096
    s_load_dword s89, s[86:87], 4160
    s_load_dword s88, s[86:87], 5120
    s_load_dword s89, s[86:87], 5184
    s_waitcnt vmcnt(8)
    s_barrier
    s_add_u32 s61, s82, 4
    s_and_b32 s61, s61, 7
    s_mul_i32 s62, s61, 196608
    s_lshl_b32 s61, s61, 7
    s_add_u32 s63, s62, 24576
    s_add_u32 m0, s60, 0
    s_nop 0
    buffer_load_dwordx4 v3, s[8:11], s61 offen lds
    s_add_u32 m0, s60, 8192
    s_nop 0
    buffer_load_dwordx4 v5, s[12:15], s62 offen offset:0 lds
    s_add_u32 m0, s60, 15360
    s_nop 0
    buffer_load_dwordx4 v5, s[12:15], s62 offen offset:1024 lds
    s_add_u32 m0, s60, 22528
    s_nop 0
    buffer_load_dwordx4 v5, s[12:15], s62 offen offset:2048 lds
    s_add_u32 m0, s60, 1024
    s_nop 0
    buffer_load_dwordx4 v4, s[8:11], s61 offen lds
    s_add_u32 m0, s60, 9216
    s_nop 0
    buffer_load_dwordx4 v6, s[12:15], s63 offen offset:0 lds
    s_add_u32 m0, s60, 16384
    s_nop 0
    buffer_load_dwordx4 v6, s[12:15], s63 offen offset:1024 lds
    s_add_u32 m0, s60, 23552
    s_nop 0
    buffer_load_dwordx4 v6, s[12:15], s63 offen offset:2048 lds
    s_load_dword s88, s[86:87], 6144
    s_load_dword s89, s[86:87], 6208
    s_load_dword s88, s[86:87], 7168
    s_load_dword s89, s[86:87], 7232
    s_load_dword s88, s[86:87], 8192
    s_load_dword s89, s[86:87], 8256
    s_waitcnt vmcnt(8)
    s_barrier
    s_add_u32 s61, s82, 5
    s_and_b32 s61, s61, 7
    s_mul_i32 s62, s61, 196608
    s_lshl_b32 s61, s61, 7
    s_add_u32 s63, s62, 24576
    s_add_u32 m0, s60, 32768
    s_nop 0
    buffer_load_dwordx4 v3, s[8:11], s61 offen lds
    s_add_u32 m0, s60, 40960
    s_nop 0
    buffer_load_dwordx4 v5, s[12:15], s62 offen offset:0 lds
    s_add_u32 m0, s60, 48128
    s_nop 0
    buffer_load_dwordx4 v5, s[12:15], s62 offen offset:1024 lds
    s_add_u32 m0, s60, 55296
    s_nop 0
    buffer_load_dwordx4 v5, s[12:15], s62 offen offset:2048 lds
    s_add_u32 m0, s60, 33792
    s_nop 0
    buffer_load_dwordx4 v4, s[8:11], s61 offen lds
    s_add_u32 m0, s60, 41984
    s_nop 0
    buffer_load_dwordx4 v6, s[12:15], s63 offen offset:0 lds
    s_add_u32 m0, s60, 49152
    s_nop 0
    buffer_load_dwordx4 v6, s[12:15], s63 offen offset:1024 lds
    s_add_u32 m0, s60, 56320
    s_nop 0
    buffer_load_dwordx4 v6, s[12:15], s63 offen offset:2048 lds
    s_load_dword s88, s[86:87], 9216
    s_load_dword s89, s[86:87], 9280
    s_load_dword s88, s[86:87], 10240
    s_load_dword s89, s[86:87], 10304
    s_load_dword s88, s[86:87], 11264
    s_load_dword s89, s[86:87], 11328
    s_waitcnt vmcnt(8)
    s_barrier
    s_add_u32 s61, s82, 6
    s_and_b32 s61, s61, 7
    s_mul_i32 s62, s61, 196608
    s_lshl_b32 s61, s61, 7
    s_add_u32 s63, s62, 24576
    s_add_u32 m0, s60, 65536
    s_nop 0
    buffer_load_dwordx4 v3, s[8:11], s61 offen lds
    s_add_u32 m0, s60, 73728
    s_nop 0
    buffer_load_dwordx4 v5, s[12:15], s62 offen offset:0 lds
    s_add_u32 m0, s60, 80896
    s_nop 0
    buffer_load_dwordx4 v5, s[12:15], s62 offen offset:1024 lds
    s_add_u32 m0, s60, 88064
    s_nop 0
    buffer_load_dwordx4 v5, s[12:15], s62 offen offset:2048 lds
    s_add_u32 m0, s60, 66560
    s_nop 0
    buffer_load_dwordx4 v4, s[8:11], s61 offen lds
    s_add_u32 m0, s60, 74752
    s_nop 0
    buffer_load_dwordx4 v6, s[12:15], s63 offen offset:0 lds
    s_add_u32 m0, s60, 81920
    s_nop 0
    buffer_load_dwordx4 v6, s[12:15], s63 offen offset:1024 lds
    s_add_u32 m0, s60, 89088
    s_nop 0
    buffer_load_dwordx4 v6, s[12:15], s63 offen offset:2048 lds
    s_load_dword s88, s[84:85], 0
    s_load_dword s89, s[84:85], 64
    s_load_dword s88, s[84:85], 1024
    s_load_dword s89, s[84:85], 1088
    s_load_dword s88, s[84:85], 2048
    s_load_dword s89, s[84:85], 2112
    s_waitcnt vmcnt(8)
    s_barrier
    s_add_u32 s61, s82, 7
    s_and_b32 s61, s61, 7
    s_mul_i32 s62, s61, 196608
    s_lshl_b32 s61, s61, 7
    s_add_u32 s63, s62, 24576
    s_add_u32 m0, s60, 98304
    s_nop 0
    buffer_load_dwordx4 v3, s[8:11], s61 offen lds
    s_add_u32 m0, s60, 106496
    s_nop 0
    buffer_load_dwordx4 v5, s[12:15], s62 offen offset:0 lds
    s_add_u32 m0, s60, 113664
    s_nop 0
    buffer_load_dwordx4 v5, s[12:15], s62 offen offset:1024 lds
    s_add_u32 m0, s60, 120832
    s_nop 0
    buffer_load_dwordx4 v5, s[12:15], s62 offen offset:2048 lds
    s_add_u32 m0, s60, 99328
    s_nop 0
    buffer_load_dwordx4 v4, s[8:11], s61 offen lds
    s_add_u32 m0, s60, 107520
    s_nop 0
    buffer_load_dwordx4 v6, s[12:15], s63 offen offset:0 lds
    s_add_u32 m0, s60, 114688
    s_nop 0
    buffer_load_dwordx4 v6, s[12:15], s63 offen offset:1024 lds
    s_add_u32 m0, s60, 121856
    s_nop 0
    buffer_load_dwordx4 v6, s[12:15], s63 offen offset:2048 lds
    s_load_dword s88, s[84:85], 3072
    s_load_dword s89, s[84:85], 3136
    s_waitcnt vmcnt(8)
    s_barrier
    s_add_u32 s61, s70, 0
    s_and_b32 s61, s61, 7
    s_mul_i32 s62, s61, 196608
    s_lshl_b32 s61, s61, 7
    s_add_u32 s63, s62, 24576
    s_add_u32 m0, s60, 0
    s_nop 0
    buffer_load_dwordx4 v3, s[16:19], s61 offen lds
    s_add_u32 m0, s60, 8192
    s_nop 0
    buffer_load_dwordx4 v5, s[20:23], s62 offen offset:0 lds
    s_add_u32 m0, s60, 15360
    s_nop 0
    buffer_load_dwordx4 v5, s[20:23], s62 offen offset:1024 lds
    s_add_u32 m0, s60, 22528
    s_nop 0
    buffer_load_dwordx4 v5, s[20:23], s62 offen offset:2048 lds
    s_add_u32 m0, s60, 1024
    s_nop 0
    buffer_load_dwordx4 v4, s[16:19], s61 offen lds
    s_add_u32 m0, s60, 9216
    s_nop 0
    buffer_load_dwordx4 v6, s[20:23], s63 offen offset:0 lds
    s_add_u32 m0, s60, 16384
    s_nop 0
    buffer_load_dwordx4 v6, s[20:23], s63 offen offset:1024 lds
    s_add_u32 m0, s60, 23552
    s_nop 0
    buffer_load_dwordx4 v6, s[20:23], s63 offen offset:2048 lds
    s_waitcnt vmcnt(8)
    s_barrier
    s_add_u32 s61, s70, 1
    s_and_b32 s61, s61, 7
    s_mul_i32 s62, s61, 196608
    s_lshl_b32 s61, s61, 7
    s_add_u32 s63, s62, 24576
    s_add_u32 m0, s60, 32768
    s_nop 0
    buffer_load_dwordx4 v3, s[16:19], s61 offen lds
    s_add_u32 m0, s60, 40960
    s_nop 0
    buffer_load_dwordx4 v5, s[20:23], s62 offen offset:0 lds
    s_add_u32 m0, s60, 48128
    s_nop 0
    buffer_load_dwordx4 v5, s[20:23], s62 offen offset:1024 lds
    s_add_u32 m0, s60, 55296
    s_nop 0
    buffer_load_dwordx4 v5, s[20:23], s62 offen offset:2048 lds
    s_add_u32 m0, s60, 33792
    s_nop 0
    buffer_load_dwordx4 v4, s[16:19], s61 offen lds
    s_add_u32 m0, s60, 41984
    s_nop 0
    buffer_load_dwordx4 v6, s[20:23], s63 offen offset:0 lds
    s_add_u32 m0, s60, 49152
    s_nop 0
    buffer_load_dwordx4 v6, s[20:23], s63 offen offset:1024 lds
    s_add_u32 m0, s60, 56320
    s_nop 0
    buffer_load_dwordx4 v6, s[20:23], s63 offen offset:2048 lds
    v_bfe_u32 v2, v1, 4, 1
    v_lshlrev_b32 v14, 15, v2
    v_lshl_or_b32 v2, v2, 31, v14
    v_lshl_or_b32 v248, v49, 16, v48
    v_xor_b32 v248, v248, v2
    v_lshl_or_b32 v249, v51, 16, v50
    v_xor_b32 v249, v249, v2
    v_lshl_or_b32 v250, v53, 16, v52
    v_xor_b32 v250, v250, v2
    v_lshl_or_b32 v251, v55, 16, v54
    v_xor_b32 v251, v251, v2
    s_waitcnt lgkmcnt(0)
    s_setprio 0
    s_waitcnt vmcnt(8)
    s_barrier
    ds_read_b64_tr_b16 v[124:125], v12 offset:8192
    ds_read_b64_tr_b16 v[126:127], v12 offset:8704
    ds_read_b128 v[104:107], v8 offset:0
    ds_read_b128 v[108:111], v8 offset:2048
    ds_read_b64_tr_b16 v[120:121], v12 offset:0
    ds_read_b64_tr_b16 v[122:123], v12 offset:512
    ds_read_b128 v[112:115], v8 offset:4096
    ds_read_b128 v[116:119], v8 offset:6144
    ds_read_b64_tr_b16 v[128:129], v12 offset:16384
    ds_read_b64_tr_b16 v[130:131], v12 offset:16896
    s_waitcnt lgkmcnt(6)
    v_mfma_f32_16x16x32_bf16 v[200:203], v[124:127], v[104:107], 0
    v_mfma_f32_16x16x32_bf16 v[204:207], v[124:127], v[108:111], 0
    ds_read_b64_tr_b16 v[152:153], v12 offset:12288
    ds_read_b64_tr_b16 v[154:155], v12 offset:12800
    ds_read_b128 v[132:135], v9 offset:0
    ds_read_b128 v[136:139], v9 offset:2048
    s_waitcnt lgkmcnt(6)
    v_mfma_f32_16x16x32_bf16 v[184:187], v[120:123], v[104:107], 0
    v_mfma_f32_16x16x32_bf16 v[188:191], v[120:123], v[108:111], 0
    v_mfma_f32_16x16x32_bf16 v[208:211], v[124:127], v[112:115], 0
    v_mfma_f32_16x16x32_bf16 v[212:215], v[124:127], v[116:119], 0
    ds_read_b64_tr_b16 v[148:149], v12 offset:4096
    ds_read_b64_tr_b16 v[150:151], v12 offset:4608
    ds_read_b128 v[140:143], v9 offset:4096
    ds_read_b128 v[144:147], v9 offset:6144
    v_mfma_f32_16x16x32_bf16 v[192:195], v[120:123], v[112:115], 0
    v_mfma_f32_16x16x32_bf16 v[196:199], v[120:123], v[116:119], 0
    s_waitcnt lgkmcnt(8)
    v_mfma_f32_16x16x32_bf16 v[216:219], v[104:107], v[128:131], 0
    v_mfma_f32_16x16x32_bf16 v[220:223], v[108:111], v[128:131], 0
    ds_read_b64_tr_b16 v[156:157], v12 offset:20480
    ds_read_b64_tr_b16 v[158:159], v12 offset:20992
    v_mfma_f32_16x16x32_bf16 v[224:227], v[112:115], v[128:131], 0
    v_mfma_f32_16x16x32_bf16 v[228:231], v[116:119], v[128:131], 0
    s_waitcnt lgkmcnt(0)
    s_waitcnt vmcnt(0)
    s_barrier
    ds_read_b64_tr_b16 v[124:125], v12 offset:40960
    ds_read_b64_tr_b16 v[126:127], v12 offset:41472
    ds_read_b128 v[104:107], v8 offset:32768
    ds_read_b128 v[108:111], v8 offset:34816
    v_mfma_f32_16x16x32_bf16 v[200:203], v[152:155], v[132:135], v[200:203]
    v_mfma_f32_16x16x32_bf16 v[204:207], v[152:155], v[136:139], v[204:207]
    v_mfma_f32_16x16x32_bf16 v[184:187], v[148:151], v[132:135], v[184:187]
    ds_read_b64_tr_b16 v[120:121], v12 offset:32768
    ds_read_b64_tr_b16 v[122:123], v12 offset:33280
    ds_read_b128 v[112:115], v8 offset:36864
    ds_read_b128 v[116:119], v8 offset:38912
    v_mfma_f32_16x16x32_bf16 v[188:191], v[148:151], v[136:139], v[188:191]
    v_mfma_f32_16x16x32_bf16 v[208:211], v[152:155], v[140:143], v[208:211]
    v_mfma_f32_16x16x32_bf16 v[212:215], v[152:155], v[144:147], v[212:215]
    ds_read_b64_tr_b16 v[128:129], v12 offset:49152
    ds_read_b64_tr_b16 v[130:131], v12 offset:49664
    v_mfma_f32_16x16x32_bf16 v[192:195], v[148:151], v[140:143], v[192:195]
    v_mfma_f32_16x16x32_bf16 v[196:199], v[148:151], v[144:147], v[196:199]
    v_mfma_f32_16x16x32_bf16 v[216:219], v[132:135], v[156:159], v[216:219]
    v_mfma_f32_16x16x32_bf16 v[220:223], v[136:139], v[156:159], v[220:223]
    v_mfma_f32_16x16x32_bf16 v[224:227], v[140:143], v[156:159], v[224:227]
    v_mfma_f32_16x16x32_bf16 v[228:231], v[144:147], v[156:159], v[228:231]
    s_waitcnt lgkmcnt(6)
    v_mfma_f32_16x16x32_bf16 v[200:203], v[124:127], v[104:107], v[200:203]
    v_mfma_f32_16x16x32_bf16 v[204:207], v[124:127], v[108:111], v[204:207]
    ds_read_b64_tr_b16 v[152:153], v12 offset:45056
    ds_read_b64_tr_b16 v[154:155], v12 offset:45568
    ds_read_b128 v[132:135], v9 offset:32768
    ds_read_b128 v[136:139], v9 offset:34816
    s_waitcnt lgkmcnt(6)
    v_mfma_f32_16x16x32_bf16 v[184:187], v[120:123], v[104:107], v[184:187]
    v_mfma_f32_16x16x32_bf16 v[188:191], v[120:123], v[108:111], v[188:191]
    v_mfma_f32_16x16x32_bf16 v[208:211], v[124:127], v[112:115], v[208:211]
    v_mfma_f32_16x16x32_bf16 v[212:215], v[124:127], v[116:119], v[212:215]
    ds_read_b64_tr_b16 v[148:149], v12 offset:36864
    ds_read_b64_tr_b16 v[150:151], v12 offset:37376
    ds_read_b128 v[140:143], v9 offset:36864
    ds_read_b128 v[144:147], v9 offset:38912
    v_mfma_f32_16x16x32_bf16 v[192:195], v[120:123], v[112:115], v[192:195]
    v_mfma_f32_16x16x32_bf16 v[196:199], v[120:123], v[116:119], v[196:199]
    s_waitcnt lgkmcnt(8)
    v_mfma_f32_16x16x32_bf16 v[216:219], v[104:107], v[128:131], v[216:219]
    v_mfma_f32_16x16x32_bf16 v[220:223], v[108:111], v[128:131], v[220:223]
    ds_read_b64_tr_b16 v[156:157], v12 offset:53248
    ds_read_b64_tr_b16 v[158:159], v12 offset:53760
    v_mfma_f32_16x16x32_bf16 v[224:227], v[112:115], v[128:131], v[224:227]
    v_mfma_f32_16x16x32_bf16 v[228:231], v[116:119], v[128:131], v[228:231]
    s_waitcnt lgkmcnt(0)
    s_barrier
    v_xor_b32 v12, 0x10000, v12
    v_xor_b32 v8, 0x10000, v8
    v_xor_b32 v9, 0x10000, v9
    ds_read_b64_tr_b16 v[124:125], v12 offset:8192
    ds_read_b64_tr_b16 v[126:127], v12 offset:8704
    ds_read_b128 v[104:107], v8 offset:0
    ds_read_b128 v[108:111], v8 offset:2048
    v_mfma_f32_16x16x32_bf16 v[200:203], v[152:155], v[132:135], v[200:203]
    v_mfma_f32_16x16x32_bf16 v[204:207], v[152:155], v[136:139], v[204:207]
    v_mfma_f32_16x16x32_bf16 v[184:187], v[148:151], v[132:135], v[184:187]
    ds_read_b64_tr_b16 v[120:121], v12 offset:0
    ds_read_b64_tr_b16 v[122:123], v12 offset:512
    ds_read_b128 v[112:115], v8 offset:4096
    ds_read_b128 v[116:119], v8 offset:6144
    v_mfma_f32_16x16x32_bf16 v[188:191], v[148:151], v[136:139], v[188:191]
    v_mfma_f32_16x16x32_bf16 v[208:211], v[152:155], v[140:143], v[208:211]
    v_mfma_f32_16x16x32_bf16 v[212:215], v[152:155], v[144:147], v[212:215]
    ds_read_b64_tr_b16 v[128:129], v12 offset:16384
    ds_read_b64_tr_b16 v[130:131], v12 offset:16896
    v_mfma_f32_16x16x32_bf16 v[192:195], v[148:151], v[140:143], v[192:195]
    v_mfma_f32_16x16x32_bf16 v[196:199], v[148:151], v[144:147], v[196:199]
    v_mfma_f32_16x16x32_bf16 v[216:219], v[132:135], v[156:159], v[216:219]
    v_mfma_f32_16x16x32_bf16 v[220:223], v[136:139], v[156:159], v[220:223]
    v_mfma_f32_16x16x32_bf16 v[224:227], v[140:143], v[156:159], v[224:227]
    v_mfma_f32_16x16x32_bf16 v[228:231], v[144:147], v[156:159], v[228:231]
    s_waitcnt lgkmcnt(6)
    v_mfma_f32_16x16x32_bf16 v[200:203], v[124:127], v[104:107], v[200:203]
    v_mfma_f32_16x16x32_bf16 v[204:207], v[124:127], v[108:111], v[204:207]
    ds_read_b64_tr_b16 v[152:153], v12 offset:12288
    ds_read_b64_tr_b16 v[154:155], v12 offset:12800
    ds_read_b128 v[132:135], v9 offset:0
    ds_read_b128 v[136:139], v9 offset:2048
    s_waitcnt lgkmcnt(6)
    v_mfma_f32_16x16x32_bf16 v[184:187], v[120:123], v[104:107], v[184:187]
    v_mfma_f32_16x16x32_bf16 v[188:191], v[120:123], v[108:111], v[188:191]
    v_mfma_f32_16x16x32_bf16 v[208:211], v[124:127], v[112:115], v[208:211]
    v_mfma_f32_16x16x32_bf16 v[212:215], v[124:127], v[116:119], v[212:215]
    ds_read_b64_tr_b16 v[148:149], v12 offset:4096
    ds_read_b64_tr_b16 v[150:151], v12 offset:4608
    ds_read_b128 v[140:143], v9 offset:4096
    ds_read_b128 v[144:147], v9 offset:6144
    v_mfma_f32_16x16x32_bf16 v[192:195], v[120:123], v[112:115], v[192:195]
    v_mfma_f32_16x16x32_bf16 v[196:199], v[120:123], v[116:119], v[196:199]
    s_waitcnt lgkmcnt(8)
    v_mfma_f32_16x16x32_bf16 v[216:219], v[104:107], v[128:131], v[216:219]
    v_mfma_f32_16x16x32_bf16 v[220:223], v[108:111], v[128:131], v[220:223]
    ds_read_b64_tr_b16 v[156:157], v12 offset:20480
    ds_read_b64_tr_b16 v[158:159], v12 offset:20992
    v_mfma_f32_16x16x32_bf16 v[224:227], v[112:115], v[128:131], v[224:227]
    v_mfma_f32_16x16x32_bf16 v[228:231], v[116:119], v[128:131], v[228:231]
    s_waitcnt lgkmcnt(0)
    s_barrier
    ds_read_b64_tr_b16 v[124:125], v12 offset:40960
    ds_read_b64_tr_b16 v[126:127], v12 offset:41472
    ds_read_b128 v[104:107], v8 offset:32768
    ds_read_b128 v[108:111], v8 offset:34816
    v_mfma_f32_16x16x32_bf16 v[200:203], v[152:155], v[132:135], v[200:203]
    v_mfma_f32_16x16x32_bf16 v[204:207], v[152:155], v[136:139], v[204:207]
    v_mfma_f32_16x16x32_bf16 v[184:187], v[148:151], v[132:135], v[184:187]
    ds_read_b64_tr_b16 v[120:121], v12 offset:32768
    ds_read_b64_tr_b16 v[122:123], v12 offset:33280
    ds_read_b128 v[112:115], v8 offset:36864
    ds_read_b128 v[116:119], v8 offset:38912
    v_mfma_f32_16x16x32_bf16 v[188:191], v[148:151], v[136:139], v[188:191]
    v_mfma_f32_16x16x32_bf16 v[208:211], v[152:155], v[140:143], v[208:211]
    v_mfma_f32_16x16x32_bf16 v[212:215], v[152:155], v[144:147], v[212:215]
    ds_read_b64_tr_b16 v[128:129], v12 offset:49152
    ds_read_b64_tr_b16 v[130:131], v12 offset:49664
    v_mfma_f32_16x16x32_bf16 v[192:195], v[148:151], v[140:143], v[192:195]
    v_mfma_f32_16x16x32_bf16 v[196:199], v[148:151], v[144:147], v[196:199]
    v_mfma_f32_16x16x32_bf16 v[216:219], v[132:135], v[156:159], v[216:219]
    v_mfma_f32_16x16x32_bf16 v[220:223], v[136:139], v[156:159], v[220:223]
    v_mfma_f32_16x16x32_bf16 v[224:227], v[140:143], v[156:159], v[224:227]
    v_mfma_f32_16x16x32_bf16 v[228:231], v[144:147], v[156:159], v[228:231]
    s_waitcnt lgkmcnt(6)
    v_mfma_f32_16x16x32_bf16 v[200:203], v[124:127], v[104:107], v[200:203]
    v_mfma_f32_16x16x32_bf16 v[204:207], v[124:127], v[108:111], v[204:207]
    ds_read_b64_tr_b16 v[152:153], v12 offset:45056
    ds_read_b64_tr_b16 v[154:155], v12 offset:45568
    ds_read_b128 v[132:135], v9 offset:32768
    ds_read_b128 v[136:139], v9 offset:34816
    s_waitcnt lgkmcnt(6)
    v_mfma_f32_16x16x32_bf16 v[184:187], v[120:123], v[104:107], v[184:187]
    v_mfma_f32_16x16x32_bf16 v[188:191], v[120:123], v[108:111], v[188:191]
    v_mfma_f32_16x16x32_bf16 v[208:211], v[124:127], v[112:115], v[208:211]
    v_mfma_f32_16x16x32_bf16 v[212:215], v[124:127], v[116:119], v[212:215]
    ds_read_b64_tr_b16 v[148:149], v12 offset:36864
    ds_read_b64_tr_b16 v[150:151], v12 offset:37376
    ds_read_b128 v[140:143], v9 offset:36864
    ds_read_b128 v[144:147], v9 offset:38912
    v_mfma_f32_16x16x32_bf16 v[192:195], v[120:123], v[112:115], v[192:195]
    v_mfma_f32_16x16x32_bf16 v[196:199], v[120:123], v[116:119], v[196:199]
    s_waitcnt lgkmcnt(8)
    v_mfma_f32_16x16x32_bf16 v[216:219], v[104:107], v[128:131], v[216:219]
    v_mfma_f32_16x16x32_bf16 v[220:223], v[108:111], v[128:131], v[220:223]
    ds_read_b64_tr_b16 v[156:157], v12 offset:53248
    ds_read_b64_tr_b16 v[158:159], v12 offset:53760
    v_mfma_f32_16x16x32_bf16 v[224:227], v[112:115], v[128:131], v[224:227]
    v_mfma_f32_16x16x32_bf16 v[228:231], v[116:119], v[128:131], v[228:231]
    s_waitcnt lgkmcnt(0)
    s_barrier
    v_xor_b32 v12, 0x10000, v12
    v_xor_b32 v8, 0x10000, v8
    v_xor_b32 v9, 0x10000, v9
    ds_read_b64_tr_b16 v[124:125], v12 offset:8192
    ds_read_b64_tr_b16 v[126:127], v12 offset:8704
    ds_read_b128 v[104:107], v8 offset:0
    ds_read_b128 v[108:111], v8 offset:2048
    v_mfma_f32_16x16x32_bf16 v[200:203], v[152:155], v[132:135], v[200:203]
    v_mfma_f32_16x16x32_bf16 v[204:207], v[152:155], v[136:139], v[204:207]
    v_mfma_f32_16x16x32_bf16 v[184:187], v[148:151], v[132:135], v[184:187]
    ds_read_b64_tr_b16 v[120:121], v12 offset:0
    ds_read_b64_tr_b16 v[122:123], v12 offset:512
    ds_read_b128 v[112:115], v8 offset:4096
    ds_read_b128 v[116:119], v8 offset:6144
    v_mfma_f32_16x16x32_bf16 v[188:191], v[148:151], v[136:139], v[188:191]
    v_mfma_f32_16x16x32_bf16 v[208:211], v[152:155], v[140:143], v[208:211]
    v_mfma_f32_16x16x32_bf16 v[212:215], v[152:155], v[144:147], v[212:215]
    ds_read_b64_tr_b16 v[128:129], v12 offset:16384
    ds_read_b64_tr_b16 v[130:131], v12 offset:16896
    v_mfma_f32_16x16x32_bf16 v[192:195], v[148:151], v[140:143], v[192:195]
    v_mfma_f32_16x16x32_bf16 v[196:199], v[148:151], v[144:147], v[196:199]
    v_mfma_f32_16x16x32_bf16 v[216:219], v[132:135], v[156:159], v[216:219]
    v_mfma_f32_16x16x32_bf16 v[220:223], v[136:139], v[156:159], v[220:223]
    v_mfma_f32_16x16x32_bf16 v[224:227], v[140:143], v[156:159], v[224:227]
    v_mfma_f32_16x16x32_bf16 v[228:231], v[144:147], v[156:159], v[228:231]
    s_waitcnt lgkmcnt(6)
    v_mfma_f32_16x16x32_bf16 v[200:203], v[124:127], v[104:107], v[200:203]
    v_mfma_f32_16x16x32_bf16 v[204:207], v[124:127], v[108:111], v[204:207]
    ds_read_b64_tr_b16 v[152:153], v12 offset:12288
    ds_read_b64_tr_b16 v[154:155], v12 offset:12800
    ds_read_b128 v[132:135], v9 offset:0
    ds_read_b128 v[136:139], v9 offset:2048
    s_waitcnt lgkmcnt(6)
    v_mfma_f32_16x16x32_bf16 v[184:187], v[120:123], v[104:107], v[184:187]
    v_mfma_f32_16x16x32_bf16 v[188:191], v[120:123], v[108:111], v[188:191]
    v_mfma_f32_16x16x32_bf16 v[208:211], v[124:127], v[112:115], v[208:211]
    v_mfma_f32_16x16x32_bf16 v[212:215], v[124:127], v[116:119], v[212:215]
    ds_read_b64_tr_b16 v[148:149], v12 offset:4096
    ds_read_b64_tr_b16 v[150:151], v12 offset:4608
    ds_read_b128 v[140:143], v9 offset:4096
    ds_read_b128 v[144:147], v9 offset:6144
    v_mfma_f32_16x16x32_bf16 v[192:195], v[120:123], v[112:115], v[192:195]
    v_mfma_f32_16x16x32_bf16 v[196:199], v[120:123], v[116:119], v[196:199]
    s_waitcnt lgkmcnt(8)
    v_mfma_f32_16x16x32_bf16 v[216:219], v[104:107], v[128:131], v[216:219]
    v_mfma_f32_16x16x32_bf16 v[220:223], v[108:111], v[128:131], v[220:223]
    ds_read_b64_tr_b16 v[156:157], v12 offset:20480
    ds_read_b64_tr_b16 v[158:159], v12 offset:20992
    v_mfma_f32_16x16x32_bf16 v[224:227], v[112:115], v[128:131], v[224:227]
    v_mfma_f32_16x16x32_bf16 v[228:231], v[116:119], v[128:131], v[228:231]
    s_waitcnt lgkmcnt(0)
    s_barrier
    ds_read_b64_tr_b16 v[124:125], v12 offset:40960
    ds_read_b64_tr_b16 v[126:127], v12 offset:41472
    ds_read_b128 v[104:107], v8 offset:32768
    ds_read_b128 v[108:111], v8 offset:34816
    v_mfma_f32_16x16x32_bf16 v[200:203], v[152:155], v[132:135], v[200:203]
    v_mfma_f32_16x16x32_bf16 v[204:207], v[152:155], v[136:139], v[204:207]
    v_mfma_f32_16x16x32_bf16 v[184:187], v[148:151], v[132:135], v[184:187]
    ds_read_b64_tr_b16 v[120:121], v12 offset:32768
    ds_read_b64_tr_b16 v[122:123], v12 offset:33280
    ds_read_b128 v[112:115], v8 offset:36864
    ds_read_b128 v[116:119], v8 offset:38912
    v_mfma_f32_16x16x32_bf16 v[188:191], v[148:151], v[136:139], v[188:191]
    v_mfma_f32_16x16x32_bf16 v[208:211], v[152:155], v[140:143], v[208:211]
    v_mfma_f32_16x16x32_bf16 v[212:215], v[152:155], v[144:147], v[212:215]
    ds_read_b64_tr_b16 v[128:129], v12 offset:49152
    ds_read_b64_tr_b16 v[130:131], v12 offset:49664
    v_mfma_f32_16x16x32_bf16 v[192:195], v[148:151], v[140:143], v[192:195]
    v_mfma_f32_16x16x32_bf16 v[196:199], v[148:151], v[144:147], v[196:199]
    v_mfma_f32_16x16x32_bf16 v[216:219], v[132:135], v[156:159], v[216:219]
    v_mfma_f32_16x16x32_bf16 v[220:223], v[136:139], v[156:159], v[220:223]
    v_mfma_f32_16x16x32_bf16 v[224:227], v[140:143], v[156:159], v[224:227]
    v_mfma_f32_16x16x32_bf16 v[228:231], v[144:147], v[156:159], v[228:231]
    s_waitcnt lgkmcnt(6)
    v_mfma_f32_16x16x32_bf16 v[200:203], v[124:127], v[104:107], v[200:203]
    v_mfma_f32_16x16x32_bf16 v[204:207], v[124:127], v[108:111], v[204:207]
    ds_read_b64_tr_b16 v[152:153], v12 offset:45056
    ds_read_b64_tr_b16 v[154:155], v12 offset:45568
    ds_read_b128 v[132:135], v9 offset:32768
    ds_read_b128 v[136:139], v9 offset:34816
    s_waitcnt lgkmcnt(6)
    v_mfma_f32_16x16x32_bf16 v[184:187], v[120:123], v[104:107], v[184:187]
    v_mfma_f32_16x16x32_bf16 v[188:191], v[120:123], v[108:111], v[188:191]
    v_mfma_f32_16x16x32_bf16 v[208:211], v[124:127], v[112:115], v[208:211]
    v_mfma_f32_16x16x32_bf16 v[212:215], v[124:127], v[116:119], v[212:215]
    ds_read_b64_tr_b16 v[148:149], v12 offset:36864
    ds_read_b64_tr_b16 v[150:151], v12 offset:37376
    ds_read_b128 v[140:143], v9 offset:36864
    ds_read_b128 v[144:147], v9 offset:38912
    v_mfma_f32_16x16x32_bf16 v[192:195], v[120:123], v[112:115], v[192:195]
    v_mfma_f32_16x16x32_bf16 v[196:199], v[120:123], v[116:119], v[196:199]
    s_waitcnt lgkmcnt(8)
    v_mfma_f32_16x16x32_bf16 v[216:219], v[104:107], v[128:131], v[216:219]
    v_mfma_f32_16x16x32_bf16 v[220:223], v[108:111], v[128:131], v[220:223]
    ds_read_b64_tr_b16 v[156:157], v12 offset:53248
    ds_read_b64_tr_b16 v[158:159], v12 offset:53760
    v_mfma_f32_16x16x32_bf16 v[224:227], v[112:115], v[128:131], v[224:227]
    v_mfma_f32_16x16x32_bf16 v[228:231], v[116:119], v[128:131], v[228:231]
    s_waitcnt lgkmcnt(0)
    s_barrier
    v_xor_b32 v12, 0x10000, v12
    v_xor_b32 v8, 0x10000, v8
    v_xor_b32 v9, 0x10000, v9
    ds_read_b64_tr_b16 v[124:125], v12 offset:8192
    ds_read_b64_tr_b16 v[126:127], v12 offset:8704
    ds_read_b128 v[104:107], v8 offset:0
    ds_read_b128 v[108:111], v8 offset:2048
    v_mfma_f32_16x16x32_bf16 v[200:203], v[152:155], v[132:135], v[200:203]
    v_mfma_f32_16x16x32_bf16 v[204:207], v[152:155], v[136:139], v[204:207]
    v_mfma_f32_16x16x32_bf16 v[184:187], v[148:151], v[132:135], v[184:187]
    ds_read_b64_tr_b16 v[120:121], v12 offset:0
    ds_read_b64_tr_b16 v[122:123], v12 offset:512
    ds_read_b128 v[112:115], v8 offset:4096
    ds_read_b128 v[116:119], v8 offset:6144
    v_mfma_f32_16x16x32_bf16 v[188:191], v[148:151], v[136:139], v[188:191]
    v_mfma_f32_16x16x32_bf16 v[208:211], v[152:155], v[140:143], v[208:211]
    v_mfma_f32_16x16x32_bf16 v[212:215], v[152:155], v[144:147], v[212:215]
    ds_read_b64_tr_b16 v[128:129], v12 offset:16384
    ds_read_b64_tr_b16 v[130:131], v12 offset:16896
    v_mfma_f32_16x16x32_bf16 v[192:195], v[148:151], v[140:143], v[192:195]
    v_mfma_f32_16x16x32_bf16 v[196:199], v[148:151], v[144:147], v[196:199]
    v_mfma_f32_16x16x32_bf16 v[216:219], v[132:135], v[156:159], v[216:219]
    v_mfma_f32_16x16x32_bf16 v[220:223], v[136:139], v[156:159], v[220:223]
    v_mfma_f32_16x16x32_bf16 v[224:227], v[140:143], v[156:159], v[224:227]
    v_mfma_f32_16x16x32_bf16 v[228:231], v[144:147], v[156:159], v[228:231]
    s_waitcnt lgkmcnt(6)
    v_mfma_f32_16x16x32_bf16 v[200:203], v[124:127], v[104:107], v[200:203]
    v_mfma_f32_16x16x32_bf16 v[204:207], v[124:127], v[108:111], v[204:207]
    ds_read_b64_tr_b16 v[152:153], v12 offset:12288
    ds_read_b64_tr_b16 v[154:155], v12 offset:12800
    ds_read_b128 v[132:135], v9 offset:0
    ds_read_b128 v[136:139], v9 offset:2048
    s_waitcnt lgkmcnt(6)
    v_mfma_f32_16x16x32_bf16 v[184:187], v[120:123], v[104:107], v[184:187]
    v_mfma_f32_16x16x32_bf16 v[188:191], v[120:123], v[108:111], v[188:191]
    v_mfma_f32_16x16x32_bf16 v[208:211], v[124:127], v[112:115], v[208:211]
    v_mfma_f32_16x16x32_bf16 v[212:215], v[124:127], v[116:119], v[212:215]
    ds_read_b64_tr_b16 v[148:149], v12 offset:4096
    ds_read_b64_tr_b16 v[150:151], v12 offset:4608
    ds_read_b128 v[140:143], v9 offset:4096
    ds_read_b128 v[144:147], v9 offset:6144
    v_mfma_f32_16x16x32_bf16 v[192:195], v[120:123], v[112:115], v[192:195]
    v_mfma_f32_16x16x32_bf16 v[196:199], v[120:123], v[116:119], v[196:199]
    s_waitcnt lgkmcnt(8)
    v_mfma_f32_16x16x32_bf16 v[216:219], v[104:107], v[128:131], v[216:219]
    v_mfma_f32_16x16x32_bf16 v[220:223], v[108:111], v[128:131], v[220:223]
    ds_read_b64_tr_b16 v[156:157], v12 offset:20480
    ds_read_b64_tr_b16 v[158:159], v12 offset:20992
    v_mfma_f32_16x16x32_bf16 v[224:227], v[112:115], v[128:131], v[224:227]
    v_mfma_f32_16x16x32_bf16 v[228:231], v[116:119], v[128:131], v[228:231]
    s_waitcnt lgkmcnt(0)
    s_barrier
    ds_read_b64_tr_b16 v[124:125], v12 offset:40960
    ds_read_b64_tr_b16 v[126:127], v12 offset:41472
    ds_read_b128 v[104:107], v8 offset:32768
    ds_read_b128 v[108:111], v8 offset:34816
    v_mfma_f32_16x16x32_bf16 v[200:203], v[152:155], v[132:135], v[200:203]
    v_mfma_f32_16x16x32_bf16 v[204:207], v[152:155], v[136:139], v[204:207]
    v_mfma_f32_16x16x32_bf16 v[184:187], v[148:151], v[132:135], v[184:187]
    ds_read_b64_tr_b16 v[120:121], v12 offset:32768
    ds_read_b64_tr_b16 v[122:123], v12 offset:33280
    ds_read_b128 v[112:115], v8 offset:36864
    ds_read_b128 v[116:119], v8 offset:38912
    v_mfma_f32_16x16x32_bf16 v[188:191], v[148:151], v[136:139], v[188:191]
    v_mfma_f32_16x16x32_bf16 v[208:211], v[152:155], v[140:143], v[208:211]
    v_mfma_f32_16x16x32_bf16 v[212:215], v[152:155], v[144:147], v[212:215]
    ds_read_b64_tr_b16 v[128:129], v12 offset:49152
    ds_read_b64_tr_b16 v[130:131], v12 offset:49664
    v_mfma_f32_16x16x32_bf16 v[192:195], v[148:151], v[140:143], v[192:195]
    v_mfma_f32_16x16x32_bf16 v[196:199], v[148:151], v[144:147], v[196:199]
    v_mfma_f32_16x16x32_bf16 v[216:219], v[132:135], v[156:159], v[216:219]
    v_mfma_f32_16x16x32_bf16 v[220:223], v[136:139], v[156:159], v[220:223]
    v_mfma_f32_16x16x32_bf16 v[224:227], v[140:143], v[156:159], v[224:227]
    v_mfma_f32_16x16x32_bf16 v[228:231], v[144:147], v[156:159], v[228:231]
    s_waitcnt lgkmcnt(6)
    v_mfma_f32_16x16x32_bf16 v[200:203], v[124:127], v[104:107], v[200:203]
    v_mfma_f32_16x16x32_bf16 v[204:207], v[124:127], v[108:111], v[204:207]
    ds_read_b64_tr_b16 v[152:153], v12 offset:45056
    ds_read_b64_tr_b16 v[154:155], v12 offset:45568
    ds_read_b128 v[132:135], v9 offset:32768
    ds_read_b128 v[136:139], v9 offset:34816
    s_waitcnt lgkmcnt(6)
    v_mfma_f32_16x16x32_bf16 v[184:187], v[120:123], v[104:107], v[184:187]
    v_mfma_f32_16x16x32_bf16 v[188:191], v[120:123], v[108:111], v[188:191]
    v_mfma_f32_16x16x32_bf16 v[208:211], v[124:127], v[112:115], v[208:211]
    v_mfma_f32_16x16x32_bf16 v[212:215], v[124:127], v[116:119], v[212:215]
    ds_read_b64_tr_b16 v[148:149], v12 offset:36864
    ds_read_b64_tr_b16 v[150:151], v12 offset:37376
    ds_read_b128 v[140:143], v9 offset:36864
    ds_read_b128 v[144:147], v9 offset:38912
    v_mfma_f32_16x16x32_bf16 v[192:195], v[120:123], v[112:115], v[192:195]
    v_mfma_f32_16x16x32_bf16 v[196:199], v[120:123], v[116:119], v[196:199]
    s_waitcnt lgkmcnt(8)
    v_mfma_f32_16x16x32_bf16 v[216:219], v[104:107], v[128:131], v[216:219]
    v_mfma_f32_16x16x32_bf16 v[220:223], v[108:111], v[128:131], v[220:223]
    ds_read_b64_tr_b16 v[156:157], v12 offset:53248
    ds_read_b64_tr_b16 v[158:159], v12 offset:53760
    v_mfma_f32_16x16x32_bf16 v[224:227], v[112:115], v[128:131], v[224:227]
    v_mfma_f32_16x16x32_bf16 v[228:231], v[116:119], v[128:131], v[228:231]
    s_waitcnt lgkmcnt(0)
    s_mov_b64 exec, 1
    ds_add_u32 v254, v253 offset:64
    s_mov_b64 exec, -1
    v_mfma_f32_16x16x32_bf16 v[200:203], v[152:155], v[132:135], v[200:203]
    v_mfma_f32_16x16x32_bf16 v[204:207], v[152:155], v[136:139], v[204:207]
    v_mfma_f32_16x16x32_bf16 v[184:187], v[148:151], v[132:135], v[184:187]
    v_mfma_f32_16x16x32_bf16 v[188:191], v[148:151], v[136:139], v[188:191]
    v_mfma_f32_16x16x32_bf16 v[208:211], v[152:155], v[140:143], v[208:211]
    v_mfma_f32_16x16x32_bf16 v[212:215], v[152:155], v[144:147], v[212:215]
    v_mfma_f32_16x16x32_bf16 v[192:195], v[148:151], v[140:143], v[192:195]
    v_mfma_f32_16x16x32_bf16 v[196:199], v[148:151], v[144:147], v[196:199]
    v_mfma_f32_16x16x32_bf16 v[216:219], v[132:135], v[156:159], v[216:219]
    v_mfma_f32_16x16x32_bf16 v[220:223], v[136:139], v[156:159], v[220:223]
    v_mfma_f32_16x16x32_bf16 v[224:227], v[140:143], v[156:159], v[224:227]
    v_mfma_f32_16x16x32_bf16 v[228:231], v[144:147], v[156:159], v[228:231]
    s_setprio 3
    s_mov_b32 s32, s46
    s_mov_b32 s33, s47
    s_mov_b32 s34, 524288
    s_mov_b32 s35, 0x00020000
    s_mov_b32 s8, s52
    s_mov_b32 s9, s53
    s_mov_b32 s10, 524288
    s_mov_b32 s11, 0x00020000
    s_mov_b32 s64, 1069066811
    s_mov_b32 s65, 1069066811
    s_mov_b32 s77, 0x3f803f80
    v_cvt_pk_bf16_f32 v112, v200, v201
    v_cvt_pk_bf16_f32 v113, v202, v203
    v_cvt_pk_bf16_f32 v114, v204, v205
    v_cvt_pk_bf16_f32 v115, v206, v207
    v_cvt_pk_bf16_f32 v116, v208, v209
    v_cvt_pk_bf16_f32 v117, v210, v211
    v_cvt_pk_bf16_f32 v118, v212, v213
    v_cvt_pk_bf16_f32 v119, v214, v215
    v_permlane16_swap_b32 v112, v114
    v_permlane16_swap_b32 v113, v115
    v_permlane16_swap_b32 v116, v118
    v_permlane16_swap_b32 v117, v119
    v_mfma_f32_32x32x16_bf16 v[48:63], v[248:251], v[112:115], 0
    s_nop 0
    v_mfma_f32_32x32x16_bf16 v[64:79], v[248:251], v[116:119], 0
    v_cvt_pk_bf16_f32 v120, v184, v185
    v_cvt_pk_bf16_f32 v121, v186, v187
    v_cvt_pk_bf16_f32 v122, v188, v189
    v_cvt_pk_bf16_f32 v123, v190, v191
    v_cvt_pk_bf16_f32 v124, v192, v193
    v_cvt_pk_bf16_f32 v125, v194, v195
    v_cvt_pk_bf16_f32 v126, v196, v197
    v_cvt_pk_bf16_f32 v127, v198, v199
    v_permlane16_swap_b32 v120, v122
    v_permlane16_swap_b32 v121, v123
    v_permlane16_swap_b32 v124, v126
    v_permlane16_swap_b32 v125, v127
    v_mfma_f32_32x32x16_bf16 v[80:95], v[248:251], v[120:123], 0
    s_nop 0
    v_mfma_f32_32x32x16_bf16 v[96:111], v[248:251], v[124:127], 0
    v_cvt_pk_bf16_f32 v128, v216, v217
    v_cvt_pk_bf16_f32 v129, v218, v219
    v_mov_b32 v130, s77
    v_mov_b32 v131, s77
    v_cvt_pk_bf16_f32 v132, v220, v221
    v_cvt_pk_bf16_f32 v133, v222, v223
    v_mov_b32 v134, s77
    v_mov_b32 v135, s77
    v_cvt_pk_bf16_f32 v136, v224, v225
    v_cvt_pk_bf16_f32 v137, v226, v227
    v_mov_b32 v138, s77
    v_mov_b32 v139, s77
    v_cvt_pk_bf16_f32 v140, v228, v229
    v_cvt_pk_bf16_f32 v141, v230, v231
    v_mov_b32 v142, s77
    v_mov_b32 v143, s77
    v_permlane16_swap_b32 v128, v130
    v_permlane16_swap_b32 v129, v131
    v_permlane16_swap_b32 v132, v134
    v_permlane16_swap_b32 v133, v135
    v_permlane16_swap_b32 v136, v138
    v_permlane16_swap_b32 v137, v139
    v_permlane16_swap_b32 v140, v142
    v_permlane16_swap_b32 v141, v143
    v_permlane32_swap_b32 v128, v130
    v_permlane32_swap_b32 v129, v131
    v_permlane32_swap_b32 v132, v134
    v_permlane32_swap_b32 v133, v135
    v_permlane32_swap_b32 v136, v138
    v_permlane32_swap_b32 v137, v139
    v_permlane32_swap_b32 v140, v142
    v_permlane32_swap_b32 v141, v143
    v_max3_f32 v176, v48, v49, v50
    v_max3_f32 v177, v56, v57, v58
    v_max3_f32 v176, v176, v51, v52
    v_max3_f32 v177, v177, v59, v60
    v_max3_f32 v176, v176, v53, v54
    v_max3_f32 v177, v177, v61, v62
    v_max_f32 v176, v176, v55
    v_max_f32 v177, v177, v63
    s_nop 1
    v_permlane32_swap_b32 v176, v177
    v_max_f32 v176, v176, v177
    v_mul_f32 v176, 3216550459, v176
    v_mov_b32 v177, v176
    s_nop 1
    v_permlane32_swap_b32 v176, v177
    v_pk_fma_f32 v[48:49], v[48:49], s[64:65], v[176:177] op_sel:[0,0,0] op_sel_hi:[1,1,0]
    v_pk_fma_f32 v[50:51], v[50:51], s[64:65], v[176:177] op_sel:[0,0,0] op_sel_hi:[1,1,0]
    v_pk_fma_f32 v[52:53], v[52:53], s[64:65], v[176:177] op_sel:[0,0,0] op_sel_hi:[1,1,0]
    v_pk_fma_f32 v[54:55], v[54:55], s[64:65], v[176:177] op_sel:[0,0,0] op_sel_hi:[1,1,0]
    v_pk_fma_f32 v[56:57], v[56:57], s[64:65], v[176:177] op_sel:[0,0,1] op_sel_hi:[1,1,1]
    v_pk_fma_f32 v[58:59], v[58:59], s[64:65], v[176:177] op_sel:[0,0,1] op_sel_hi:[1,1,1]
    v_pk_fma_f32 v[60:61], v[60:61], s[64:65], v[176:177] op_sel:[0,0,1] op_sel_hi:[1,1,1]
    v_pk_fma_f32 v[62:63], v[62:63], s[64:65], v[176:177] op_sel:[0,0,1] op_sel_hi:[1,1,1]
    v_exp_f32 v48, v48
    v_exp_f32 v49, v49
    v_exp_f32 v50, v50
    v_exp_f32 v51, v51
    v_exp_f32 v52, v52
    v_exp_f32 v53, v53
    v_exp_f32 v54, v54
    v_exp_f32 v55, v55
    v_exp_f32 v56, v56
    v_exp_f32 v57, v57
    v_exp_f32 v58, v58
    v_exp_f32 v59, v59
    v_exp_f32 v60, v60
    v_exp_f32 v61, v61
    v_exp_f32 v62, v62
    v_exp_f32 v63, v63
    v_pk_add_f32 v[178:179], v[48:49], v[50:51]
    v_pk_add_f32 v[180:181], v[56:57], v[58:59]
    v_pk_add_f32 v[178:179], v[178:179], v[52:53]
    v_pk_add_f32 v[180:181], v[180:181], v[60:61]
    v_pk_add_f32 v[178:179], v[178:179], v[54:55]
    v_pk_add_f32 v[180:181], v[180:181], v[62:63]
    v_add_f32 v176, v178, v179
    v_add_f32 v177, v180, v181
    s_nop 1
    v_permlane32_swap_b32 v176, v177
    v_add_f32 v176, v176, v177
    v_rcp_f32 v176, v176
    s_nop 0
    v_mov_b32 v177, v176
    s_nop 1
    v_permlane32_swap_b32 v176, v177
    v_pk_mul_f32 v[48:49], v[48:49], v[176:177] op_sel:[0,0] op_sel_hi:[1,0]
    v_pk_mul_f32 v[50:51], v[50:51], v[176:177] op_sel:[0,0] op_sel_hi:[1,0]
    v_pk_mul_f32 v[52:53], v[52:53], v[176:177] op_sel:[0,0] op_sel_hi:[1,0]
    v_pk_mul_f32 v[54:55], v[54:55], v[176:177] op_sel:[0,0] op_sel_hi:[1,0]
    v_pk_mul_f32 v[56:57], v[56:57], v[176:177] op_sel:[0,1] op_sel_hi:[1,1]
    v_pk_mul_f32 v[58:59], v[58:59], v[176:177] op_sel:[0,1] op_sel_hi:[1,1]
    v_pk_mul_f32 v[60:61], v[60:61], v[176:177] op_sel:[0,1] op_sel_hi:[1,1]
    v_pk_mul_f32 v[62:63], v[62:63], v[176:177] op_sel:[0,1] op_sel_hi:[1,1]
    v_cvt_pk_bf16_f32 v144, v48, v49
    v_cvt_pk_bf16_f32 v145, v50, v51
    v_cvt_pk_bf16_f32 v146, v52, v53
    v_cvt_pk_bf16_f32 v147, v54, v55
    v_cvt_pk_bf16_f32 v148, v56, v57
    v_cvt_pk_bf16_f32 v149, v58, v59
    v_cvt_pk_bf16_f32 v150, v60, v61
    v_cvt_pk_bf16_f32 v151, v62, v63
    v_mfma_f32_32x32x16_bf16 v[152:167], v[144:147], v[40:43], 0
    s_nop 0
    v_mfma_f32_32x32x16_bf16 v[152:167], v[148:151], v[44:47], v[152:167]
    v_max3_f32 v176, v64, v65, v66
    v_max3_f32 v177, v72, v73, v74
    v_max3_f32 v176, v176, v67, v68
    v_max3_f32 v177, v177, v75, v76
    v_max3_f32 v176, v176, v69, v70
    v_max3_f32 v177, v177, v77, v78
    v_max_f32 v176, v176, v71
    v_max_f32 v177, v177, v79
    s_nop 1
    v_permlane32_swap_b32 v176, v177
    v_max_f32 v176, v176, v177
    v_mul_f32 v176, 3216550459, v176
    v_mov_b32 v177, v176
    s_nop 1
    v_permlane32_swap_b32 v176, v177
    v_pk_fma_f32 v[64:65], v[64:65], s[64:65], v[176:177] op_sel:[0,0,0] op_sel_hi:[1,1,0]
    v_pk_fma_f32 v[66:67], v[66:67], s[64:65], v[176:177] op_sel:[0,0,0] op_sel_hi:[1,1,0]
    v_pk_fma_f32 v[68:69], v[68:69], s[64:65], v[176:177] op_sel:[0,0,0] op_sel_hi:[1,1,0]
    v_pk_fma_f32 v[70:71], v[70:71], s[64:65], v[176:177] op_sel:[0,0,0] op_sel_hi:[1,1,0]
    v_pk_fma_f32 v[72:73], v[72:73], s[64:65], v[176:177] op_sel:[0,0,1] op_sel_hi:[1,1,1]
    v_pk_fma_f32 v[74:75], v[74:75], s[64:65], v[176:177] op_sel:[0,0,1] op_sel_hi:[1,1,1]
    v_pk_fma_f32 v[76:77], v[76:77], s[64:65], v[176:177] op_sel:[0,0,1] op_sel_hi:[1,1,1]
    v_pk_fma_f32 v[78:79], v[78:79], s[64:65], v[176:177] op_sel:[0,0,1] op_sel_hi:[1,1,1]
    v_exp_f32 v64, v64
    v_exp_f32 v65, v65
    v_exp_f32 v66, v66
    v_exp_f32 v67, v67
    v_exp_f32 v68, v68
    v_exp_f32 v69, v69
    v_exp_f32 v70, v70
    v_exp_f32 v71, v71
    v_exp_f32 v72, v72
    v_exp_f32 v73, v73
    v_exp_f32 v74, v74
    v_exp_f32 v75, v75
    v_exp_f32 v76, v76
    v_exp_f32 v77, v77
    v_exp_f32 v78, v78
    v_exp_f32 v79, v79
    v_pk_add_f32 v[178:179], v[64:65], v[66:67]
    v_pk_add_f32 v[180:181], v[72:73], v[74:75]
    v_pk_add_f32 v[178:179], v[178:179], v[68:69]
    v_pk_add_f32 v[180:181], v[180:181], v[76:77]
    v_pk_add_f32 v[178:179], v[178:179], v[70:71]
    v_pk_add_f32 v[180:181], v[180:181], v[78:79]
    v_add_f32 v176, v178, v179
    v_add_f32 v177, v180, v181
    s_nop 1
    v_permlane32_swap_b32 v176, v177
    v_add_f32 v176, v176, v177
    v_rcp_f32 v176, v176
    s_nop 0
    v_mov_b32 v177, v176
    s_nop 1
    v_permlane32_swap_b32 v176, v177
    v_pk_mul_f32 v[64:65], v[64:65], v[176:177] op_sel:[0,0] op_sel_hi:[1,0]
    v_pk_mul_f32 v[66:67], v[66:67], v[176:177] op_sel:[0,0] op_sel_hi:[1,0]
    v_pk_mul_f32 v[68:69], v[68:69], v[176:177] op_sel:[0,0] op_sel_hi:[1,0]
    v_pk_mul_f32 v[70:71], v[70:71], v[176:177] op_sel:[0,0] op_sel_hi:[1,0]
    v_pk_mul_f32 v[72:73], v[72:73], v[176:177] op_sel:[0,1] op_sel_hi:[1,1]
    v_pk_mul_f32 v[74:75], v[74:75], v[176:177] op_sel:[0,1] op_sel_hi:[1,1]
    v_pk_mul_f32 v[76:77], v[76:77], v[176:177] op_sel:[0,1] op_sel_hi:[1,1]
    v_pk_mul_f32 v[78:79], v[78:79], v[176:177] op_sel:[0,1] op_sel_hi:[1,1]
    v_cvt_pk_bf16_f32 v144, v64, v65
    v_cvt_pk_bf16_f32 v145, v66, v67
    v_cvt_pk_bf16_f32 v146, v68, v69
    v_cvt_pk_bf16_f32 v147, v70, v71
    v_cvt_pk_bf16_f32 v148, v72, v73
    v_cvt_pk_bf16_f32 v149, v74, v75
    v_cvt_pk_bf16_f32 v150, v76, v77
    v_cvt_pk_bf16_f32 v151, v78, v79
    v_cvt_pk_bf16_f32 v168, v152, v153
    v_cvt_pk_bf16_f32 v169, v154, v155
    v_cvt_pk_bf16_f32 v170, v156, v157
    v_cvt_pk_bf16_f32 v171, v158, v159
    v_cvt_pk_bf16_f32 v172, v160, v161
    v_cvt_pk_bf16_f32 v173, v162, v163
    v_cvt_pk_bf16_f32 v174, v164, v165
    v_cvt_pk_bf16_f32 v175, v166, v167
    v_mfma_f32_32x32x16_bf16 v[152:167], v[144:147], v[40:43], 0
    v_mfma_f32_32x32x16_bf16 v[152:167], v[148:151], v[44:47], v[152:167]
    v_mfma_f32_32x32x16_bf16 v[184:199], v[168:171], v[128:131], 0
    v_mfma_f32_32x32x16_bf16 v[184:199], v[172:175], v[132:135], v[184:199]
    v_max3_f32 v176, v80, v81, v82
    v_max3_f32 v177, v88, v89, v90
    v_max3_f32 v176, v176, v83, v84
    v_max3_f32 v177, v177, v91, v92
    v_max3_f32 v176, v176, v85, v86
    v_max3_f32 v177, v177, v93, v94
    v_max_f32 v176, v176, v87
    v_max_f32 v177, v177, v95
    s_nop 1
    v_permlane32_swap_b32 v176, v177
    v_max_f32 v176, v176, v177
    v_mul_f32 v176, 3216550459, v176
    v_mov_b32 v177, v176
    s_nop 1
    v_permlane32_swap_b32 v176, v177
    v_pk_fma_f32 v[80:81], v[80:81], s[64:65], v[176:177] op_sel:[0,0,0] op_sel_hi:[1,1,0]
    v_pk_fma_f32 v[82:83], v[82:83], s[64:65], v[176:177] op_sel:[0,0,0] op_sel_hi:[1,1,0]
    v_pk_fma_f32 v[84:85], v[84:85], s[64:65], v[176:177] op_sel:[0,0,0] op_sel_hi:[1,1,0]
    v_pk_fma_f32 v[86:87], v[86:87], s[64:65], v[176:177] op_sel:[0,0,0] op_sel_hi:[1,1,0]
    v_pk_fma_f32 v[88:89], v[88:89], s[64:65], v[176:177] op_sel:[0,0,1] op_sel_hi:[1,1,1]
    v_pk_fma_f32 v[90:91], v[90:91], s[64:65], v[176:177] op_sel:[0,0,1] op_sel_hi:[1,1,1]
    v_pk_fma_f32 v[92:93], v[92:93], s[64:65], v[176:177] op_sel:[0,0,1] op_sel_hi:[1,1,1]
    v_pk_fma_f32 v[94:95], v[94:95], s[64:65], v[176:177] op_sel:[0,0,1] op_sel_hi:[1,1,1]
    v_exp_f32 v80, v80
    v_exp_f32 v81, v81
    v_exp_f32 v82, v82
    v_exp_f32 v83, v83
    v_exp_f32 v84, v84
    v_exp_f32 v85, v85
    v_exp_f32 v86, v86
    v_exp_f32 v87, v87
    v_exp_f32 v88, v88
    v_exp_f32 v89, v89
    v_exp_f32 v90, v90
    v_exp_f32 v91, v91
    v_exp_f32 v92, v92
    v_exp_f32 v93, v93
    v_exp_f32 v94, v94
    v_exp_f32 v95, v95
    v_pk_add_f32 v[178:179], v[80:81], v[82:83]
    v_pk_add_f32 v[180:181], v[88:89], v[90:91]
    v_pk_add_f32 v[178:179], v[178:179], v[84:85]
    v_pk_add_f32 v[180:181], v[180:181], v[92:93]
    v_pk_add_f32 v[178:179], v[178:179], v[86:87]
    v_pk_add_f32 v[180:181], v[180:181], v[94:95]
    v_add_f32 v176, v178, v179
    v_add_f32 v177, v180, v181
    s_nop 1
    v_permlane32_swap_b32 v176, v177
    v_add_f32 v176, v176, v177
    v_rcp_f32 v176, v176
    s_nop 0
    v_mov_b32 v177, v176
    s_nop 1
    v_permlane32_swap_b32 v176, v177
    v_pk_mul_f32 v[80:81], v[80:81], v[176:177] op_sel:[0,0] op_sel_hi:[1,0]
    v_pk_mul_f32 v[82:83], v[82:83], v[176:177] op_sel:[0,0] op_sel_hi:[1,0]
    v_pk_mul_f32 v[84:85], v[84:85], v[176:177] op_sel:[0,0] op_sel_hi:[1,0]
    v_pk_mul_f32 v[86:87], v[86:87], v[176:177] op_sel:[0,0] op_sel_hi:[1,0]
    v_pk_mul_f32 v[88:89], v[88:89], v[176:177] op_sel:[0,1] op_sel_hi:[1,1]
    v_pk_mul_f32 v[90:91], v[90:91], v[176:177] op_sel:[0,1] op_sel_hi:[1,1]
    v_pk_mul_f32 v[92:93], v[92:93], v[176:177] op_sel:[0,1] op_sel_hi:[1,1]
    v_pk_mul_f32 v[94:95], v[94:95], v[176:177] op_sel:[0,1] op_sel_hi:[1,1]
    v_cvt_pk_bf16_f32 v24, v80, v81
    v_cvt_pk_bf16_f32 v25, v82, v83
    v_cvt_pk_bf16_f32 v26, v84, v85
    v_cvt_pk_bf16_f32 v27, v86, v87
    v_cvt_pk_bf16_f32 v28, v88, v89
    v_cvt_pk_bf16_f32 v29, v90, v91
    v_cvt_pk_bf16_f32 v30, v92, v93
    v_cvt_pk_bf16_f32 v31, v94, v95
    v_cvt_pk_bf16_f32 v168, v152, v153
    v_cvt_pk_bf16_f32 v169, v154, v155
    v_cvt_pk_bf16_f32 v170, v156, v157
    v_cvt_pk_bf16_f32 v171, v158, v159
    v_cvt_pk_bf16_f32 v172, v160, v161
    v_cvt_pk_bf16_f32 v173, v162, v163
    v_cvt_pk_bf16_f32 v174, v164, v165
    v_cvt_pk_bf16_f32 v175, v166, v167
    v_mfma_f32_32x32x16_bf16 v[184:199], v[168:171], v[136:139], v[184:199]
    s_nop 0
    v_mfma_f32_32x32x16_bf16 v[184:199], v[172:175], v[140:143], v[184:199]
    v_lshrrev_b32 v2, 5, v1
    v_mul_u32_u24 v2, 12288, v2
    v_and_b32 v14, 31, v1
    v_lshl_add_u32 v2, v14, 4, v2
    s_mul_i32 s74, s7, 98304
    s_mul_i32 s75, s5, 384
    s_add_u32 s74, s74, s75
    s_add_u32 s74, s74, 8388608
    s_mov_b32 exec_lo, 0x1ffff
    s_mov_b32 exec_hi, 0x1ffff
    s_nop 1
    buffer_store_dwordx4 v[184:187], v2, s[24:27], s74 offen sc1
    s_add_u32 s74, s74, 24576
    buffer_store_dwordx4 v[188:191], v2, s[24:27], s74 offen sc1
    s_add_u32 s74, s74, 24576
    buffer_store_dwordx4 v[192:195], v2, s[24:27], s74 offen sc1
    s_add_u32 s74, s74, 24576
    buffer_store_dwordx4 v[196:199], v2, s[24:27], s74 offen sc1
    s_mov_b64 exec, -1
    v_max3_f32 v176, v96, v97, v98
    v_max3_f32 v177, v104, v105, v106
    v_max3_f32 v176, v176, v99, v100
    v_max3_f32 v177, v177, v107, v108
    v_max3_f32 v176, v176, v101, v102
    v_max3_f32 v177, v177, v109, v110
    v_max_f32 v176, v176, v103
    v_max_f32 v177, v177, v111
    s_nop 1
    v_permlane32_swap_b32 v176, v177
    v_max_f32 v176, v176, v177
    v_mul_f32 v176, 3216550459, v176
    v_mov_b32 v177, v176
    s_nop 1
    v_permlane32_swap_b32 v176, v177
    v_pk_fma_f32 v[96:97], v[96:97], s[64:65], v[176:177] op_sel:[0,0,0] op_sel_hi:[1,1,0]
    v_pk_fma_f32 v[98:99], v[98:99], s[64:65], v[176:177] op_sel:[0,0,0] op_sel_hi:[1,1,0]
    v_pk_fma_f32 v[100:101], v[100:101], s[64:65], v[176:177] op_sel:[0,0,0] op_sel_hi:[1,1,0]
    v_pk_fma_f32 v[102:103], v[102:103], s[64:65], v[176:177] op_sel:[0,0,0] op_sel_hi:[1,1,0]
    v_pk_fma_f32 v[104:105], v[104:105], s[64:65], v[176:177] op_sel:[0,0,1] op_sel_hi:[1,1,1]
    v_pk_fma_f32 v[106:107], v[106:107], s[64:65], v[176:177] op_sel:[0,0,1] op_sel_hi:[1,1,1]
    v_pk_fma_f32 v[108:109], v[108:109], s[64:65], v[176:177] op_sel:[0,0,1] op_sel_hi:[1,1,1]
    v_pk_fma_f32 v[110:111], v[110:111], s[64:65], v[176:177] op_sel:[0,0,1] op_sel_hi:[1,1,1]
    v_exp_f32 v96, v96
    v_exp_f32 v97, v97
    v_exp_f32 v98, v98
    v_exp_f32 v99, v99
    v_exp_f32 v100, v100
    v_exp_f32 v101, v101
    v_exp_f32 v102, v102
    v_exp_f32 v103, v103
    v_exp_f32 v104, v104
    v_exp_f32 v105, v105
    v_exp_f32 v106, v106
    v_exp_f32 v107, v107
    v_exp_f32 v108, v108
    v_exp_f32 v109, v109
    v_exp_f32 v110, v110
    v_exp_f32 v111, v111
    v_pk_add_f32 v[178:179], v[96:97], v[98:99]
    v_pk_add_f32 v[180:181], v[104:105], v[106:107]
    v_pk_add_f32 v[178:179], v[178:179], v[100:101]
    v_pk_add_f32 v[180:181], v[180:181], v[108:109]
    v_pk_add_f32 v[178:179], v[178:179], v[102:103]
    v_pk_add_f32 v[180:181], v[180:181], v[110:111]
    v_add_f32 v176, v178, v179
    v_add_f32 v177, v180, v181
    s_nop 1
    v_permlane32_swap_b32 v176, v177
    v_add_f32 v176, v176, v177
    v_rcp_f32 v176, v176
    s_nop 0
    v_mov_b32 v177, v176
    s_nop 1
    v_permlane32_swap_b32 v176, v177
    v_pk_mul_f32 v[96:97], v[96:97], v[176:177] op_sel:[0,0] op_sel_hi:[1,0]
    v_pk_mul_f32 v[98:99], v[98:99], v[176:177] op_sel:[0,0] op_sel_hi:[1,0]
    v_pk_mul_f32 v[100:101], v[100:101], v[176:177] op_sel:[0,0] op_sel_hi:[1,0]
    v_pk_mul_f32 v[102:103], v[102:103], v[176:177] op_sel:[0,0] op_sel_hi:[1,0]
    v_pk_mul_f32 v[104:105], v[104:105], v[176:177] op_sel:[0,1] op_sel_hi:[1,1]
    v_pk_mul_f32 v[106:107], v[106:107], v[176:177] op_sel:[0,1] op_sel_hi:[1,1]
    v_pk_mul_f32 v[108:109], v[108:109], v[176:177] op_sel:[0,1] op_sel_hi:[1,1]
    v_pk_mul_f32 v[110:111], v[110:111], v[176:177] op_sel:[0,1] op_sel_hi:[1,1]
    v_cvt_pk_bf16_f32 v32, v96, v97
    v_cvt_pk_bf16_f32 v33, v98, v99
    v_cvt_pk_bf16_f32 v34, v100, v101
    v_cvt_pk_bf16_f32 v35, v102, v103
    v_cvt_pk_bf16_f32 v36, v104, v105
    v_cvt_pk_bf16_f32 v37, v106, v107
    v_cvt_pk_bf16_f32 v38, v108, v109
    v_cvt_pk_bf16_f32 v39, v110, v111
    s_lshl_b32 s74, s4, 11
    s_add_u32 s74, s74, 131072
    v_add_u32 v2, s74, v0
    ds_read_b128 v[16:19], v2
    ds_read_b128 v[20:23], v2 offset:1024
    s_lshl_b32 s74, s4, 9
    s_add_u32 s74, s74, 139264
    v_lshl_add_u32 v2, v1, 3, s74
    ds_read_b64 v[176:177], v2
    s_waitcnt vmcnt(4)
    s_mov_b64 exec, 1
    s_mov_b32 s78, 33554432
L_cw_1:
    ds_read_b32 v15, v254 offset:64
    s_sub_u32 s78, s78, 1
    s_cbranch_scc1 L_cwd_2
    s_waitcnt lgkmcnt(0)
    v_cmp_gt_u32 vcc, 4, v15
    s_nop 0
    s_cbranch_vccnz L_cw_1
L_cwd_2:
    s_mov_b64 exec, -1
    v_pk_mov_b32 v[40:41], v[176:177], v[176:177] op_sel:[0,0]
    v_pk_mov_b32 v[56:57], v[176:177], v[176:177] op_sel:[1,1]
    v_pk_mov_b32 v[42:43], v[176:177], v[176:177] op_sel:[0,0]
    v_pk_mov_b32 v[58:59], v[176:177], v[176:177] op_sel:[1,1]
    v_pk_mov_b32 v[44:45], v[176:177], v[176:177] op_sel:[0,0]
    v_pk_mov_b32 v[60:61], v[176:177], v[176:177] op_sel:[1,1]
    v_pk_mov_b32 v[46:47], v[176:177], v[176:177] op_sel:[0,0]
    v_pk_mov_b32 v[62:63], v[176:177], v[176:177] op_sel:[1,1]
    v_pk_mov_b32 v[48:49], v[176:177], v[176:177] op_sel:[0,0]
    v_pk_mov_b32 v[64:65], v[176:177], v[176:177] op_sel:[1,1]
    v_pk_mov_b32 v[50:51], v[176:177], v[176:177] op_sel:[0,0]
    v_pk_mov_b32 v[66:67], v[176:177], v[176:177] op_sel:[1,1]
    v_pk_mov_b32 v[52:53], v[176:177], v[176:177] op_sel:[0,0]
    v_pk_mov_b32 v[68:69], v[176:177], v[176:177] op_sel:[1,1]
    v_pk_mov_b32 v[54:55], v[176:177], v[176:177] op_sel:[0,0]
    v_pk_mov_b32 v[70:71], v[176:177], v[176:177] op_sel:[1,1]
    s_branch L_attA
L_roleB:
    s_getpc_b64 s[74:75]
L_pcB:
    s_sub_u32 s74, s74, L_pcB-concat_heads__linear_kernel_hedgehog__softmax_full_mha__prompt_kernel
    s_subb_u32 s75, s75, 0
    s_lshr_b32 s76, s2, 3
    s_lshl_b32 s76, s76, 2
    s_add_u32 s76, s76, s4
    s_mul_i32 s76, s76, 3
    v_min_u32 v2, 2, v1
    v_add_u32 v2, s76, v2
    v_lshlrev_b32 v2, 7, v2
    v_min_u32 v2, L_end-concat_heads__linear_kernel_hedgehog__softmax_full_mha__prompt_kernel, v2
    global_load_dword v39, v2, s[74:75]
    s_lshr_b32 s74, s2, 3
    s_lshl_b32 s75, s74, 2
    s_add_u32 s75, s75, s4
    s_mul_i32 s76, s75, 12
    s_bfe_u32 s77, s2, 0x20001
    s_mul_i32 s74, s77, 1536
    s_add_u32 s76, s76, s74
    v_min_u32 v2, 11, v1
    v_add_u32 v2, s76, v2
    v_lshrrev_b32 v14, 2, v2
    v_and_b32 v2, 3, v2
    v_lshlrev_b32 v2, 7, v2
    v_lshl_add_u32 v35, v14, 10, v2
    s_and_b32 s76, s2, 1
    s_lshl_b32 s74, s76, 9
    v_add_u32 v35, s74, v35
    s_mul_i32 s75, s75, 2048
    s_lshl_b32 s77, s77, 19
    s_add_u32 s75, s75, s77
    s_lshl_b32 s76, s76, 18
    s_add_u32 s75, s75, s76
    v_min_u32 v2, 15, v1
    v_lshl_add_u32 v34, v2, 7, s75
    s_mov_b32 s10, 2097152
    s_mov_b32 s11, 0x00020000
    s_mov_b32 s14, 1572864
    s_mov_b32 s15, 0x00020000
    s_waitcnt lgkmcnt(0)
    buffer_load_dword v36, v35, s[12:15], 0 offen
    buffer_load_dword v37, v34, s[8:11], 0 offen
    s_lshl_b32 s7, s6, 2
    s_add_u32 s7, s7, s4
    v_lshlrev_b32 v0, 4, v1
    v_mov_b32 v254, 163584
    v_mov_b32 v253, 1
    s_mul_i32 s70, s6, 2
    s_mul_i32 s74, s5, 1
    s_add_u32 s70, s70, s74
    s_lshr_b32 s74, s6, 2
    s_mul_i32 s74, s74, 1
    s_add_u32 s70, s70, s74
    s_lshl_b32 s60, s4, 11
    v_lshrrev_b32 v14, 3, v1
    v_and_b32 v15, 7, v1
    s_lshl_b32 s74, s5, 6
    s_lshl_b32 s75, s4, 4
    s_add_u32 s74, s74, s75
    v_add_u32 v2, s74, v14
    v_lshlrev_b32 v2, 10, v2
    v_lshrrev_b32 v3, 1, v14
    v_xor_b32 v3, v3, v15
    v_lshl_add_u32 v3, v3, 4, v2
    v_add_u32 v4, 0x2000, v3
    v_xor_b32 v4, 64, v4
    v_add_u32 v2, s75, v14
    v_mul_u32_u24 v2, 0xc00, v2
    s_lshl_b32 s76, s6, 7
    v_add_u32 v2, s76, v2
    v_bfe_u32 v14, v1, 4, 1
    v_lshlrev_b32 v5, 1, v14
    v_xor_b32 v5, v5, v15
    v_xor_b32 v6, 4, v5
    v_lshl_add_u32 v5, v5, 4, v2
    v_lshl_add_u32 v6, v6, 4, v2
    s_mov_b32 s16, s40
    s_mov_b32 s17, s41
    s_mov_b32 s18, 2097152
    s_mov_b32 s19, 0x00020000
    s_mov_b32 s20, s42
    s_mov_b32 s21, s43
    s_mov_b32 s22, 1572864
    s_mov_b32 s23, 0x00020000
    s_mov_b32 s24, s58
    s_mov_b32 s25, s59
    s_mov_b32 s26, 16777216
    s_mov_b32 s27, 0x00020000
    s_mov_b32 s28, s54
    s_mov_b32 s29, s55
    s_mov_b32 s30, 4194304
    s_mov_b32 s31, 0x00020000
    s_mov_b32 s36, s56
    s_mov_b32 s37, s57
    s_mov_b32 s38, 256
    s_mov_b32 s39, 0x00020000
    s_bitcmp1_b32 s2, 0
    s_cbranch_scc1 L_noss_3
    s_lshr_b32 s74, s2, 3
    s_lshl_b32 s74, s74, 2
    s_add_u32 s74, s74, s4
    s_mul_i32 s74, s74, 12288
    s_add_u32 s74, s74, 384
    s_add_u32 s84, s50, s74
    s_addc_u32 s85, s51, 0
    s_add_u32 s86, s42, s74
    s_addc_u32 s87, s43, 0
    s_load_dword s88, s[84:85], 0
    s_load_dword s89, s[84:85], 64
    s_load_dword s88, s[84:85], 1024
    s_load_dword s89, s[84:85], 1088
    s_load_dword s88, s[84:85], 2048
    s_load_dword s89, s[84:85], 2112
    s_load_dword s88, s[84:85], 3072
    s_load_dword s89, s[84:85], 3136
    s_load_dword s88, s[84:85], 4096
    s_load_dword s89, s[84:85], 4160
    s_load_dword s88, s[84:85], 5120
    s_load_dword s89, s[84:85], 5184
    s_load_dword s88, s[84:85], 6144
    s_load_dword s89, s[84:85], 6208
    s_load_dword s88, s[84:85], 7168
    s_load_dword s89, s[84:85], 7232
    s_load_dword s88, s[84:85], 8192
    s_load_dword s89, s[84:85], 8256
    s_load_dword s88, s[84:85], 9216
    s_load_dword s89, s[84:85], 9280
    s_load_dword s88, s[84:85], 10240
    s_load_dword s89, s[84:85], 10304
    s_load_dword s88, s[84:85], 11264
    s_load_dword s89, s[84:85], 11328
L_noss_3:
    v_and_b32 v2, 15, v1
    v_lshrrev_b32 v14, 4, v1
    v_lshrrev_b32 v15, 1, v2
    v_xor_b32 v15, v15, v14
    v_lshlrev_b32 v15, 4, v15
    v_lshl_add_u32 v8, v2, 7, v15
    v_xor_b32 v9, 64, v8
    v_bfe_u32 v2, v1, 2, 2
    v_lshl_add_u32 v2, v14, 3, v2
    v_lshlrev_b32 v2, 7, v2
    v_and_b32 v15, 3, v1
    v_lshl_add_u32 v2, v15, 3, v2
    v_bfe_u32 v14, v1, 3, 2
    v_xor_b32 v14, s4, v14
    v_lshl_add_u32 v12, v14, 5, v2
    v_add_u32 v12, 0x2000, v12
    s_cmp_lt_u32 s2, 8
    s_cselect_b32 s73, s3, 0
    s_cmp_lg_u32 s73, 1
    s_cbranch_scc1 L_noreset
    v_mov_b32 v16, 0
    v_mov_b32 v17, 0
    v_mov_b32 v18, 0
    v_mov_b32 v19, 0
    s_mul_i32 s75, s2, 7168
    s_add_u32 s75, s75, 11599872
    buffer_store_dwordx4 v[16:19], v0, s[24:27], s75 offen offset:0 sc1
    buffer_store_dwordx4 v[16:19], v0, s[24:27], s75 offen offset:1024 sc1
    buffer_store_dwordx4 v[16:19], v0, s[24:27], s75 offen offset:2048 sc1
    buffer_store_dwordx4 v[16:19], v0, s[24:27], s75 offen offset:3072 sc1
    s_add_u32 s75, s75, 4096
    buffer_store_dwordx4 v[16:19], v0, s[24:27], s75 offen offset:0 sc1
    buffer_store_dwordx4 v[16:19], v0, s[24:27], s75 offen offset:1024 sc1
    buffer_store_dwordx4 v[16:19], v0, s[24:27], s75 offen offset:2048 sc1
L_noreset:
    v_lshl_add_u32 v2, v1, 2, v254
    v_mov_b32 v14, 0
    ds_write_b32 v2, v14
    v_and_b32 v28, 0x23, v1
    v_bfe_u32 v2, v1, 2, 2
    v_lshl_or_b32 v28, v2, 3, v28
    v_bfe_u32 v2, v1, 4, 1
    v_lshl_or_b32 v28, v2, 2, v28
    v_lshlrev_b32 v28, 4, v28
    s_waitcnt lgkmcnt(0)
    s_barrier
    ds_read_b64_tr_b16 v[124:125], v12 offset:8192
    ds_read_b64_tr_b16 v[126:127], v12 offset:8704
    ds_read_b128 v[104:107], v8 offset:0
    ds_read_b128 v[108:111], v8 offset:2048
    ds_read_b64_tr_b16 v[120:121], v12 offset:0
    ds_read_b64_tr_b16 v[122:123], v12 offset:512
    ds_read_b128 v[112:115], v8 offset:4096
    ds_read_b128 v[116:119], v8 offset:6144
    ds_read_b64_tr_b16 v[128:129], v12 offset:16384
    ds_read_b64_tr_b16 v[130:131], v12 offset:16896
    s_waitcnt lgkmcnt(6)
    v_mfma_f32_16x16x32_bf16 v[200:203], v[124:127], v[104:107], 0
    v_mfma_f32_16x16x32_bf16 v[204:207], v[124:127], v[108:111], 0
    ds_read_b64_tr_b16 v[152:153], v12 offset:12288
    ds_read_b64_tr_b16 v[154:155], v12 offset:12800
    ds_read_b128 v[132:135], v9 offset:0
    ds_read_b128 v[136:139], v9 offset:2048
    s_waitcnt lgkmcnt(6)
    v_mfma_f32_16x16x32_bf16 v[184:187], v[120:123], v[104:107], 0
    v_mfma_f32_16x16x32_bf16 v[188:191], v[120:123], v[108:111], 0
    v_mfma_f32_16x16x32_bf16 v[208:211], v[124:127], v[112:115], 0
    v_mfma_f32_16x16x32_bf16 v[212:215], v[124:127], v[116:119], 0
    ds_read_b64_tr_b16 v[148:149], v12 offset:4096
    ds_read_b64_tr_b16 v[150:151], v12 offset:4608
    ds_read_b128 v[140:143], v9 offset:4096
    ds_read_b128 v[144:147], v9 offset:6144
    v_mfma_f32_16x16x32_bf16 v[192:195], v[120:123], v[112:115], 0
    v_mfma_f32_16x16x32_bf16 v[196:199], v[120:123], v[116:119], 0
    s_waitcnt lgkmcnt(8)
    v_mfma_f32_16x16x32_bf16 v[216:219], v[104:107], v[128:131], 0
    v_mfma_f32_16x16x32_bf16 v[220:223], v[108:111], v[128:131], 0
    ds_read_b64_tr_b16 v[156:157], v12 offset:20480
    ds_read_b64_tr_b16 v[158:159], v12 offset:20992
    v_mfma_f32_16x16x32_bf16 v[224:227], v[112:115], v[128:131], 0
    v_mfma_f32_16x16x32_bf16 v[228:231], v[116:119], v[128:131], 0
    s_waitcnt lgkmcnt(0)
    s_barrier
    ds_read_b64_tr_b16 v[124:125], v12 offset:40960
    ds_read_b64_tr_b16 v[126:127], v12 offset:41472
    ds_read_b128 v[104:107], v8 offset:32768
    ds_read_b128 v[108:111], v8 offset:34816
    v_mfma_f32_16x16x32_bf16 v[200:203], v[152:155], v[132:135], v[200:203]
    v_mfma_f32_16x16x32_bf16 v[204:207], v[152:155], v[136:139], v[204:207]
    v_mfma_f32_16x16x32_bf16 v[184:187], v[148:151], v[132:135], v[184:187]
    ds_read_b64_tr_b16 v[120:121], v12 offset:32768
    ds_read_b64_tr_b16 v[122:123], v12 offset:33280
    ds_read_b128 v[112:115], v8 offset:36864
    ds_read_b128 v[116:119], v8 offset:38912
    v_mfma_f32_16x16x32_bf16 v[188:191], v[148:151], v[136:139], v[188:191]
    v_mfma_f32_16x16x32_bf16 v[208:211], v[152:155], v[140:143], v[208:211]
    v_mfma_f32_16x16x32_bf16 v[212:215], v[152:155], v[144:147], v[212:215]
    ds_read_b64_tr_b16 v[128:129], v12 offset:49152
    ds_read_b64_tr_b16 v[130:131], v12 offset:49664
    v_mfma_f32_16x16x32_bf16 v[192:195], v[148:151], v[140:143], v[192:195]
    v_mfma_f32_16x16x32_bf16 v[196:199], v[148:151], v[144:147], v[196:199]
    v_mfma_f32_16x16x32_bf16 v[216:219], v[132:135], v[156:159], v[216:219]
    v_mfma_f32_16x16x32_bf16 v[220:223], v[136:139], v[156:159], v[220:223]
    v_mfma_f32_16x16x32_bf16 v[224:227], v[140:143], v[156:159], v[224:227]
    v_mfma_f32_16x16x32_bf16 v[228:231], v[144:147], v[156:159], v[228:231]
    s_waitcnt lgkmcnt(6)
    v_mfma_f32_16x16x32_bf16 v[200:203], v[124:127], v[104:107], v[200:203]
    v_mfma_f32_16x16x32_bf16 v[204:207], v[124:127], v[108:111], v[204:207]
    ds_read_b64_tr_b16 v[152:153], v12 offset:45056
    ds_read_b64_tr_b16 v[154:155], v12 offset:45568
    ds_read_b128 v[132:135], v9 offset:32768
    ds_read_b128 v[136:139], v9 offset:34816
    s_waitcnt lgkmcnt(6)
    v_mfma_f32_16x16x32_bf16 v[184:187], v[120:123], v[104:107], v[184:187]
    v_mfma_f32_16x16x32_bf16 v[188:191], v[120:123], v[108:111], v[188:191]
    v_mfma_f32_16x16x32_bf16 v[208:211], v[124:127], v[112:115], v[208:211]
    v_mfma_f32_16x16x32_bf16 v[212:215], v[124:127], v[116:119], v[212:215]
    ds_read_b64_tr_b16 v[148:149], v12 offset:36864
    ds_read_b64_tr_b16 v[150:151], v12 offset:37376
    ds_read_b128 v[140:143], v9 offset:36864
    ds_read_b128 v[144:147], v9 offset:38912
    v_mfma_f32_16x16x32_bf16 v[192:195], v[120:123], v[112:115], v[192:195]
    v_mfma_f32_16x16x32_bf16 v[196:199], v[120:123], v[116:119], v[196:199]
    s_waitcnt lgkmcnt(8)
    v_mfma_f32_16x16x32_bf16 v[216:219], v[104:107], v[128:131], v[216:219]
    v_mfma_f32_16x16x32_bf16 v[220:223], v[108:111], v[128:131], v[220:223]
    ds_read_b64_tr_b16 v[156:157], v12 offset:53248
    ds_read_b64_tr_b16 v[158:159], v12 offset:53760
    v_mfma_f32_16x16x32_bf16 v[224:227], v[112:115], v[128:131], v[224:227]
    v_mfma_f32_16x16x32_bf16 v[228:231], v[116:119], v[128:131], v[228:231]
    s_waitcnt lgkmcnt(0)
    s_barrier
    v_xor_b32 v12, 0x10000, v12
    v_xor_b32 v8, 0x10000, v8
    v_xor_b32 v9, 0x10000, v9
    ds_read_b64_tr_b16 v[124:125], v12 offset:8192
    ds_read_b64_tr_b16 v[126:127], v12 offset:8704
    ds_read_b128 v[104:107], v8 offset:0
    ds_read_b128 v[108:111], v8 offset:2048
    v_mfma_f32_16x16x32_bf16 v[200:203], v[152:155], v[132:135], v[200:203]
    v_mfma_f32_16x16x32_bf16 v[204:207], v[152:155], v[136:139], v[204:207]
    v_mfma_f32_16x16x32_bf16 v[184:187], v[148:151], v[132:135], v[184:187]
    ds_read_b64_tr_b16 v[120:121], v12 offset:0
    ds_read_b64_tr_b16 v[122:123], v12 offset:512
    ds_read_b128 v[112:115], v8 offset:4096
    ds_read_b128 v[116:119], v8 offset:6144
    v_mfma_f32_16x16x32_bf16 v[188:191], v[148:151], v[136:139], v[188:191]
    v_mfma_f32_16x16x32_bf16 v[208:211], v[152:155], v[140:143], v[208:211]
    v_mfma_f32_16x16x32_bf16 v[212:215], v[152:155], v[144:147], v[212:215]
    ds_read_b64_tr_b16 v[128:129], v12 offset:16384
    ds_read_b64_tr_b16 v[130:131], v12 offset:16896
    v_mfma_f32_16x16x32_bf16 v[192:195], v[148:151], v[140:143], v[192:195]
    v_mfma_f32_16x16x32_bf16 v[196:199], v[148:151], v[144:147], v[196:199]
    v_mfma_f32_16x16x32_bf16 v[216:219], v[132:135], v[156:159], v[216:219]
    v_mfma_f32_16x16x32_bf16 v[220:223], v[136:139], v[156:159], v[220:223]
    v_mfma_f32_16x16x32_bf16 v[224:227], v[140:143], v[156:159], v[224:227]
    v_mfma_f32_16x16x32_bf16 v[228:231], v[144:147], v[156:159], v[228:231]
    s_waitcnt lgkmcnt(6)
    v_mfma_f32_16x16x32_bf16 v[200:203], v[124:127], v[104:107], v[200:203]
    v_mfma_f32_16x16x32_bf16 v[204:207], v[124:127], v[108:111], v[204:207]
    ds_read_b64_tr_b16 v[152:153], v12 offset:12288
    ds_read_b64_tr_b16 v[154:155], v12 offset:12800
    ds_read_b128 v[132:135], v9 offset:0
    ds_read_b128 v[136:139], v9 offset:2048
    s_waitcnt lgkmcnt(6)
    v_mfma_f32_16x16x32_bf16 v[184:187], v[120:123], v[104:107], v[184:187]
    v_mfma_f32_16x16x32_bf16 v[188:191], v[120:123], v[108:111], v[188:191]
    v_mfma_f32_16x16x32_bf16 v[208:211], v[124:127], v[112:115], v[208:211]
    v_mfma_f32_16x16x32_bf16 v[212:215], v[124:127], v[116:119], v[212:215]
    ds_read_b64_tr_b16 v[148:149], v12 offset:4096
    ds_read_b64_tr_b16 v[150:151], v12 offset:4608
    ds_read_b128 v[140:143], v9 offset:4096
    ds_read_b128 v[144:147], v9 offset:6144
    v_mfma_f32_16x16x32_bf16 v[192:195], v[120:123], v[112:115], v[192:195]
    v_mfma_f32_16x16x32_bf16 v[196:199], v[120:123], v[116:119], v[196:199]
    s_waitcnt lgkmcnt(8)
    v_mfma_f32_16x16x32_bf16 v[216:219], v[104:107], v[128:131], v[216:219]
    v_mfma_f32_16x16x32_bf16 v[220:223], v[108:111], v[128:131], v[220:223]
    ds_read_b64_tr_b16 v[156:157], v12 offset:20480
    ds_read_b64_tr_b16 v[158:159], v12 offset:20992
    v_mfma_f32_16x16x32_bf16 v[224:227], v[112:115], v[128:131], v[224:227]
    v_mfma_f32_16x16x32_bf16 v[228:231], v[116:119], v[128:131], v[228:231]
    s_waitcnt lgkmcnt(0)
    s_barrier
    ds_read_b64_tr_b16 v[124:125], v12 offset:40960
    ds_read_b64_tr_b16 v[126:127], v12 offset:41472
    ds_read_b128 v[104:107], v8 offset:32768
    ds_read_b128 v[108:111], v8 offset:34816
    v_mfma_f32_16x16x32_bf16 v[200:203], v[152:155], v[132:135], v[200:203]
    v_mfma_f32_16x16x32_bf16 v[204:207], v[152:155], v[136:139], v[204:207]
    v_mfma_f32_16x16x32_bf16 v[184:187], v[148:151], v[132:135], v[184:187]
    ds_read_b64_tr_b16 v[120:121], v12 offset:32768
    ds_read_b64_tr_b16 v[122:123], v12 offset:33280
    ds_read_b128 v[112:115], v8 offset:36864
    ds_read_b128 v[116:119], v8 offset:38912
    v_mfma_f32_16x16x32_bf16 v[188:191], v[148:151], v[136:139], v[188:191]
    v_mfma_f32_16x16x32_bf16 v[208:211], v[152:155], v[140:143], v[208:211]
    v_mfma_f32_16x16x32_bf16 v[212:215], v[152:155], v[144:147], v[212:215]
    ds_read_b64_tr_b16 v[128:129], v12 offset:49152
    ds_read_b64_tr_b16 v[130:131], v12 offset:49664
    v_mfma_f32_16x16x32_bf16 v[192:195], v[148:151], v[140:143], v[192:195]
    v_mfma_f32_16x16x32_bf16 v[196:199], v[148:151], v[144:147], v[196:199]
    v_mfma_f32_16x16x32_bf16 v[216:219], v[132:135], v[156:159], v[216:219]
    v_mfma_f32_16x16x32_bf16 v[220:223], v[136:139], v[156:159], v[220:223]
    v_mfma_f32_16x16x32_bf16 v[224:227], v[140:143], v[156:159], v[224:227]
    v_mfma_f32_16x16x32_bf16 v[228:231], v[144:147], v[156:159], v[228:231]
    s_waitcnt lgkmcnt(6)
    v_mfma_f32_16x16x32_bf16 v[200:203], v[124:127], v[104:107], v[200:203]
    v_mfma_f32_16x16x32_bf16 v[204:207], v[124:127], v[108:111], v[204:207]
    ds_read_b64_tr_b16 v[152:153], v12 offset:45056
    ds_read_b64_tr_b16 v[154:155], v12 offset:45568
    ds_read_b128 v[132:135], v9 offset:32768
    ds_read_b128 v[136:139], v9 offset:34816
    s_waitcnt lgkmcnt(6)
    v_mfma_f32_16x16x32_bf16 v[184:187], v[120:123], v[104:107], v[184:187]
    v_mfma_f32_16x16x32_bf16 v[188:191], v[120:123], v[108:111], v[188:191]
    v_mfma_f32_16x16x32_bf16 v[208:211], v[124:127], v[112:115], v[208:211]
    v_mfma_f32_16x16x32_bf16 v[212:215], v[124:127], v[116:119], v[212:215]
    ds_read_b64_tr_b16 v[148:149], v12 offset:36864
    ds_read_b64_tr_b16 v[150:151], v12 offset:37376
    ds_read_b128 v[140:143], v9 offset:36864
    ds_read_b128 v[144:147], v9 offset:38912
    v_mfma_f32_16x16x32_bf16 v[192:195], v[120:123], v[112:115], v[192:195]
    v_mfma_f32_16x16x32_bf16 v[196:199], v[120:123], v[116:119], v[196:199]
    s_waitcnt lgkmcnt(8)
    v_mfma_f32_16x16x32_bf16 v[216:219], v[104:107], v[128:131], v[216:219]
    v_mfma_f32_16x16x32_bf16 v[220:223], v[108:111], v[128:131], v[220:223]
    ds_read_b64_tr_b16 v[156:157], v12 offset:53248
    ds_read_b64_tr_b16 v[158:159], v12 offset:53760
    v_mfma_f32_16x16x32_bf16 v[224:227], v[112:115], v[128:131], v[224:227]
    v_mfma_f32_16x16x32_bf16 v[228:231], v[116:119], v[128:131], v[228:231]
    s_waitcnt lgkmcnt(0)
    s_barrier
    v_xor_b32 v12, 0x10000, v12
    v_xor_b32 v8, 0x10000, v8
    v_xor_b32 v9, 0x10000, v9
    ds_read_b64_tr_b16 v[124:125], v12 offset:8192
    ds_read_b64_tr_b16 v[126:127], v12 offset:8704
    ds_read_b128 v[104:107], v8 offset:0
    ds_read_b128 v[108:111], v8 offset:2048
    v_mfma_f32_16x16x32_bf16 v[200:203], v[152:155], v[132:135], v[200:203]
    v_mfma_f32_16x16x32_bf16 v[204:207], v[152:155], v[136:139], v[204:207]
    v_mfma_f32_16x16x32_bf16 v[184:187], v[148:151], v[132:135], v[184:187]
    ds_read_b64_tr_b16 v[120:121], v12 offset:0
    ds_read_b64_tr_b16 v[122:123], v12 offset:512
    ds_read_b128 v[112:115], v8 offset:4096
    ds_read_b128 v[116:119], v8 offset:6144
    v_mfma_f32_16x16x32_bf16 v[188:191], v[148:151], v[136:139], v[188:191]
    v_mfma_f32_16x16x32_bf16 v[208:211], v[152:155], v[140:143], v[208:211]
    v_mfma_f32_16x16x32_bf16 v[212:215], v[152:155], v[144:147], v[212:215]
    ds_read_b64_tr_b16 v[128:129], v12 offset:16384
    ds_read_b64_tr_b16 v[130:131], v12 offset:16896
    v_mfma_f32_16x16x32_bf16 v[192:195], v[148:151], v[140:143], v[192:195]
    v_mfma_f32_16x16x32_bf16 v[196:199], v[148:151], v[144:147], v[196:199]
    v_mfma_f32_16x16x32_bf16 v[216:219], v[132:135], v[156:159], v[216:219]
    v_mfma_f32_16x16x32_bf16 v[220:223], v[136:139], v[156:159], v[220:223]
    v_mfma_f32_16x16x32_bf16 v[224:227], v[140:143], v[156:159], v[224:227]
    v_mfma_f32_16x16x32_bf16 v[228:231], v[144:147], v[156:159], v[228:231]
    s_waitcnt lgkmcnt(6)
    v_mfma_f32_16x16x32_bf16 v[200:203], v[124:127], v[104:107], v[200:203]
    v_mfma_f32_16x16x32_bf16 v[204:207], v[124:127], v[108:111], v[204:207]
    ds_read_b64_tr_b16 v[152:153], v12 offset:12288
    ds_read_b64_tr_b16 v[154:155], v12 offset:12800
    ds_read_b128 v[132:135], v9 offset:0
    ds_read_b128 v[136:139], v9 offset:2048
    s_waitcnt lgkmcnt(6)
    v_mfma_f32_16x16x32_bf16 v[184:187], v[120:123], v[104:107], v[184:187]
    v_mfma_f32_16x16x32_bf16 v[188:191], v[120:123], v[108:111], v[188:191]
    v_mfma_f32_16x16x32_bf16 v[208:211], v[124:127], v[112:115], v[208:211]
    v_mfma_f32_16x16x32_bf16 v[212:215], v[124:127], v[116:119], v[212:215]
    ds_read_b64_tr_b16 v[148:149], v12 offset:4096
    ds_read_b64_tr_b16 v[150:151], v12 offset:4608
    ds_read_b128 v[140:143], v9 offset:4096
    ds_read_b128 v[144:147], v9 offset:6144
    v_mfma_f32_16x16x32_bf16 v[192:195], v[120:123], v[112:115], v[192:195]
    v_mfma_f32_16x16x32_bf16 v[196:199], v[120:123], v[116:119], v[196:199]
    s_waitcnt lgkmcnt(8)
    v_mfma_f32_16x16x32_bf16 v[216:219], v[104:107], v[128:131], v[216:219]
    v_mfma_f32_16x16x32_bf16 v[220:223], v[108:111], v[128:131], v[220:223]
    ds_read_b64_tr_b16 v[156:157], v12 offset:20480
    ds_read_b64_tr_b16 v[158:159], v12 offset:20992
    v_mfma_f32_16x16x32_bf16 v[224:227], v[112:115], v[128:131], v[224:227]
    v_mfma_f32_16x16x32_bf16 v[228:231], v[116:119], v[128:131], v[228:231]
    s_waitcnt lgkmcnt(0)
    s_barrier
    s_cmp_lg_u32 s73, 1
    s_cbranch_scc1 L_nogate_4
    s_lshl_b32 s74, s2, 2
    v_mov_b32 v2, s74
    s_waitcnt vmcnt(0)
    v_mov_b32 v15, 1
    s_mov_b32 exec_lo, 1
    s_mov_b32 exec_hi, 0
    buffer_store_dword v15, v2, s[36:39], 0 offen sc1
    s_mov_b64 exec, -1
L_nogate_4:
    ds_read_b64_tr_b16 v[124:125], v12 offset:40960
    ds_read_b64_tr_b16 v[126:127], v12 offset:41472
    ds_read_b128 v[104:107], v8 offset:32768
    ds_read_b128 v[108:111], v8 offset:34816
    v_mfma_f32_16x16x32_bf16 v[200:203], v[152:155], v[132:135], v[200:203]
    v_mfma_f32_16x16x32_bf16 v[204:207], v[152:155], v[136:139], v[204:207]
    v_mfma_f32_16x16x32_bf16 v[184:187], v[148:151], v[132:135], v[184:187]
    ds_read_b64_tr_b16 v[120:121], v12 offset:32768
    ds_read_b64_tr_b16 v[122:123], v12 offset:33280
    ds_read_b128 v[112:115], v8 offset:36864
    ds_read_b128 v[116:119], v8 offset:38912
    v_mfma_f32_16x16x32_bf16 v[188:191], v[148:151], v[136:139], v[188:191]
    v_mfma_f32_16x16x32_bf16 v[208:211], v[152:155], v[140:143], v[208:211]
    v_mfma_f32_16x16x32_bf16 v[212:215], v[152:155], v[144:147], v[212:215]
    ds_read_b64_tr_b16 v[128:129], v12 offset:49152
    ds_read_b64_tr_b16 v[130:131], v12 offset:49664
    v_mfma_f32_16x16x32_bf16 v[192:195], v[148:151], v[140:143], v[192:195]
    v_mfma_f32_16x16x32_bf16 v[196:199], v[148:151], v[144:147], v[196:199]
    v_mfma_f32_16x16x32_bf16 v[216:219], v[132:135], v[156:159], v[216:219]
    v_mfma_f32_16x16x32_bf16 v[220:223], v[136:139], v[156:159], v[220:223]
    v_mfma_f32_16x16x32_bf16 v[224:227], v[140:143], v[156:159], v[224:227]
    v_mfma_f32_16x16x32_bf16 v[228:231], v[144:147], v[156:159], v[228:231]
    s_waitcnt lgkmcnt(6)
    v_mfma_f32_16x16x32_bf16 v[200:203], v[124:127], v[104:107], v[200:203]
    v_mfma_f32_16x16x32_bf16 v[204:207], v[124:127], v[108:111], v[204:207]
    ds_read_b64_tr_b16 v[152:153], v12 offset:45056
    ds_read_b64_tr_b16 v[154:155], v12 offset:45568
    ds_read_b128 v[132:135], v9 offset:32768
    ds_read_b128 v[136:139], v9 offset:34816
    s_waitcnt lgkmcnt(6)
    v_mfma_f32_16x16x32_bf16 v[184:187], v[120:123], v[104:107], v[184:187]
    v_mfma_f32_16x16x32_bf16 v[188:191], v[120:123], v[108:111], v[188:191]
    v_mfma_f32_16x16x32_bf16 v[208:211], v[124:127], v[112:115], v[208:211]
    v_mfma_f32_16x16x32_bf16 v[212:215], v[124:127], v[116:119], v[212:215]
    ds_read_b64_tr_b16 v[148:149], v12 offset:36864
    ds_read_b64_tr_b16 v[150:151], v12 offset:37376
    ds_read_b128 v[140:143], v9 offset:36864
    ds_read_b128 v[144:147], v9 offset:38912
    v_mfma_f32_16x16x32_bf16 v[192:195], v[120:123], v[112:115], v[192:195]
    v_mfma_f32_16x16x32_bf16 v[196:199], v[120:123], v[116:119], v[196:199]
    s_waitcnt lgkmcnt(8)
    v_mfma_f32_16x16x32_bf16 v[216:219], v[104:107], v[128:131], v[216:219]
    v_mfma_f32_16x16x32_bf16 v[220:223], v[108:111], v[128:131], v[220:223]
    ds_read_b64_tr_b16 v[156:157], v12 offset:53248
    ds_read_b64_tr_b16 v[158:159], v12 offset:53760
    v_mfma_f32_16x16x32_bf16 v[224:227], v[112:115], v[128:131], v[224:227]
    v_mfma_f32_16x16x32_bf16 v[228:231], v[116:119], v[128:131], v[228:231]
    s_waitcnt lgkmcnt(0)
    s_barrier
    v_xor_b32 v12, 0x10000, v12
    v_xor_b32 v8, 0x10000, v8
    v_xor_b32 v9, 0x10000, v9
    ds_read_b64_tr_b16 v[124:125], v12 offset:8192
    ds_read_b64_tr_b16 v[126:127], v12 offset:8704
    ds_read_b128 v[104:107], v8 offset:0
    ds_read_b128 v[108:111], v8 offset:2048
    v_mfma_f32_16x16x32_bf16 v[200:203], v[152:155], v[132:135], v[200:203]
    v_mfma_f32_16x16x32_bf16 v[204:207], v[152:155], v[136:139], v[204:207]
    v_mfma_f32_16x16x32_bf16 v[184:187], v[148:151], v[132:135], v[184:187]
    ds_read_b64_tr_b16 v[120:121], v12 offset:0
    ds_read_b64_tr_b16 v[122:123], v12 offset:512
    ds_read_b128 v[112:115], v8 offset:4096
    ds_read_b128 v[116:119], v8 offset:6144
    v_mfma_f32_16x16x32_bf16 v[188:191], v[148:151], v[136:139], v[188:191]
    v_mfma_f32_16x16x32_bf16 v[208:211], v[152:155], v[140:143], v[208:211]
    v_mfma_f32_16x16x32_bf16 v[212:215], v[152:155], v[144:147], v[212:215]
    ds_read_b64_tr_b16 v[128:129], v12 offset:16384
    ds_read_b64_tr_b16 v[130:131], v12 offset:16896
    v_mfma_f32_16x16x32_bf16 v[192:195], v[148:151], v[140:143], v[192:195]
    v_mfma_f32_16x16x32_bf16 v[196:199], v[148:151], v[144:147], v[196:199]
    v_mfma_f32_16x16x32_bf16 v[216:219], v[132:135], v[156:159], v[216:219]
    v_mfma_f32_16x16x32_bf16 v[220:223], v[136:139], v[156:159], v[220:223]
    v_mfma_f32_16x16x32_bf16 v[224:227], v[140:143], v[156:159], v[224:227]
    v_mfma_f32_16x16x32_bf16 v[228:231], v[144:147], v[156:159], v[228:231]
    s_waitcnt lgkmcnt(6)
    v_mfma_f32_16x16x32_bf16 v[200:203], v[124:127], v[104:107], v[200:203]
    v_mfma_f32_16x16x32_bf16 v[204:207], v[124:127], v[108:111], v[204:207]
    ds_read_b64_tr_b16 v[152:153], v12 offset:12288
    ds_read_b64_tr_b16 v[154:155], v12 offset:12800
    ds_read_b128 v[132:135], v9 offset:0
    ds_read_b128 v[136:139], v9 offset:2048
    s_waitcnt lgkmcnt(6)
    v_mfma_f32_16x16x32_bf16 v[184:187], v[120:123], v[104:107], v[184:187]
    v_mfma_f32_16x16x32_bf16 v[188:191], v[120:123], v[108:111], v[188:191]
    v_mfma_f32_16x16x32_bf16 v[208:211], v[124:127], v[112:115], v[208:211]
    v_mfma_f32_16x16x32_bf16 v[212:215], v[124:127], v[116:119], v[212:215]
    ds_read_b64_tr_b16 v[148:149], v12 offset:4096
    ds_read_b64_tr_b16 v[150:151], v12 offset:4608
    ds_read_b128 v[140:143], v9 offset:4096
    ds_read_b128 v[144:147], v9 offset:6144
    v_mfma_f32_16x16x32_bf16 v[192:195], v[120:123], v[112:115], v[192:195]
    v_mfma_f32_16x16x32_bf16 v[196:199], v[120:123], v[116:119], v[196:199]
    s_waitcnt lgkmcnt(8)
    v_mfma_f32_16x16x32_bf16 v[216:219], v[104:107], v[128:131], v[216:219]
    v_mfma_f32_16x16x32_bf16 v[220:223], v[108:111], v[128:131], v[220:223]
    ds_read_b64_tr_b16 v[156:157], v12 offset:20480
    ds_read_b64_tr_b16 v[158:159], v12 offset:20992
    v_mfma_f32_16x16x32_bf16 v[224:227], v[112:115], v[128:131], v[224:227]
    v_mfma_f32_16x16x32_bf16 v[228:231], v[116:119], v[128:131], v[228:231]
    s_waitcnt lgkmcnt(0)
    s_barrier
    ds_read_b64_tr_b16 v[124:125], v12 offset:40960
    ds_read_b64_tr_b16 v[126:127], v12 offset:41472
    ds_read_b128 v[104:107], v8 offset:32768
    ds_read_b128 v[108:111], v8 offset:34816
    v_mfma_f32_16x16x32_bf16 v[200:203], v[152:155], v[132:135], v[200:203]
    v_mfma_f32_16x16x32_bf16 v[204:207], v[152:155], v[136:139], v[204:207]
    v_mfma_f32_16x16x32_bf16 v[184:187], v[148:151], v[132:135], v[184:187]
    ds_read_b64_tr_b16 v[120:121], v12 offset:32768
    ds_read_b64_tr_b16 v[122:123], v12 offset:33280
    ds_read_b128 v[112:115], v8 offset:36864
    ds_read_b128 v[116:119], v8 offset:38912
    v_mfma_f32_16x16x32_bf16 v[188:191], v[148:151], v[136:139], v[188:191]
    v_mfma_f32_16x16x32_bf16 v[208:211], v[152:155], v[140:143], v[208:211]
    v_mfma_f32_16x16x32_bf16 v[212:215], v[152:155], v[144:147], v[212:215]
    ds_read_b64_tr_b16 v[128:129], v12 offset:49152
    ds_read_b64_tr_b16 v[130:131], v12 offset:49664
    v_mfma_f32_16x16x32_bf16 v[192:195], v[148:151], v[140:143], v[192:195]
    v_mfma_f32_16x16x32_bf16 v[196:199], v[148:151], v[144:147], v[196:199]
    v_mfma_f32_16x16x32_bf16 v[216:219], v[132:135], v[156:159], v[216:219]
    v_mfma_f32_16x16x32_bf16 v[220:223], v[136:139], v[156:159], v[220:223]
    v_mfma_f32_16x16x32_bf16 v[224:227], v[140:143], v[156:159], v[224:227]
    v_mfma_f32_16x16x32_bf16 v[228:231], v[144:147], v[156:159], v[228:231]
    s_waitcnt lgkmcnt(6)
    v_mfma_f32_16x16x32_bf16 v[200:203], v[124:127], v[104:107], v[200:203]
    v_mfma_f32_16x16x32_bf16 v[204:207], v[124:127], v[108:111], v[204:207]
    ds_read_b64_tr_b16 v[152:153], v12 offset:45056
    ds_read_b64_tr_b16 v[154:155], v12 offset:45568
    ds_read_b128 v[132:135], v9 offset:32768
    ds_read_b128 v[136:139], v9 offset:34816
    s_waitcnt lgkmcnt(6)
    v_mfma_f32_16x16x32_bf16 v[184:187], v[120:123], v[104:107], v[184:187]
    v_mfma_f32_16x16x32_bf16 v[188:191], v[120:123], v[108:111], v[188:191]
    v_mfma_f32_16x16x32_bf16 v[208:211], v[124:127], v[112:115], v[208:211]
    v_mfma_f32_16x16x32_bf16 v[212:215], v[124:127], v[116:119], v[212:215]
    ds_read_b64_tr_b16 v[148:149], v12 offset:36864
    ds_read_b64_tr_b16 v[150:151], v12 offset:37376
    ds_read_b128 v[140:143], v9 offset:36864
    ds_read_b128 v[144:147], v9 offset:38912
    v_mfma_f32_16x16x32_bf16 v[192:195], v[120:123], v[112:115], v[192:195]
    v_mfma_f32_16x16x32_bf16 v[196:199], v[120:123], v[116:119], v[196:199]
    s_waitcnt lgkmcnt(8)
    v_mfma_f32_16x16x32_bf16 v[216:219], v[104:107], v[128:131], v[216:219]
    v_mfma_f32_16x16x32_bf16 v[220:223], v[108:111], v[128:131], v[220:223]
    ds_read_b64_tr_b16 v[156:157], v12 offset:53248
    ds_read_b64_tr_b16 v[158:159], v12 offset:53760
    v_mfma_f32_16x16x32_bf16 v[224:227], v[112:115], v[128:131], v[224:227]
    v_mfma_f32_16x16x32_bf16 v[228:231], v[116:119], v[128:131], v[228:231]
    s_waitcnt lgkmcnt(0)
    v_mfma_f32_16x16x32_bf16 v[200:203], v[152:155], v[132:135], v[200:203]
    v_mfma_f32_16x16x32_bf16 v[204:207], v[152:155], v[136:139], v[204:207]
    v_mfma_f32_16x16x32_bf16 v[184:187], v[148:151], v[132:135], v[184:187]
    v_mfma_f32_16x16x32_bf16 v[188:191], v[148:151], v[136:139], v[188:191]
    v_mfma_f32_16x16x32_bf16 v[208:211], v[152:155], v[140:143], v[208:211]
    v_mfma_f32_16x16x32_bf16 v[212:215], v[152:155], v[144:147], v[212:215]
    v_mfma_f32_16x16x32_bf16 v[192:195], v[148:151], v[140:143], v[192:195]
    v_mfma_f32_16x16x32_bf16 v[196:199], v[148:151], v[144:147], v[196:199]
    v_mfma_f32_16x16x32_bf16 v[216:219], v[132:135], v[156:159], v[216:219]
    v_mfma_f32_16x16x32_bf16 v[220:223], v[136:139], v[156:159], v[220:223]
    v_mfma_f32_16x16x32_bf16 v[224:227], v[140:143], v[156:159], v[224:227]
    v_mfma_f32_16x16x32_bf16 v[228:231], v[144:147], v[156:159], v[228:231]
    s_setprio 2
    v_lshlrev_b32 v31, 2, v1
    s_mov_b64 exec, 0xff
    buffer_load_dword v30, v31, s[36:39], 0 offen sc1
    s_mov_b64 exec, -1
    s_lshl_b32 s74, s5, 12
    s_lshl_b32 s75, s7, 17
    s_add_u32 s75, s75, s74
    v_cvt_pk_bf16_f32 v232, v200, v201
    v_cvt_pk_bf16_f32 v233, v202, v203
    v_cvt_pk_bf16_f32 v234, v204, v205
    v_cvt_pk_bf16_f32 v235, v206, v207
    v_cvt_pk_bf16_f32 v240, v216, v217
    v_cvt_pk_bf16_f32 v241, v218, v219
    v_cvt_pk_bf16_f32 v242, v220, v221
    v_cvt_pk_bf16_f32 v243, v222, v223
    v_permlane16_swap_b32 v232, v234
    v_permlane16_swap_b32 v233, v235
    buffer_store_dwordx4 v[240:243], v0, s[24:27], s75 offen offset:1024 sc1
    buffer_store_dwordx4 v[232:235], v28, s[24:27], s75 offen offset:0 sc1
    v_cvt_pk_bf16_f32 v236, v208, v209
    v_cvt_pk_bf16_f32 v237, v210, v211
    v_cvt_pk_bf16_f32 v238, v212, v213
    v_cvt_pk_bf16_f32 v239, v214, v215
    v_cvt_pk_bf16_f32 v244, v224, v225
    v_cvt_pk_bf16_f32 v245, v226, v227
    v_cvt_pk_bf16_f32 v246, v228, v229
    v_cvt_pk_bf16_f32 v247, v230, v231
    v_permlane16_swap_b32 v236, v238
    v_permlane16_swap_b32 v237, v239
    buffer_store_dwordx4 v[244:247], v0, s[24:27], s75 offen offset:3072 sc1
    buffer_store_dwordx4 v[236:239], v28, s[24:27], s75 offen offset:2048 sc1
    s_mov_b32 s64, 1052289595
    s_mov_b32 s65, 1052289595
    v_pk_mul_f32 v[184:185], v[184:185], s[64:65]
    v_pk_mul_f32 v[186:187], v[186:187], s[64:65]
    v_pk_mul_f32 v[188:189], v[188:189], s[64:65]
    v_pk_mul_f32 v[190:191], v[190:191], s[64:65]
    v_cvt_pk_bf16_f32 v16, v184, v185
    v_cvt_pk_bf16_f32 v17, v186, v187
    v_cvt_pk_bf16_f32 v18, v188, v189
    v_cvt_pk_bf16_f32 v19, v190, v191
    s_nop 0
    v_permlane16_swap_b32 v16, v18
    v_permlane16_swap_b32 v17, v19
    v_pk_mul_f32 v[192:193], v[192:193], s[64:65]
    v_pk_mul_f32 v[194:195], v[194:195], s[64:65]
    v_pk_mul_f32 v[196:197], v[196:197], s[64:65]
    v_pk_mul_f32 v[198:199], v[198:199], s[64:65]
    v_cvt_pk_bf16_f32 v20, v192, v193
    v_cvt_pk_bf16_f32 v21, v194, v195
    v_cvt_pk_bf16_f32 v22, v196, v197
    v_cvt_pk_bf16_f32 v23, v198, v199
    s_nop 0
    v_permlane16_swap_b32 v20, v22
    v_permlane16_swap_b32 v21, v23
    s_lshl_b32 s74, s4, 11
    s_add_u32 s74, s74, 131072
    v_add_u32 v2, s74, v0
    ds_write_b128 v2, v[16:19]
    ds_write_b128 v2, v[20:23] offset:1024
    v_mfma_f32_32x32x16_bf16 v[72:87], v[232:235], v[16:19], 0
    v_mfma_f32_32x32x16_bf16 v[88:103], v[236:239], v[16:19], 0
    v_mfma_f32_32x32x16_bf16 v[104:119], v[232:235], v[20:23], 0
    v_mfma_f32_32x32x16_bf16 v[120:135], v[236:239], v[20:23], 0
    s_nop 8
    v_max3_f32 v32, v72, v73, v74
    v_max3_f32 v32, v32, v75, v76
    v_max3_f32 v32, v32, v77, v78
    v_max3_f32 v32, v32, v79, v80
    v_max3_f32 v32, v32, v81, v82
    v_max3_f32 v32, v32, v83, v84
    v_max3_f32 v32, v32, v85, v86
    v_max3_f32 v32, v32, v87, v88
    v_max3_f32 v32, v32, v89, v90
    v_max3_f32 v32, v32, v91, v92
    v_max3_f32 v32, v32, v93, v94
    v_max3_f32 v32, v32, v95, v96
    v_max3_f32 v32, v32, v97, v98
    v_max3_f32 v32, v32, v99, v100
    v_max3_f32 v32, v32, v101, v102
    v_max_f32 v32, v32, v103
    v_max3_f32 v33, v104, v105, v106
    v_max3_f32 v33, v33, v107, v108
    v_max3_f32 v33, v33, v109, v110
    v_max3_f32 v33, v33, v111, v112
    v_max3_f32 v33, v33, v113, v114
    v_max3_f32 v33, v33, v115, v116
    v_max3_f32 v33, v33, v117, v118
    v_max3_f32 v33, v33, v119, v120
    v_max3_f32 v33, v33, v121, v122
    v_max3_f32 v33, v33, v123, v124
    v_max3_f32 v33, v33, v125, v126
    v_max3_f32 v33, v33, v127, v128
    v_max3_f32 v33, v33, v129, v130
    v_max3_f32 v33, v33, v131, v132
    v_max3_f32 v33, v33, v133, v134
    v_max_f32 v33, v33, v135
    s_nop 1
    v_permlane32_swap_b32 v32, v33
    v_max_f32 v32, v32, v33
    v_sub_f32 v32, 3267887104, v32
    v_mov_b32 v33, v32
    s_nop 1
    v_permlane32_swap_b32 v32, v33
    s_lshl_b32 s74, s4, 9
    s_add_u32 s74, s74, 139264
    v_lshl_add_u32 v2, v1, 3, s74
    ds_write_b64 v2, v[32:33]
    v_pk_mov_b32 v[40:41], v[32:33], v[32:33] op_sel:[0,0]
    v_pk_mov_b32 v[56:57], v[32:33], v[32:33] op_sel:[1,1]
    v_pk_mov_b32 v[42:43], v[32:33], v[32:33] op_sel:[0,0]
    v_pk_mov_b32 v[58:59], v[32:33], v[32:33] op_sel:[1,1]
    v_pk_mov_b32 v[44:45], v[32:33], v[32:33] op_sel:[0,0]
    v_pk_mov_b32 v[60:61], v[32:33], v[32:33] op_sel:[1,1]
    v_pk_mov_b32 v[46:47], v[32:33], v[32:33] op_sel:[0,0]
    v_pk_mov_b32 v[62:63], v[32:33], v[32:33] op_sel:[1,1]
    v_pk_mov_b32 v[48:49], v[32:33], v[32:33] op_sel:[0,0]
    v_pk_mov_b32 v[64:65], v[32:33], v[32:33] op_sel:[1,1]
    v_pk_mov_b32 v[50:51], v[32:33], v[32:33] op_sel:[0,0]
    v_pk_mov_b32 v[66:67], v[32:33], v[32:33] op_sel:[1,1]
    v_pk_mov_b32 v[52:53], v[32:33], v[32:33] op_sel:[0,0]
    v_pk_mov_b32 v[68:69], v[32:33], v[32:33] op_sel:[1,1]
    v_pk_mov_b32 v[54:55], v[32:33], v[32:33] op_sel:[0,0]
    v_pk_mov_b32 v[70:71], v[32:33], v[32:33] op_sel:[1,1]
    s_waitcnt lgkmcnt(0)
    s_barrier
    s_mul_i32 s74, s6, 1024
    s_lshl_b32 s75, s5, 2
    s_add_u32 s75, s74, s75
    s_add_u32 s75, s75, 11612160
    v_lshl_add_u32 v2, v1, 7, s75
    s_and_b32 s75, s5, 7
    s_lshl_b32 s75, s75, 7
    s_add_u32 s74, s74, s75
    s_add_u32 s74, s74, 11612160
    s_waitcnt lgkmcnt(0)
    s_waitcnt vmcnt(0)
    s_mov_b32 exec_lo, 255
    s_mov_b32 exec_hi, 0
    s_mov_b32 s78, 2097152
    v_cmp_eq_u32 vcc, 0, v30
    s_nop 0
    s_cbranch_vccz L_polld_6
L_poll_5:
    buffer_load_dword v30, v31, s[36:39], 0 offen sc1
    s_sub_u32 s78, s78, 1
    s_cbranch_scc1 L_polld_6
    s_waitcnt vmcnt(0)
    v_cmp_eq_u32 vcc, 0, v30
    s_nop 0
    s_cbranch_vccnz L_poll_5
L_polld_6:
    s_mov_b64 exec, -1
    v_lshl_add_u32 v31, v1, 2, s74
    s_mov_b64 exec, 1
    ds_add_rtn_u32 v14, v254, v253 offset:4
    s_waitcnt lgkmcnt(0)
    v_cmp_eq_u32 vcc, 3, v14
    s_mov_b64 exec, -1
    s_cbranch_vccz L_noflag_7
    v_mov_b32 v15, 1
    s_mov_b32 exec_lo, 255
    s_mov_b32 exec_hi, 0
    buffer_store_dword v15, v2, s[24:27], 0 offen sc1
    s_mov_b64 exec, -1
L_noflag_7:
    s_add_u32 s61, s70, 2
    s_and_b32 s61, s61, 7
    s_mul_i32 s62, s61, 196608
    s_lshl_b32 s61, s61, 7
    s_add_u32 s63, s62, 24576
    s_add_u32 m0, s60, 65536
    s_nop 0
    buffer_load_dwordx4 v3, s[16:19], s61 offen lds
    s_add_u32 m0, s60, 73728
    s_nop 0
    buffer_load_dwordx4 v5, s[20:23], s62 offen offset:0 lds
    s_add_u32 m0, s60, 80896
    s_nop 0
    buffer_load_dwordx4 v5, s[20:23], s62 offen offset:1024 lds
    s_add_u32 m0, s60, 88064
    s_nop 0
    buffer_load_dwordx4 v5, s[20:23], s62 offen offset:2048 lds
    s_add_u32 m0, s60, 66560
    s_nop 0
    buffer_load_dwordx4 v4, s[16:19], s61 offen lds
    s_add_u32 m0, s60, 74752
    s_nop 0
    buffer_load_dwordx4 v6, s[20:23], s63 offen offset:0 lds
    s_add_u32 m0, s60, 81920
    s_nop 0
    buffer_load_dwordx4 v6, s[20:23], s63 offen offset:1024 lds
    s_add_u32 m0, s60, 89088
    s_nop 0
    buffer_load_dwordx4 v6, s[20:23], s63 offen offset:2048 lds
    s_barrier
    s_add_u32 s61, s70, 3
    s_and_b32 s61, s61, 7
    s_mul_i32 s62, s61, 196608
    s_lshl_b32 s61, s61, 7
    s_add_u32 s63, s62, 24576
    s_add_u32 m0, s60, 98304
    s_nop 0
    buffer_load_dwordx4 v3, s[16:19], s61 offen lds
    s_add_u32 m0, s60, 106496
    s_nop 0
    buffer_load_dwordx4 v5, s[20:23], s62 offen offset:0 lds
    s_add_u32 m0, s60, 113664
    s_nop 0
    buffer_load_dwordx4 v5, s[20:23], s62 offen offset:1024 lds
    s_add_u32 m0, s60, 120832
    s_nop 0
    buffer_load_dwordx4 v5, s[20:23], s62 offen offset:2048 lds
    s_add_u32 m0, s60, 99328
    s_nop 0
    buffer_load_dwordx4 v4, s[16:19], s61 offen lds
    s_add_u32 m0, s60, 107520
    s_nop 0
    buffer_load_dwordx4 v6, s[20:23], s63 offen offset:0 lds
    s_add_u32 m0, s60, 114688
    s_nop 0
    buffer_load_dwordx4 v6, s[20:23], s63 offen offset:1024 lds
    s_add_u32 m0, s60, 121856
    s_nop 0
    buffer_load_dwordx4 v6, s[20:23], s63 offen offset:2048 lds
    s_waitcnt vmcnt(8)
    s_barrier
    s_add_u32 s61, s70, 4
    s_and_b32 s61, s61, 7
    s_mul_i32 s62, s61, 196608
    s_lshl_b32 s61, s61, 7
    s_add_u32 s63, s62, 24576
    s_add_u32 m0, s60, 0
    s_nop 0
    buffer_load_dwordx4 v3, s[16:19], s61 offen lds
    s_add_u32 m0, s60, 8192
    s_nop 0
    buffer_load_dwordx4 v5, s[20:23], s62 offen offset:0 lds
    s_add_u32 m0, s60, 15360
    s_nop 0
    buffer_load_dwordx4 v5, s[20:23], s62 offen offset:1024 lds
    s_add_u32 m0, s60, 22528
    s_nop 0
    buffer_load_dwordx4 v5, s[20:23], s62 offen offset:2048 lds
    s_add_u32 m0, s60, 1024
    s_nop 0
    buffer_load_dwordx4 v4, s[16:19], s61 offen lds
    s_add_u32 m0, s60, 9216
    s_nop 0
    buffer_load_dwordx4 v6, s[20:23], s63 offen offset:0 lds
    s_add_u32 m0, s60, 16384
    s_nop 0
    buffer_load_dwordx4 v6, s[20:23], s63 offen offset:1024 lds
    s_add_u32 m0, s60, 23552
    s_nop 0
    buffer_load_dwordx4 v6, s[20:23], s63 offen offset:2048 lds
    s_mov_b32 s73, 0
    s_lshl_b32 s74, s7, 17
    v_add_u32 v8, s74, v0
    v_lshrrev_b32 v2, 5, v1
    v_and_b32 v14, 15, v1
    v_lshlrev_b32 v14, 4, v14
    v_lshl_add_u32 v250, v2, 8, v14
    v_add_u32 v250, s74, v250
    v_mov_b32 v251, 0xdddd
    s_mov_b32 s66, 0xffff
    s_mov_b32 s67, 0xffff
    s_mov_b32 s83, 24
    s_and_b32 s79, s5, 7
    s_lshl_b32 s79, s79, 14
    s_add_u32 s79, s79, 0
    s_and_b32 s79, s79, 0x1ffff
    s_mov_b32 s69, s79
    v_and_b32 v2, 27, v1
    v_cmp_eq_u32 vcc, 16, v2
    v_mov_b32 v2, 0x3f803f80
    s_nop 0
    v_cndmask_b32 v2, 0, v2, vcc
    v_mov_b32 v140, v2
    v_mov_b32 v141, v2
    v_mov_b32 v142, v2
    v_mov_b32 v143, v2
    v_mov_b32 v144, v2
    v_mov_b32 v145, v2
    v_mov_b32 v146, v2
    v_mov_b32 v147, v2
    v_mov_b32 v152, v2
    v_mov_b32 v153, v2
    v_mov_b32 v154, v2
    v_mov_b32 v155, v2
    v_mov_b32 v156, v2
    v_mov_b32 v157, v2
    v_mov_b32 v158, v2
    v_mov_b32 v159, v2
    v_mov_b32 v164, v2
    v_mov_b32 v165, v2
    v_mov_b32 v166, v2
    v_mov_b32 v167, v2
    v_mov_b32 v168, v2
    v_mov_b32 v169, v2
    v_mov_b32 v170, v2
    v_mov_b32 v171, v2
    s_waitcnt vmcnt(8)
    s_barrier
    s_add_u32 s61, s70, 5
    s_and_b32 s61, s61, 7
    s_mul_i32 s62, s61, 196608
    s_lshl_b32 s61, s61, 7
    s_add_u32 s63, s62, 24576
    s_add_u32 m0, s60, 32768
    s_nop 0
    buffer_load_dwordx4 v3, s[16:19], s61 offen lds
    s_add_u32 m0, s60, 40960
    s_nop 0
    buffer_load_dwordx4 v5, s[20:23], s62 offen offset:0 lds
    s_add_u32 m0, s60, 48128
    s_nop 0
    buffer_load_dwordx4 v5, s[20:23], s62 offen offset:1024 lds
    s_add_u32 m0, s60, 55296
    s_nop 0
    buffer_load_dwordx4 v5, s[20:23], s62 offen offset:2048 lds
    s_add_u32 m0, s60, 33792
    s_nop 0
    buffer_load_dwordx4 v4, s[16:19], s61 offen lds
    s_add_u32 m0, s60, 41984
    s_nop 0
    buffer_load_dwordx4 v6, s[20:23], s63 offen offset:0 lds
    s_add_u32 m0, s60, 49152
    s_nop 0
    buffer_load_dwordx4 v6, s[20:23], s63 offen offset:1024 lds
    s_add_u32 m0, s60, 56320
    s_nop 0
    buffer_load_dwordx4 v6, s[20:23], s63 offen offset:2048 lds
    v_mov_b32 v72, 0
    v_mov_b32 v73, 0
    v_mov_b32 v74, 0
    v_mov_b32 v75, 0
    v_mov_b32 v76, 0
    v_mov_b32 v77, 0
    v_mov_b32 v78, 0
    v_mov_b32 v79, 0
    v_mov_b32 v80, 0
    v_mov_b32 v81, 0
    v_mov_b32 v82, 0
    v_mov_b32 v83, 0
    v_mov_b32 v84, 0
    v_mov_b32 v85, 0
    v_mov_b32 v86, 0
    v_mov_b32 v87, 0
    v_mov_b32 v88, 0
    v_mov_b32 v89, 0
    v_mov_b32 v90, 0
    v_mov_b32 v91, 0
    v_mov_b32 v92, 0
    v_mov_b32 v93, 0
    v_mov_b32 v94, 0
    v_mov_b32 v95, 0
    v_mov_b32 v96, 0
    v_mov_b32 v97, 0
    v_mov_b32 v98, 0
    v_mov_b32 v99, 0
    v_mov_b32 v100, 0
    v_mov_b32 v101, 0
    v_mov_b32 v102, 0
    v_mov_b32 v103, 0
    s_waitcnt vmcnt(8)
    s_barrier
    s_add_u32 s61, s70, 6
    s_and_b32 s61, s61, 7
    s_mul_i32 s62, s61, 196608
    s_lshl_b32 s61, s61, 7
    s_add_u32 s63, s62, 24576
    s_add_u32 m0, s60, 65536
    s_nop 0
    buffer_load_dwordx4 v3, s[16:19], s61 offen lds
    s_add_u32 m0, s60, 73728
    s_nop 0
    buffer_load_dwordx4 v5, s[20:23], s62 offen offset:0 lds
    s_add_u32 m0, s60, 80896
    s_nop 0
    buffer_load_dwordx4 v5, s[20:23], s62 offen offset:1024 lds
    s_add_u32 m0, s60, 88064
    s_nop 0
    buffer_load_dwordx4 v5, s[20:23], s62 offen offset:2048 lds
    s_add_u32 m0, s60, 66560
    s_nop 0
    buffer_load_dwordx4 v4, s[16:19], s61 offen lds
    s_add_u32 m0, s60, 74752
    s_nop 0
    buffer_load_dwordx4 v6, s[20:23], s63 offen offset:0 lds
    s_add_u32 m0, s60, 81920
    s_nop 0
    buffer_load_dwordx4 v6, s[20:23], s63 offen offset:1024 lds
    s_add_u32 m0, s60, 89088
    s_nop 0
    buffer_load_dwordx4 v6, s[20:23], s63 offen offset:2048 lds
    s_mov_b32 exec_hi, 0
    buffer_load_dword v30, v31, s[24:27], 0 offen sc1
    s_mov_b64 exec, -1
    s_waitcnt vmcnt(9)
    s_barrier
    s_add_u32 s61, s70, 7
    s_and_b32 s61, s61, 7
    s_mul_i32 s62, s61, 196608
    s_lshl_b32 s61, s61, 7
    s_add_u32 s63, s62, 24576
    s_add_u32 m0, s60, 98304
    s_nop 0
    buffer_load_dwordx4 v3, s[16:19], s61 offen lds
    s_add_u32 m0, s60, 106496
    s_nop 0
    buffer_load_dwordx4 v5, s[20:23], s62 offen offset:0 lds
    s_add_u32 m0, s60, 113664
    s_nop 0
    buffer_load_dwordx4 v5, s[20:23], s62 offen offset:1024 lds
    s_add_u32 m0, s60, 120832
    s_nop 0
    buffer_load_dwordx4 v5, s[20:23], s62 offen offset:2048 lds
    s_add_u32 m0, s60, 99328
    s_nop 0
    buffer_load_dwordx4 v4, s[16:19], s61 offen lds
    s_add_u32 m0, s60, 107520
    s_nop 0
    buffer_load_dwordx4 v6, s[20:23], s63 offen offset:0 lds
    s_add_u32 m0, s60, 114688
    s_nop 0
    buffer_load_dwordx4 v6, s[20:23], s63 offen offset:1024 lds
    s_add_u32 m0, s60, 121856
    s_nop 0
    buffer_load_dwordx4 v6, s[20:23], s63 offen offset:2048 lds
    s_waitcnt vmcnt(9)
    s_barrier
    s_waitcnt vmcnt(8)
    s_mov_b32 exec_lo, 4294967295
    s_mov_b32 exec_hi, 0
    s_mov_b32 s78, 2097152
    v_cmp_eq_u32 vcc, 0, v30
    s_nop 0
    s_cbranch_vccz L_polld_9
L_poll_8:
    buffer_load_dword v30, v31, s[24:27], 0 offen sc1
    s_sub_u32 s78, s78, 1
    s_cbranch_scc1 L_polld_9
    s_waitcnt vmcnt(0)
    v_cmp_eq_u32 vcc, 0, v30
    s_nop 0
    s_cbranch_vccnz L_poll_8
L_polld_9:
    s_mov_b64 exec, -1
    buffer_load_dwordx4 v[136:139], v8, s[24:27], s69 offen offset:0 sc1
    s_mov_b64 exec, s[66:67]
    buffer_load_dwordx4 v[140:143], v250, s[24:27], s69 offen offset:1024 sc1
    buffer_load_dwordx4 v[144:147], v250, s[24:27], s69 offen offset:1536 sc1
    s_mov_b64 exec, -1
    buffer_load_dwordx4 v[148:151], v8, s[24:27], s69 offen offset:2048 sc1
    s_mov_b64 exec, s[66:67]
    buffer_load_dwordx4 v[152:155], v250, s[24:27], s69 offen offset:3072 sc1
    buffer_load_dwordx4 v[156:159], v250, s[24:27], s69 offen offset:3584 sc1
    s_mov_b64 exec, -1
    s_add_u32 s69, s69, 4096
    s_and_b32 s69, s69, 0x1ffff
    s_waitcnt vmcnt(6)
    s_barrier
    s_waitcnt vmcnt(3)
    v_mfma_f32_32x32x16_bf16 v[104:119], v[136:139], v[16:19], v[40:55]
    s_setprio 0
    s_nop 10
    v_exp_f32 v104, v104
    v_exp_f32 v105, v105
    v_exp_f32 v106, v106
    buffer_load_dwordx4 v[160:163], v8, s[24:27], s69 offen offset:0 sc1
    s_mov_b64 exec, s[66:67]
    buffer_load_dwordx4 v[164:167], v250, s[24:27], s69 offen offset:1024 sc1
    buffer_load_dwordx4 v[168:171], v250, s[24:27], s69 offen offset:1536 sc1
    s_mov_b64 exec, -1
    v_exp_f32 v107, v107
    v_exp_f32 v108, v108
    v_mfma_f32_32x32x16_bf16 v[120:135], v[136:139], v[20:23], v[56:71]
    v_exp_f32 v109, v109
    v_exp_f32 v110, v110
    v_exp_f32 v111, v111
    v_exp_f32 v112, v112
    v_exp_f32 v113, v113
    v_smfmac_f32_32x32x32_bf16 v[72:87], v[140:143], v[104:111], v251
    v_exp_f32 v114, v114
    v_exp_f32 v115, v115
    v_exp_f32 v116, v116
    v_exp_f32 v117, v117
    v_exp_f32 v118, v118
    v_exp_f32 v119, v119
    v_exp_f32 v120, v120
    v_exp_f32 v121, v121
    v_smfmac_f32_32x32x32_bf16 v[72:87], v[144:147], v[112:119], v251
    v_exp_f32 v122, v122
    v_exp_f32 v123, v123
    s_waitcnt vmcnt(3)
    v_exp_f32 v124, v124
    v_mfma_f32_32x32x16_bf16 v[104:119], v[148:151], v[16:19], v[40:55]
    v_exp_f32 v125, v125
    v_exp_f32 v126, v126
    v_exp_f32 v127, v127
    v_exp_f32 v128, v128
    v_exp_f32 v129, v129
    v_smfmac_f32_32x32x32_bf16 v[88:103], v[140:143], v[120:127], v251
    v_exp_f32 v130, v130
    v_exp_f32 v131, v131
    v_exp_f32 v132, v132
    v_exp_f32 v133, v133
    v_exp_f32 v134, v134
    v_exp_f32 v135, v135
    v_exp_f32 v104, v104
    v_exp_f32 v105, v105
    v_smfmac_f32_32x32x32_bf16 v[88:103], v[144:147], v[128:135], v251
    v_exp_f32 v106, v106
    buffer_load_dwordx4 v[136:139], v8, s[24:27], s69 offen offset:2048 sc1
    s_mov_b64 exec, s[66:67]
    buffer_load_dwordx4 v[140:143], v250, s[24:27], s69 offen offset:3072 sc1
    buffer_load_dwordx4 v[144:147], v250, s[24:27], s69 offen offset:3584 sc1
    s_mov_b64 exec, -1
    s_add_u32 s69, s69, 4096
    s_and_b32 s69, s69, 0x1ffff
    v_exp_f32 v107, v107
    v_exp_f32 v108, v108
    v_mfma_f32_32x32x16_bf16 v[120:135], v[148:151], v[20:23], v[56:71]
    v_exp_f32 v109, v109
    v_exp_f32 v110, v110
    v_exp_f32 v111, v111
    v_exp_f32 v112, v112
    v_exp_f32 v113, v113
    v_smfmac_f32_32x32x32_bf16 v[72:87], v[152:155], v[104:111], v251
    v_exp_f32 v114, v114
    v_exp_f32 v115, v115
    v_exp_f32 v116, v116
    v_exp_f32 v117, v117
    v_exp_f32 v118, v118
    v_exp_f32 v119, v119
    v_exp_f32 v120, v120
    v_exp_f32 v121, v121
    v_smfmac_f32_32x32x32_bf16 v[72:87], v[156:159], v[112:119], v251
    v_exp_f32 v122, v122
    v_exp_f32 v123, v123
    s_waitcnt vmcnt(3)
    v_exp_f32 v124, v124
    v_mfma_f32_32x32x16_bf16 v[104:119], v[160:163], v[16:19], v[40:55]
    v_exp_f32 v125, v125
    v_exp_f32 v126, v126
    v_exp_f32 v127, v127
    v_exp_f32 v128, v128
    v_exp_f32 v129, v129
    v_smfmac_f32_32x32x32_bf16 v[88:103], v[152:155], v[120:127], v251
    v_exp_f32 v130, v130
    v_exp_f32 v131, v131
    v_exp_f32 v132, v132
    v_exp_f32 v133, v133
    v_exp_f32 v134, v134
    v_exp_f32 v135, v135
    v_exp_f32 v104, v104
    v_exp_f32 v105, v105
    v_smfmac_f32_32x32x32_bf16 v[88:103], v[156:159], v[128:135], v251
    v_exp_f32 v106, v106
    buffer_load_dwordx4 v[148:151], v8, s[24:27], s69 offen offset:0 sc1
    s_mov_b64 exec, s[66:67]
    buffer_load_dwordx4 v[152:155], v250, s[24:27], s69 offen offset:1024 sc1
    buffer_load_dwordx4 v[156:159], v250, s[24:27], s69 offen offset:1536 sc1
    s_mov_b64 exec, -1
    v_exp_f32 v107, v107
    v_exp_f32 v108, v108
    v_mfma_f32_32x32x16_bf16 v[120:135], v[160:163], v[20:23], v[56:71]
    v_exp_f32 v109, v109
    v_exp_f32 v110, v110
    v_exp_f32 v111, v111
    v_exp_f32 v112, v112
    v_exp_f32 v113, v113
    v_smfmac_f32_32x32x32_bf16 v[72:87], v[164:167], v[104:111], v251
    v_exp_f32 v114, v114
    v_exp_f32 v115, v115
    v_exp_f32 v116, v116
    v_exp_f32 v117, v117
    v_exp_f32 v118, v118
    v_exp_f32 v119, v119
    v_exp_f32 v120, v120
    v_exp_f32 v121, v121
    v_smfmac_f32_32x32x32_bf16 v[72:87], v[168:171], v[112:119], v251
    v_exp_f32 v122, v122
    v_exp_f32 v123, v123
    s_waitcnt vmcnt(3)
    v_exp_f32 v124, v124
    v_mfma_f32_32x32x16_bf16 v[104:119], v[136:139], v[16:19], v[40:55]
    v_exp_f32 v125, v125
    v_exp_f32 v126, v126
    v_exp_f32 v127, v127
    v_exp_f32 v128, v128
    v_exp_f32 v129, v129
    v_smfmac_f32_32x32x32_bf16 v[88:103], v[164:167], v[120:127], v251
    v_exp_f32 v130, v130
    v_exp_f32 v131, v131
    v_exp_f32 v132, v132
    v_exp_f32 v133, v133
    v_exp_f32 v134, v134
    v_exp_f32 v135, v135
    v_exp_f32 v104, v104
    v_exp_f32 v105, v105
    v_smfmac_f32_32x32x32_bf16 v[88:103], v[168:171], v[128:135], v251
    v_exp_f32 v106, v106
    buffer_load_dwordx4 v[160:163], v8, s[24:27], s69 offen offset:2048 sc1
    s_mov_b64 exec, s[66:67]
    buffer_load_dwordx4 v[164:167], v250, s[24:27], s69 offen offset:3072 sc1
    buffer_load_dwordx4 v[168:171], v250, s[24:27], s69 offen offset:3584 sc1
    s_mov_b64 exec, -1
    s_add_u32 s69, s69, 4096
    s_and_b32 s69, s69, 0x1ffff
    v_exp_f32 v107, v107
    v_exp_f32 v108, v108
    v_mfma_f32_32x32x16_bf16 v[120:135], v[136:139], v[20:23], v[56:71]
    v_exp_f32 v109, v109
    v_exp_f32 v110, v110
    v_exp_f32 v111, v111
    v_exp_f32 v112, v112
    v_exp_f32 v113, v113
    v_smfmac_f32_32x32x32_bf16 v[72:87], v[140:143], v[104:111], v251
    v_exp_f32 v114, v114
    v_exp_f32 v115, v115
    v_exp_f32 v116, v116
    v_exp_f32 v117, v117
    v_exp_f32 v118, v118
    v_exp_f32 v119, v119
    v_exp_f32 v120, v120
    v_exp_f32 v121, v121
    v_smfmac_f32_32x32x32_bf16 v[72:87], v[144:147], v[112:119], v251
    v_exp_f32 v122, v122
    v_exp_f32 v123, v123
    s_waitcnt vmcnt(3)
    v_exp_f32 v124, v124
    v_mfma_f32_32x32x16_bf16 v[104:119], v[148:151], v[16:19], v[40:55]
    v_exp_f32 v125, v125
    v_exp_f32 v126, v126
    v_exp_f32 v127, v127
    v_exp_f32 v128, v128
    v_exp_f32 v129, v129
    v_smfmac_f32_32x32x32_bf16 v[88:103], v[140:143], v[120:127], v251
    v_exp_f32 v130, v130
    v_exp_f32 v131, v131
    v_exp_f32 v132, v132
    v_exp_f32 v133, v133
    v_exp_f32 v134, v134
    v_exp_f32 v135, v135
    v_exp_f32 v104, v104
    v_exp_f32 v105, v105
    v_smfmac_f32_32x32x32_bf16 v[88:103], v[144:147], v[128:135], v251
    v_exp_f32 v106, v106
    buffer_load_dwordx4 v[136:139], v8, s[24:27], s69 offen offset:0 sc1
    s_mov_b64 exec, s[66:67]
    buffer_load_dwordx4 v[140:143], v250, s[24:27], s69 offen offset:1024 sc1
    buffer_load_dwordx4 v[144:147], v250, s[24:27], s69 offen offset:1536 sc1
    s_mov_b64 exec, -1
    v_exp_f32 v107, v107
    v_exp_f32 v108, v108
    v_mfma_f32_32x32x16_bf16 v[120:135], v[148:151], v[20:23], v[56:71]
    v_exp_f32 v109, v109
    v_exp_f32 v110, v110
    v_exp_f32 v111, v111
    v_exp_f32 v112, v112
    v_exp_f32 v113, v113
    v_smfmac_f32_32x32x32_bf16 v[72:87], v[152:155], v[104:111], v251
    v_exp_f32 v114, v114
    v_exp_f32 v115, v115
    v_exp_f32 v116, v116
    v_exp_f32 v117, v117
    v_exp_f32 v118, v118
    v_exp_f32 v119, v119
    v_exp_f32 v120, v120
    v_exp_f32 v121, v121
    v_smfmac_f32_32x32x32_bf16 v[72:87], v[156:159], v[112:119], v251
    v_exp_f32 v122, v122
    v_exp_f32 v123, v123
    s_waitcnt vmcnt(3)
    v_exp_f32 v124, v124
    v_mfma_f32_32x32x16_bf16 v[104:119], v[160:163], v[16:19], v[40:55]
    v_exp_f32 v125, v125
    v_exp_f32 v126, v126
    v_exp_f32 v127, v127
    v_exp_f32 v128, v128
    v_exp_f32 v129, v129
    v_smfmac_f32_32x32x32_bf16 v[88:103], v[152:155], v[120:127], v251
    v_exp_f32 v130, v130
    v_exp_f32 v131, v131
    v_exp_f32 v132, v132
    v_exp_f32 v133, v133
    v_exp_f32 v134, v134
    v_exp_f32 v135, v135
    v_exp_f32 v104, v104
    v_exp_f32 v105, v105
    v_smfmac_f32_32x32x32_bf16 v[88:103], v[156:159], v[128:135], v251
    v_exp_f32 v106, v106
    buffer_load_dwordx4 v[148:151], v8, s[24:27], s69 offen offset:2048 sc1
    s_mov_b64 exec, s[66:67]
    buffer_load_dwordx4 v[152:155], v250, s[24:27], s69 offen offset:3072 sc1
    buffer_load_dwordx4 v[156:159], v250, s[24:27], s69 offen offset:3584 sc1
    s_mov_b64 exec, -1
    s_add_u32 s69, s69, 4096
    s_and_b32 s69, s69, 0x1ffff
    v_exp_f32 v107, v107
    v_exp_f32 v108, v108
    v_mfma_f32_32x32x16_bf16 v[120:135], v[160:163], v[20:23], v[56:71]
    v_exp_f32 v109, v109
    v_exp_f32 v110, v110
    v_exp_f32 v111, v111
    v_exp_f32 v112, v112
    v_exp_f32 v113, v113
    v_smfmac_f32_32x32x32_bf16 v[72:87], v[164:167], v[104:111], v251
    v_exp_f32 v114, v114
    v_exp_f32 v115, v115
    v_exp_f32 v116, v116
    v_exp_f32 v117, v117
    v_exp_f32 v118, v118
    v_exp_f32 v119, v119
    v_exp_f32 v120, v120
    v_exp_f32 v121, v121
    v_smfmac_f32_32x32x32_bf16 v[72:87], v[168:171], v[112:119], v251
    v_exp_f32 v122, v122
    v_exp_f32 v123, v123
    s_waitcnt vmcnt(3)
    v_exp_f32 v124, v124
    v_mfma_f32_32x32x16_bf16 v[104:119], v[136:139], v[16:19], v[40:55]
    v_exp_f32 v125, v125
    v_exp_f32 v126, v126
    v_exp_f32 v127, v127
    v_exp_f32 v128, v128
    v_exp_f32 v129, v129
    v_smfmac_f32_32x32x32_bf16 v[88:103], v[164:167], v[120:127], v251
    v_exp_f32 v130, v130
    v_exp_f32 v131, v131
    v_exp_f32 v132, v132
    v_exp_f32 v133, v133
    v_exp_f32 v134, v134
    v_exp_f32 v135, v135
    v_exp_f32 v104, v104
    v_exp_f32 v105, v105
    v_smfmac_f32_32x32x32_bf16 v[88:103], v[168:171], v[128:135], v251
    v_exp_f32 v106, v106
    buffer_load_dwordx4 v[160:163], v8, s[24:27], s69 offen offset:0 sc1
    s_mov_b64 exec, s[66:67]
    buffer_load_dwordx4 v[164:167], v250, s[24:27], s69 offen offset:1024 sc1
    buffer_load_dwordx4 v[168:171], v250, s[24:27], s69 offen offset:1536 sc1
    s_mov_b64 exec, -1
    v_exp_f32 v107, v107
    v_exp_f32 v108, v108
    v_mfma_f32_32x32x16_bf16 v[120:135], v[136:139], v[20:23], v[56:71]
    v_exp_f32 v109, v109
    v_exp_f32 v110, v110
    v_exp_f32 v111, v111
    v_exp_f32 v112, v112
    v_exp_f32 v113, v113
    v_smfmac_f32_32x32x32_bf16 v[72:87], v[140:143], v[104:111], v251
    v_exp_f32 v114, v114
    v_exp_f32 v115, v115
    v_exp_f32 v116, v116
    v_exp_f32 v117, v117
    v_exp_f32 v118, v118
    v_exp_f32 v119, v119
    v_exp_f32 v120, v120
    v_exp_f32 v121, v121
    v_smfmac_f32_32x32x32_bf16 v[72:87], v[144:147], v[112:119], v251
    v_exp_f32 v122, v122
    v_exp_f32 v123, v123
    s_waitcnt vmcnt(3)
    v_exp_f32 v124, v124
    v_mfma_f32_32x32x16_bf16 v[104:119], v[148:151], v[16:19], v[40:55]
    v_exp_f32 v125, v125
    v_exp_f32 v126, v126
    v_exp_f32 v127, v127
    v_exp_f32 v128, v128
    v_exp_f32 v129, v129
    v_smfmac_f32_32x32x32_bf16 v[88:103], v[140:143], v[120:127], v251
    v_exp_f32 v130, v130
    v_exp_f32 v131, v131
    v_exp_f32 v132, v132
    v_exp_f32 v133, v133
    v_exp_f32 v134, v134
    v_exp_f32 v135, v135
    v_exp_f32 v104, v104
    v_exp_f32 v105, v105
    v_smfmac_f32_32x32x32_bf16 v[88:103], v[144:147], v[128:135], v251
    v_exp_f32 v106, v106
    buffer_load_dwordx4 v[136:139], v8, s[24:27], s69 offen offset:2048 sc1
    s_mov_b64 exec, s[66:67]
    buffer_load_dwordx4 v[140:143], v250, s[24:27], s69 offen offset:3072 sc1
    buffer_load_dwordx4 v[144:147], v250, s[24:27], s69 offen offset:3584 sc1
    s_mov_b64 exec, -1
    s_add_u32 s69, s69, 4096
    s_and_b32 s69, s69, 0x1ffff
    v_exp_f32 v107, v107
    v_exp_f32 v108, v108
    v_mfma_f32_32x32x16_bf16 v[120:135], v[148:151], v[20:23], v[56:71]
    v_exp_f32 v109, v109
    v_exp_f32 v110, v110
    v_exp_f32 v111, v111
    v_exp_f32 v112, v112
    v_exp_f32 v113, v113
    v_smfmac_f32_32x32x32_bf16 v[72:87], v[152:155], v[104:111], v251
    v_exp_f32 v114, v114
    v_exp_f32 v115, v115
    v_exp_f32 v116, v116
    v_exp_f32 v117, v117
    v_exp_f32 v118, v118
    v_exp_f32 v119, v119
    v_exp_f32 v120, v120
    v_exp_f32 v121, v121
    v_smfmac_f32_32x32x32_bf16 v[72:87], v[156:159], v[112:119], v251
    v_exp_f32 v122, v122
    v_exp_f32 v123, v123
    s_waitcnt vmcnt(3)
    v_exp_f32 v124, v124
    v_mfma_f32_32x32x16_bf16 v[104:119], v[160:163], v[16:19], v[40:55]
    v_exp_f32 v125, v125
    v_exp_f32 v126, v126
    v_exp_f32 v127, v127
    v_exp_f32 v128, v128
    v_exp_f32 v129, v129
    v_smfmac_f32_32x32x32_bf16 v[88:103], v[152:155], v[120:127], v251
    v_exp_f32 v130, v130
    v_exp_f32 v131, v131
    v_exp_f32 v132, v132
    v_exp_f32 v133, v133
    v_exp_f32 v134, v134
    v_exp_f32 v135, v135
    v_exp_f32 v104, v104
    v_exp_f32 v105, v105
    v_smfmac_f32_32x32x32_bf16 v[88:103], v[156:159], v[128:135], v251
    v_exp_f32 v106, v106
    buffer_load_dwordx4 v[148:151], v8, s[24:27], s69 offen offset:0 sc1
    s_mov_b64 exec, s[66:67]
    buffer_load_dwordx4 v[152:155], v250, s[24:27], s69 offen offset:1024 sc1
    buffer_load_dwordx4 v[156:159], v250, s[24:27], s69 offen offset:1536 sc1
    s_mov_b64 exec, -1
    v_exp_f32 v107, v107
    v_exp_f32 v108, v108
    v_mfma_f32_32x32x16_bf16 v[120:135], v[160:163], v[20:23], v[56:71]
    v_exp_f32 v109, v109
    v_exp_f32 v110, v110
    v_exp_f32 v111, v111
    v_exp_f32 v112, v112
    v_exp_f32 v113, v113
    v_smfmac_f32_32x32x32_bf16 v[72:87], v[164:167], v[104:111], v251
    v_exp_f32 v114, v114
    v_exp_f32 v115, v115
    v_exp_f32 v116, v116
    v_exp_f32 v117, v117
    v_exp_f32 v118, v118
    v_exp_f32 v119, v119
    v_exp_f32 v120, v120
    v_exp_f32 v121, v121
    v_smfmac_f32_32x32x32_bf16 v[72:87], v[168:171], v[112:119], v251
    v_exp_f32 v122, v122
    v_exp_f32 v123, v123
    s_waitcnt vmcnt(3)
    v_exp_f32 v124, v124
    v_mfma_f32_32x32x16_bf16 v[104:119], v[136:139], v[16:19], v[40:55]
    v_exp_f32 v125, v125
    v_exp_f32 v126, v126
    v_exp_f32 v127, v127
    v_exp_f32 v128, v128
    v_exp_f32 v129, v129
    v_smfmac_f32_32x32x32_bf16 v[88:103], v[164:167], v[120:127], v251
    v_exp_f32 v130, v130
    v_exp_f32 v131, v131
    v_exp_f32 v132, v132
    v_exp_f32 v133, v133
    v_exp_f32 v134, v134
    v_exp_f32 v135, v135
    v_exp_f32 v104, v104
    v_exp_f32 v105, v105
    v_smfmac_f32_32x32x32_bf16 v[88:103], v[168:171], v[128:135], v251
    v_exp_f32 v106, v106
    buffer_load_dwordx4 v[160:163], v8, s[24:27], s69 offen offset:2048 sc1
    s_mov_b64 exec, s[66:67]
    buffer_load_dwordx4 v[164:167], v250, s[24:27], s69 offen offset:3072 sc1
    buffer_load_dwordx4 v[168:171], v250, s[24:27], s69 offen offset:3584 sc1
    s_mov_b64 exec, -1
    s_add_u32 s69, s69, 4096
    s_and_b32 s69, s69, 0x1ffff
    v_exp_f32 v107, v107
    v_exp_f32 v108, v108
    v_mfma_f32_32x32x16_bf16 v[120:135], v[136:139], v[20:23], v[56:71]
    v_exp_f32 v109, v109
    v_exp_f32 v110, v110
    v_exp_f32 v111, v111
    v_exp_f32 v112, v112
    v_exp_f32 v113, v113
    v_smfmac_f32_32x32x32_bf16 v[72:87], v[140:143], v[104:111], v251
    v_exp_f32 v114, v114
    v_exp_f32 v115, v115
    v_exp_f32 v116, v116
    v_exp_f32 v117, v117
    v_exp_f32 v118, v118
    v_exp_f32 v119, v119
    v_exp_f32 v120, v120
    v_exp_f32 v121, v121
    v_smfmac_f32_32x32x32_bf16 v[72:87], v[144:147], v[112:119], v251
    v_exp_f32 v122, v122
    v_exp_f32 v123, v123
    s_waitcnt vmcnt(3)
    v_exp_f32 v124, v124
    v_mfma_f32_32x32x16_bf16 v[104:119], v[148:151], v[16:19], v[40:55]
    v_exp_f32 v125, v125
    v_exp_f32 v126, v126
    v_exp_f32 v127, v127
    v_exp_f32 v128, v128
    v_exp_f32 v129, v129
    v_smfmac_f32_32x32x32_bf16 v[88:103], v[140:143], v[120:127], v251
    v_exp_f32 v130, v130
    v_exp_f32 v131, v131
    v_exp_f32 v132, v132
    v_exp_f32 v133, v133
    v_exp_f32 v134, v134
    v_exp_f32 v135, v135
    v_exp_f32 v104, v104
    v_exp_f32 v105, v105
    v_smfmac_f32_32x32x32_bf16 v[88:103], v[144:147], v[128:135], v251
    v_exp_f32 v106, v106
    buffer_load_dwordx4 v[136:139], v8, s[24:27], s69 offen offset:0 sc1
    s_mov_b64 exec, s[66:67]
    buffer_load_dwordx4 v[140:143], v250, s[24:27], s69 offen offset:1024 sc1
    buffer_load_dwordx4 v[144:147], v250, s[24:27], s69 offen offset:1536 sc1
    s_mov_b64 exec, -1
    v_exp_f32 v107, v107
    v_exp_f32 v108, v108
    v_mfma_f32_32x32x16_bf16 v[120:135], v[148:151], v[20:23], v[56:71]
    v_exp_f32 v109, v109
    v_exp_f32 v110, v110
    v_exp_f32 v111, v111
    v_exp_f32 v112, v112
    v_exp_f32 v113, v113
    v_smfmac_f32_32x32x32_bf16 v[72:87], v[152:155], v[104:111], v251
    v_exp_f32 v114, v114
    v_exp_f32 v115, v115
    v_exp_f32 v116, v116
    v_exp_f32 v117, v117
    v_exp_f32 v118, v118
    v_exp_f32 v119, v119
    v_exp_f32 v120, v120
    v_exp_f32 v121, v121
    v_smfmac_f32_32x32x32_bf16 v[72:87], v[156:159], v[112:119], v251
    v_exp_f32 v122, v122
    v_exp_f32 v123, v123
    s_waitcnt vmcnt(3)
    v_exp_f32 v124, v124
    v_mfma_f32_32x32x16_bf16 v[104:119], v[160:163], v[16:19], v[40:55]
    v_exp_f32 v125, v125
    v_exp_f32 v126, v126
    v_exp_f32 v127, v127
    v_exp_f32 v128, v128
    v_exp_f32 v129, v129
    v_smfmac_f32_32x32x32_bf16 v[88:103], v[152:155], v[120:127], v251
    v_exp_f32 v130, v130
    v_exp_f32 v131, v131
    v_exp_f32 v132, v132
    v_exp_f32 v133, v133
    v_exp_f32 v134, v134
    v_exp_f32 v135, v135
    v_exp_f32 v104, v104
    v_exp_f32 v105, v105
    v_smfmac_f32_32x32x32_bf16 v[88:103], v[156:159], v[128:135], v251
    v_exp_f32 v106, v106
    buffer_load_dwordx4 v[148:151], v8, s[24:27], s69 offen offset:2048 sc1
    s_mov_b64 exec, s[66:67]
    buffer_load_dwordx4 v[152:155], v250, s[24:27], s69 offen offset:3072 sc1
    buffer_load_dwordx4 v[156:159], v250, s[24:27], s69 offen offset:3584 sc1
    s_mov_b64 exec, -1
    s_add_u32 s69, s69, 4096
    s_and_b32 s69, s69, 0x1ffff
    v_exp_f32 v107, v107
    v_exp_f32 v108, v108
    v_mfma_f32_32x32x16_bf16 v[120:135], v[160:163], v[20:23], v[56:71]
    v_exp_f32 v109, v109
    v_exp_f32 v110, v110
    v_exp_f32 v111, v111
    v_exp_f32 v112, v112
    v_exp_f32 v113, v113
    v_smfmac_f32_32x32x32_bf16 v[72:87], v[164:167], v[104:111], v251
    v_exp_f32 v114, v114
    v_exp_f32 v115, v115
    v_exp_f32 v116, v116
    v_exp_f32 v117, v117
    v_exp_f32 v118, v118
    v_exp_f32 v119, v119
    v_exp_f32 v120, v120
    v_exp_f32 v121, v121
    v_smfmac_f32_32x32x32_bf16 v[72:87], v[168:171], v[112:119], v251
    v_exp_f32 v122, v122
    v_exp_f32 v123, v123
    s_waitcnt vmcnt(3)
    v_exp_f32 v124, v124
    v_mfma_f32_32x32x16_bf16 v[104:119], v[136:139], v[16:19], v[40:55]
    v_exp_f32 v125, v125
    v_exp_f32 v126, v126
    v_exp_f32 v127, v127
    v_exp_f32 v128, v128
    v_exp_f32 v129, v129
    v_smfmac_f32_32x32x32_bf16 v[88:103], v[164:167], v[120:127], v251
    v_exp_f32 v130, v130
    v_exp_f32 v131, v131
    v_exp_f32 v132, v132
    v_exp_f32 v133, v133
    v_exp_f32 v134, v134
    v_exp_f32 v135, v135
    v_exp_f32 v104, v104
    v_exp_f32 v105, v105
    v_smfmac_f32_32x32x32_bf16 v[88:103], v[168:171], v[128:135], v251
    v_exp_f32 v106, v106
    buffer_load_dwordx4 v[160:163], v8, s[24:27], s69 offen offset:0 sc1
    s_mov_b64 exec, s[66:67]
    buffer_load_dwordx4 v[164:167], v250, s[24:27], s69 offen offset:1024 sc1
    buffer_load_dwordx4 v[168:171], v250, s[24:27], s69 offen offset:1536 sc1
    s_mov_b64 exec, -1
    v_exp_f32 v107, v107
    v_exp_f32 v108, v108
    v_mfma_f32_32x32x16_bf16 v[120:135], v[136:139], v[20:23], v[56:71]
    v_exp_f32 v109, v109
    v_exp_f32 v110, v110
    v_exp_f32 v111, v111
    v_exp_f32 v112, v112
    v_exp_f32 v113, v113
    v_smfmac_f32_32x32x32_bf16 v[72:87], v[140:143], v[104:111], v251
    v_exp_f32 v114, v114
    v_exp_f32 v115, v115
    v_exp_f32 v116, v116
    v_exp_f32 v117, v117
    v_exp_f32 v118, v118
    v_exp_f32 v119, v119
    v_exp_f32 v120, v120
    v_exp_f32 v121, v121
    v_smfmac_f32_32x32x32_bf16 v[72:87], v[144:147], v[112:119], v251
    v_exp_f32 v122, v122
    v_exp_f32 v123, v123
    s_waitcnt vmcnt(3)
    v_exp_f32 v124, v124
    v_mfma_f32_32x32x16_bf16 v[104:119], v[148:151], v[16:19], v[40:55]
    v_exp_f32 v125, v125
    v_exp_f32 v126, v126
    v_exp_f32 v127, v127
    v_exp_f32 v128, v128
    v_exp_f32 v129, v129
    v_smfmac_f32_32x32x32_bf16 v[88:103], v[140:143], v[120:127], v251
    v_exp_f32 v130, v130
    v_exp_f32 v131, v131
    v_exp_f32 v132, v132
    v_exp_f32 v133, v133
    v_exp_f32 v134, v134
    v_exp_f32 v135, v135
    v_exp_f32 v104, v104
    v_exp_f32 v105, v105
    v_smfmac_f32_32x32x32_bf16 v[88:103], v[144:147], v[128:135], v251
    v_exp_f32 v106, v106
    buffer_load_dwordx4 v[136:139], v8, s[24:27], s69 offen offset:2048 sc1
    s_mov_b64 exec, s[66:67]
    buffer_load_dwordx4 v[140:143], v250, s[24:27], s69 offen offset:3072 sc1
    buffer_load_dwordx4 v[144:147], v250, s[24:27], s69 offen offset:3584 sc1
    s_mov_b64 exec, -1
    s_add_u32 s69, s69, 4096
    s_and_b32 s69, s69, 0x1ffff
    v_exp_f32 v107, v107
    v_exp_f32 v108, v108
    v_mfma_f32_32x32x16_bf16 v[120:135], v[148:151], v[20:23], v[56:71]
    v_exp_f32 v109, v109
    v_exp_f32 v110, v110
    v_exp_f32 v111, v111
    v_exp_f32 v112, v112
    v_exp_f32 v113, v113
    v_smfmac_f32_32x32x32_bf16 v[72:87], v[152:155], v[104:111], v251
    v_exp_f32 v114, v114
    v_exp_f32 v115, v115
    v_exp_f32 v116, v116
    v_exp_f32 v117, v117
    v_exp_f32 v118, v118
    v_exp_f32 v119, v119
    v_exp_f32 v120, v120
    v_exp_f32 v121, v121
    v_smfmac_f32_32x32x32_bf16 v[72:87], v[156:159], v[112:119], v251
    v_exp_f32 v122, v122
    v_exp_f32 v123, v123
    s_waitcnt vmcnt(3)
    v_exp_f32 v124, v124
    v_mfma_f32_32x32x16_bf16 v[104:119], v[160:163], v[16:19], v[40:55]
    v_exp_f32 v125, v125
    v_exp_f32 v126, v126
    v_exp_f32 v127, v127
    v_exp_f32 v128, v128
    v_exp_f32 v129, v129
    v_smfmac_f32_32x32x32_bf16 v[88:103], v[152:155], v[120:127], v251
    v_exp_f32 v130, v130
    v_exp_f32 v131, v131
    v_exp_f32 v132, v132
    v_exp_f32 v133, v133
    v_exp_f32 v134, v134
    v_exp_f32 v135, v135
    v_exp_f32 v104, v104
    v_exp_f32 v105, v105
    v_smfmac_f32_32x32x32_bf16 v[88:103], v[156:159], v[128:135], v251
    v_exp_f32 v106, v106
    buffer_load_dwordx4 v[148:151], v8, s[24:27], s69 offen offset:0 sc1
    s_mov_b64 exec, s[66:67]
    buffer_load_dwordx4 v[152:155], v250, s[24:27], s69 offen offset:1024 sc1
    buffer_load_dwordx4 v[156:159], v250, s[24:27], s69 offen offset:1536 sc1
    s_mov_b64 exec, -1
    v_exp_f32 v107, v107
    v_exp_f32 v108, v108
    v_mfma_f32_32x32x16_bf16 v[120:135], v[160:163], v[20:23], v[56:71]
    v_exp_f32 v109, v109
    v_exp_f32 v110, v110
    v_exp_f32 v111, v111
    v_exp_f32 v112, v112
    v_exp_f32 v113, v113
    v_smfmac_f32_32x32x32_bf16 v[72:87], v[164:167], v[104:111], v251
    v_exp_f32 v114, v114
    v_exp_f32 v115, v115
    v_exp_f32 v116, v116
    v_exp_f32 v117, v117
    v_exp_f32 v118, v118
    v_exp_f32 v119, v119
    v_exp_f32 v120, v120
    v_exp_f32 v121, v121
    v_smfmac_f32_32x32x32_bf16 v[72:87], v[168:171], v[112:119], v251
    v_exp_f32 v122, v122
    v_exp_f32 v123, v123
    s_waitcnt vmcnt(3)
    v_exp_f32 v124, v124
    v_mfma_f32_32x32x16_bf16 v[104:119], v[136:139], v[16:19], v[40:55]
    v_exp_f32 v125, v125
    v_exp_f32 v126, v126
    v_exp_f32 v127, v127
    v_exp_f32 v128, v128
    v_exp_f32 v129, v129
    v_smfmac_f32_32x32x32_bf16 v[88:103], v[164:167], v[120:127], v251
    v_exp_f32 v130, v130
    v_exp_f32 v131, v131
    v_exp_f32 v132, v132
    v_exp_f32 v133, v133
    v_exp_f32 v134, v134
    v_exp_f32 v135, v135
    v_exp_f32 v104, v104
    v_exp_f32 v105, v105
    v_smfmac_f32_32x32x32_bf16 v[88:103], v[168:171], v[128:135], v251
    v_exp_f32 v106, v106
    buffer_load_dwordx4 v[160:163], v8, s[24:27], s69 offen offset:2048 sc1
    s_mov_b64 exec, s[66:67]
    buffer_load_dwordx4 v[164:167], v250, s[24:27], s69 offen offset:3072 sc1
    buffer_load_dwordx4 v[168:171], v250, s[24:27], s69 offen offset:3584 sc1
    s_mov_b64 exec, -1
    s_add_u32 s69, s69, 4096
    s_and_b32 s69, s69, 0x1ffff
    v_exp_f32 v107, v107
    v_exp_f32 v108, v108
    v_mfma_f32_32x32x16_bf16 v[120:135], v[136:139], v[20:23], v[56:71]
    v_exp_f32 v109, v109
    v_exp_f32 v110, v110
    v_exp_f32 v111, v111
    v_exp_f32 v112, v112
    v_exp_f32 v113, v113
    v_smfmac_f32_32x32x32_bf16 v[72:87], v[140:143], v[104:111], v251
    v_exp_f32 v114, v114
    v_exp_f32 v115, v115
    v_exp_f32 v116, v116
    v_exp_f32 v117, v117
    v_exp_f32 v118, v118
    v_exp_f32 v119, v119
    v_exp_f32 v120, v120
    v_exp_f32 v121, v121
    v_smfmac_f32_32x32x32_bf16 v[72:87], v[144:147], v[112:119], v251
    v_exp_f32 v122, v122
    v_exp_f32 v123, v123
    s_waitcnt vmcnt(3)
    v_exp_f32 v124, v124
    v_mfma_f32_32x32x16_bf16 v[104:119], v[148:151], v[16:19], v[40:55]
    v_exp_f32 v125, v125
    v_exp_f32 v126, v126
    v_exp_f32 v127, v127
    v_exp_f32 v128, v128
    v_exp_f32 v129, v129
    v_smfmac_f32_32x32x32_bf16 v[88:103], v[140:143], v[120:127], v251
    v_exp_f32 v130, v130
    v_exp_f32 v131, v131
    v_exp_f32 v132, v132
    v_exp_f32 v133, v133
    v_exp_f32 v134, v134
    v_exp_f32 v135, v135
    v_exp_f32 v104, v104
    v_exp_f32 v105, v105
    v_smfmac_f32_32x32x32_bf16 v[88:103], v[144:147], v[128:135], v251
    v_exp_f32 v106, v106
    buffer_load_dwordx4 v[136:139], v8, s[24:27], s69 offen offset:0 sc1
    s_mov_b64 exec, s[66:67]
    buffer_load_dwordx4 v[140:143], v250, s[24:27], s69 offen offset:1024 sc1
    buffer_load_dwordx4 v[144:147], v250, s[24:27], s69 offen offset:1536 sc1
    s_mov_b64 exec, -1
    v_exp_f32 v107, v107
    v_exp_f32 v108, v108
    v_mfma_f32_32x32x16_bf16 v[120:135], v[148:151], v[20:23], v[56:71]
    v_exp_f32 v109, v109
    v_exp_f32 v110, v110
    v_exp_f32 v111, v111
    v_exp_f32 v112, v112
    v_exp_f32 v113, v113
    v_smfmac_f32_32x32x32_bf16 v[72:87], v[152:155], v[104:111], v251
    v_exp_f32 v114, v114
    v_exp_f32 v115, v115
    v_exp_f32 v116, v116
    v_exp_f32 v117, v117
    v_exp_f32 v118, v118
    v_exp_f32 v119, v119
    v_exp_f32 v120, v120
    v_exp_f32 v121, v121
    v_smfmac_f32_32x32x32_bf16 v[72:87], v[156:159], v[112:119], v251
    v_exp_f32 v122, v122
    v_exp_f32 v123, v123
    s_waitcnt vmcnt(3)
    v_exp_f32 v124, v124
    v_mfma_f32_32x32x16_bf16 v[104:119], v[160:163], v[16:19], v[40:55]
    v_exp_f32 v125, v125
    v_exp_f32 v126, v126
    v_exp_f32 v127, v127
    v_exp_f32 v128, v128
    v_exp_f32 v129, v129
    v_smfmac_f32_32x32x32_bf16 v[88:103], v[152:155], v[120:127], v251
    v_exp_f32 v130, v130
    v_exp_f32 v131, v131
    v_exp_f32 v132, v132
    v_exp_f32 v133, v133
    v_exp_f32 v134, v134
    v_exp_f32 v135, v135
    v_exp_f32 v104, v104
    v_exp_f32 v105, v105
    v_smfmac_f32_32x32x32_bf16 v[88:103], v[156:159], v[128:135], v251
    v_exp_f32 v106, v106
    buffer_load_dwordx4 v[148:151], v8, s[24:27], s69 offen offset:2048 sc1
    s_mov_b64 exec, s[66:67]
    buffer_load_dwordx4 v[152:155], v250, s[24:27], s69 offen offset:3072 sc1
    buffer_load_dwordx4 v[156:159], v250, s[24:27], s69 offen offset:3584 sc1
    s_mov_b64 exec, -1
    s_add_u32 s69, s69, 4096
    s_and_b32 s69, s69, 0x1ffff
    v_exp_f32 v107, v107
    v_exp_f32 v108, v108
    v_mfma_f32_32x32x16_bf16 v[120:135], v[160:163], v[20:23], v[56:71]
    v_exp_f32 v109, v109
    v_exp_f32 v110, v110
    v_exp_f32 v111, v111
    v_exp_f32 v112, v112
    v_exp_f32 v113, v113
    v_smfmac_f32_32x32x32_bf16 v[72:87], v[164:167], v[104:111], v251
    v_exp_f32 v114, v114
    v_exp_f32 v115, v115
    v_exp_f32 v116, v116
    v_exp_f32 v117, v117
    v_exp_f32 v118, v118
    v_exp_f32 v119, v119
    v_exp_f32 v120, v120
    v_exp_f32 v121, v121
    v_smfmac_f32_32x32x32_bf16 v[72:87], v[168:171], v[112:119], v251
    v_exp_f32 v122, v122
    v_exp_f32 v123, v123
    s_waitcnt vmcnt(3)
    v_exp_f32 v124, v124
    v_mfma_f32_32x32x16_bf16 v[104:119], v[136:139], v[16:19], v[40:55]
    v_exp_f32 v125, v125
    v_exp_f32 v126, v126
    v_exp_f32 v127, v127
    v_exp_f32 v128, v128
    v_exp_f32 v129, v129
    v_smfmac_f32_32x32x32_bf16 v[88:103], v[164:167], v[120:127], v251
    v_exp_f32 v130, v130
    v_bfe_u32 v14, v1, 2, 2
    v_lshrrev_b32 v15, 5, v1
    v_lshl_add_u32 v14, v15, 2, v14
    v_lshlrev_b32 v12, 7, v14
    s_lshr_b32 s75, s4, 1
    v_bfe_u32 v14, v1, 3, 1
    v_xor_b32 v14, s75, v14
    v_lshl_add_u32 v12, v14, 6, v12
    v_and_b32 v14, 1, v1
    v_lshl_add_u32 v12, v14, 5, v12
    s_and_b32 s75, s4, 1
    v_bfe_u32 v14, v1, 4, 1
    v_xor_b32 v14, s75, v14
    v_lshl_add_u32 v12, v14, 4, v12
    v_bfe_u32 v14, v1, 1, 1
    v_lshl_add_u32 v12, v14, 3, v12
    s_lshl_b32 s75, s4, 14
    s_add_u32 s75, s75, 65536
    v_add_u32 v12, s75, v12
    v_xor_b32 v13, 64, v12
    s_mov_b64 exec, 1
    s_mov_b32 s78, 33554432
L_cw_10:
    ds_read_b32 v15, v254 offset:8
    s_sub_u32 s78, s78, 1
    s_cbranch_scc1 L_cwd_11
    s_waitcnt lgkmcnt(0)
    v_cmp_gt_u32 vcc, 4, v15
    s_nop 0
    s_cbranch_vccnz L_cw_10
L_cwd_11:
    s_mov_b64 exec, -1
    ds_read_b64_tr_b16 v[184:185], v12 offset:0
    ds_read_b64_tr_b16 v[186:187], v12 offset:1024
    ds_read_b64_tr_b16 v[188:189], v12 offset:2048
    ds_read_b64_tr_b16 v[190:191], v12 offset:3072
    ds_read_b64_tr_b16 v[192:193], v12 offset:4096
    ds_read_b64_tr_b16 v[194:195], v12 offset:5120
    ds_read_b64_tr_b16 v[196:197], v12 offset:6144
    ds_read_b64_tr_b16 v[198:199], v12 offset:7168
    ds_read_b64_tr_b16 v[200:201], v12 offset:8192
    ds_read_b64_tr_b16 v[202:203], v12 offset:9216
    ds_read_b64_tr_b16 v[204:205], v12 offset:10240
    ds_read_b64_tr_b16 v[206:207], v12 offset:11264
    ds_read_b64_tr_b16 v[208:209], v12 offset:12288
    ds_read_b64_tr_b16 v[210:211], v12 offset:13312
    ds_read_b64_tr_b16 v[212:213], v12 offset:14336
    ds_read_b64_tr_b16 v[214:215], v12 offset:15360
    v_exp_f32 v131, v131
    v_exp_f32 v132, v132
    v_exp_f32 v133, v133
    v_exp_f32 v134, v134
    v_exp_f32 v135, v135
    v_exp_f32 v104, v104
    v_exp_f32 v105, v105
    v_smfmac_f32_32x32x32_bf16 v[88:103], v[168:171], v[128:135], v251
    v_exp_f32 v106, v106
    buffer_load_dwordx4 v[160:163], v8, s[24:27], s69 offen offset:0 sc1
    s_mov_b64 exec, s[66:67]
    buffer_load_dwordx4 v[164:167], v250, s[24:27], s69 offen offset:1024 sc1
    buffer_load_dwordx4 v[168:171], v250, s[24:27], s69 offen offset:1536 sc1
    s_mov_b64 exec, -1
    v_exp_f32 v107, v107
    v_exp_f32 v108, v108
    v_mfma_f32_32x32x16_bf16 v[120:135], v[136:139], v[20:23], v[56:71]
    v_exp_f32 v109, v109
    v_exp_f32 v110, v110
    v_exp_f32 v111, v111
    v_exp_f32 v112, v112
    v_exp_f32 v113, v113
    v_smfmac_f32_32x32x32_bf16 v[72:87], v[140:143], v[104:111], v251
    v_exp_f32 v114, v114
    v_exp_f32 v115, v115
    v_exp_f32 v116, v116
    v_exp_f32 v117, v117
    v_exp_f32 v118, v118
    v_exp_f32 v119, v119
    v_exp_f32 v120, v120
    v_exp_f32 v121, v121
    v_smfmac_f32_32x32x32_bf16 v[72:87], v[144:147], v[112:119], v251
    v_exp_f32 v122, v122
    v_exp_f32 v123, v123
    s_waitcnt vmcnt(3)
    v_exp_f32 v124, v124
    v_mfma_f32_32x32x16_bf16 v[104:119], v[148:151], v[16:19], v[40:55]
    v_exp_f32 v125, v125
    v_exp_f32 v126, v126
    v_exp_f32 v127, v127
    v_exp_f32 v128, v128
    v_exp_f32 v129, v129
    v_smfmac_f32_32x32x32_bf16 v[88:103], v[140:143], v[120:127], v251
    v_exp_f32 v130, v130
    ds_read_b64_tr_b16 v[216:217], v13 offset:0
    ds_read_b64_tr_b16 v[218:219], v13 offset:1024
    ds_read_b64_tr_b16 v[220:221], v13 offset:2048
    ds_read_b64_tr_b16 v[222:223], v13 offset:3072
    ds_read_b64_tr_b16 v[224:225], v13 offset:4096
    ds_read_b64_tr_b16 v[226:227], v13 offset:5120
    ds_read_b64_tr_b16 v[228:229], v13 offset:6144
    ds_read_b64_tr_b16 v[230:231], v13 offset:7168
    ds_read_b64_tr_b16 v[232:233], v13 offset:8192
    ds_read_b64_tr_b16 v[234:235], v13 offset:9216
    ds_read_b64_tr_b16 v[236:237], v13 offset:10240
    ds_read_b64_tr_b16 v[238:239], v13 offset:11264
    ds_read_b64_tr_b16 v[240:241], v13 offset:12288
    ds_read_b64_tr_b16 v[242:243], v13 offset:13312
    ds_read_b64_tr_b16 v[244:245], v13 offset:14336
    ds_read_b64_tr_b16 v[246:247], v13 offset:15360
    v_exp_f32 v131, v131
    v_exp_f32 v132, v132
    v_exp_f32 v133, v133
    v_exp_f32 v134, v134
    v_exp_f32 v135, v135
    v_exp_f32 v104, v104
    v_exp_f32 v105, v105
    v_smfmac_f32_32x32x32_bf16 v[88:103], v[144:147], v[128:135], v251
    v_exp_f32 v106, v106
    buffer_load_dwordx4 v[136:139], v8, s[24:27], s69 offen offset:2048 sc1
    s_mov_b64 exec, s[66:67]
    buffer_load_dwordx4 v[140:143], v250, s[24:27], s69 offen offset:3072 sc1
    buffer_load_dwordx4 v[144:147], v250, s[24:27], s69 offen offset:3584 sc1
    s_mov_b64 exec, -1
    s_add_u32 s69, s69, 4096
    s_and_b32 s69, s69, 0x1ffff
    v_exp_f32 v107, v107
    v_exp_f32 v108, v108
    v_mfma_f32_32x32x16_bf16 v[120:135], v[148:151], v[20:23], v[56:71]
    v_exp_f32 v109, v109
    v_exp_f32 v110, v110
    v_exp_f32 v111, v111
    v_exp_f32 v112, v112
    v_exp_f32 v113, v113
    v_smfmac_f32_32x32x32_bf16 v[72:87], v[152:155], v[104:111], v251
    v_exp_f32 v114, v114
    v_exp_f32 v115, v115
    v_exp_f32 v116, v116
    v_exp_f32 v117, v117
    v_exp_f32 v118, v118
    v_exp_f32 v119, v119
    v_exp_f32 v120, v120
    v_exp_f32 v121, v121
    v_smfmac_f32_32x32x32_bf16 v[72:87], v[156:159], v[112:119], v251
    v_exp_f32 v122, v122
    v_exp_f32 v123, v123
    s_waitcnt vmcnt(3)
    v_exp_f32 v124, v124
    v_mfma_f32_32x32x16_bf16 v[104:119], v[160:163], v[16:19], v[40:55]
    v_exp_f32 v125, v125
    v_exp_f32 v126, v126
    v_exp_f32 v127, v127
    v_exp_f32 v128, v128
    v_exp_f32 v129, v129
    v_smfmac_f32_32x32x32_bf16 v[88:103], v[152:155], v[120:127], v251
    v_exp_f32 v130, v130
    s_waitcnt lgkmcnt(0)
    s_mov_b64 exec, 1
    ds_add_u32 v254, v253 offset:28
    s_mov_b64 exec, -1
    v_exp_f32 v131, v131
    v_exp_f32 v132, v132
    v_exp_f32 v133, v133
    v_exp_f32 v134, v134
    v_exp_f32 v135, v135
    v_exp_f32 v104, v104
    v_exp_f32 v105, v105
    v_smfmac_f32_32x32x32_bf16 v[88:103], v[156:159], v[128:135], v251
    v_exp_f32 v106, v106
    buffer_load_dwordx4 v[148:151], v8, s[24:27], s69 offen offset:0 sc1
    s_mov_b64 exec, s[66:67]
    buffer_load_dwordx4 v[152:155], v250, s[24:27], s69 offen offset:1024 sc1
    buffer_load_dwordx4 v[156:159], v250, s[24:27], s69 offen offset:1536 sc1
    s_mov_b64 exec, -1
    v_exp_f32 v107, v107
    v_exp_f32 v108, v108
    v_mfma_f32_32x32x16_bf16 v[120:135], v[160:163], v[20:23], v[56:71]
    v_exp_f32 v109, v109
    v_exp_f32 v110, v110
    v_exp_f32 v111, v111
    v_exp_f32 v112, v112
    v_exp_f32 v113, v113
    v_smfmac_f32_32x32x32_bf16 v[72:87], v[164:167], v[104:111], v251
    v_exp_f32 v114, v114
    v_exp_f32 v115, v115
    v_exp_f32 v116, v116
    v_exp_f32 v117, v117
    v_exp_f32 v118, v118
    v_exp_f32 v119, v119
    v_exp_f32 v120, v120
    v_exp_f32 v121, v121
    v_smfmac_f32_32x32x32_bf16 v[72:87], v[168:171], v[112:119], v251
    v_exp_f32 v122, v122
    v_exp_f32 v123, v123
    s_waitcnt vmcnt(3)
    v_exp_f32 v124, v124
    v_mfma_f32_32x32x16_bf16 v[104:119], v[136:139], v[16:19], v[40:55]
    v_exp_f32 v125, v125
    v_exp_f32 v126, v126
    v_exp_f32 v127, v127
    v_exp_f32 v128, v128
    v_exp_f32 v129, v129
    v_smfmac_f32_32x32x32_bf16 v[88:103], v[164:167], v[120:127], v251
    v_exp_f32 v130, v130
    v_exp_f32 v131, v131
    v_exp_f32 v132, v132
    v_exp_f32 v133, v133
    v_exp_f32 v134, v134
    v_exp_f32 v135, v135
    v_exp_f32 v104, v104
    v_exp_f32 v105, v105
    v_smfmac_f32_32x32x32_bf16 v[88:103], v[168:171], v[128:135], v251
    v_exp_f32 v106, v106
    buffer_load_dwordx4 v[160:163], v8, s[24:27], s69 offen offset:2048 sc1
    s_mov_b64 exec, s[66:67]
    buffer_load_dwordx4 v[164:167], v250, s[24:27], s69 offen offset:3072 sc1
    buffer_load_dwordx4 v[168:171], v250, s[24:27], s69 offen offset:3584 sc1
    s_mov_b64 exec, -1
    s_add_u32 s69, s69, 4096
    s_and_b32 s69, s69, 0x1ffff
    v_exp_f32 v107, v107
    v_exp_f32 v108, v108
    v_mfma_f32_32x32x16_bf16 v[120:135], v[136:139], v[20:23], v[56:71]
    v_exp_f32 v109, v109
    v_exp_f32 v110, v110
    v_exp_f32 v111, v111
    v_exp_f32 v112, v112
    v_exp_f32 v113, v113
    v_smfmac_f32_32x32x32_bf16 v[72:87], v[140:143], v[104:111], v251
    v_exp_f32 v114, v114
    v_exp_f32 v115, v115
    v_exp_f32 v116, v116
    v_exp_f32 v117, v117
    v_exp_f32 v118, v118
    v_exp_f32 v119, v119
    v_exp_f32 v120, v120
    v_exp_f32 v121, v121
    v_smfmac_f32_32x32x32_bf16 v[72:87], v[144:147], v[112:119], v251
    v_exp_f32 v122, v122
    v_exp_f32 v123, v123
    s_waitcnt vmcnt(3)
    v_exp_f32 v124, v124
    v_mfma_f32_32x32x16_bf16 v[104:119], v[148:151], v[16:19], v[40:55]
    v_exp_f32 v125, v125
    v_exp_f32 v126, v126
    v_exp_f32 v127, v127
    v_exp_f32 v128, v128
    v_exp_f32 v129, v129
    v_smfmac_f32_32x32x32_bf16 v[88:103], v[140:143], v[120:127], v251
    v_exp_f32 v130, v130
    v_exp_f32 v131, v131
    v_exp_f32 v132, v132
    v_exp_f32 v133, v133
    v_exp_f32 v134, v134
    v_exp_f32 v135, v135
    v_exp_f32 v104, v104
    v_exp_f32 v105, v105
    v_smfmac_f32_32x32x32_bf16 v[88:103], v[144:147], v[128:135], v251
    v_exp_f32 v106, v106
    v_exp_f32 v107, v107
    v_exp_f32 v108, v108
    v_mfma_f32_32x32x16_bf16 v[120:135], v[148:151], v[20:23], v[56:71]
    v_exp_f32 v109, v109
    v_exp_f32 v110, v110
    v_exp_f32 v111, v111
    v_exp_f32 v112, v112
    v_exp_f32 v113, v113
    v_smfmac_f32_32x32x32_bf16 v[72:87], v[152:155], v[104:111], v251
    v_exp_f32 v114, v114
    v_exp_f32 v115, v115
    v_exp_f32 v116, v116
    v_exp_f32 v117, v117
    v_exp_f32 v118, v118
    v_exp_f32 v119, v119
    v_exp_f32 v120, v120
    v_exp_f32 v121, v121
    v_smfmac_f32_32x32x32_bf16 v[72:87], v[156:159], v[112:119], v251
    v_exp_f32 v122, v122
    v_exp_f32 v123, v123
    s_waitcnt vmcnt(0)
    v_exp_f32 v124, v124
    v_mfma_f32_32x32x16_bf16 v[104:119], v[160:163], v[16:19], v[40:55]
    v_exp_f32 v125, v125
    v_exp_f32 v126, v126
    v_exp_f32 v127, v127
    v_exp_f32 v128, v128
    v_exp_f32 v129, v129
    v_smfmac_f32_32x32x32_bf16 v[88:103], v[152:155], v[120:127], v251
    v_exp_f32 v130, v130
    s_mul_i32 s74, s4, 4608
    s_add_u32 s74, s74, 141312
    v_add_u32 v6, s74, v0
    v_lshl_add_u32 v7, v1, 2, s74
    s_lshl_b32 s74, s5, 3
    s_add_u32 s74, s74, s6
    s_lshl_b32 s74, s74, 2
    s_add_u32 s74, s74, s4
    s_mul_i32 s74, s74, 32
    s_add_u32 s74, s74, 11620352
    v_lshl_add_u32 v249, v1, 2, s74
    s_lshl_b32 s74, s5, 16
    s_lshl_b32 s75, s4, 13
    s_add_u32 s61, s74, s75
    s_add_u32 s61, s61, 6291456
    s_lshr_b32 s74, s6, 1
    s_and_b32 s75, s6, 1
    s_lshl_b32 s75, 1, s75
    s_cmp_eq_u32 s74, s4
    s_cselect_b32 s63, s75, 0
    v_exp_f32 v131, v131
    v_exp_f32 v132, v132
    v_exp_f32 v133, v133
    v_exp_f32 v134, v134
    v_exp_f32 v135, v135
    v_exp_f32 v104, v104
    v_exp_f32 v105, v105
    v_smfmac_f32_32x32x32_bf16 v[88:103], v[156:159], v[128:135], v251
    v_exp_f32 v106, v106
    v_exp_f32 v107, v107
    v_exp_f32 v108, v108
    v_mfma_f32_32x32x16_bf16 v[120:135], v[160:163], v[20:23], v[56:71]
    v_exp_f32 v109, v109
    v_exp_f32 v110, v110
    v_exp_f32 v111, v111
    v_exp_f32 v112, v112
    v_exp_f32 v113, v113
    v_smfmac_f32_32x32x32_bf16 v[72:87], v[164:167], v[104:111], v251
    v_exp_f32 v114, v114
    v_exp_f32 v115, v115
    v_exp_f32 v116, v116
    v_exp_f32 v117, v117
    v_exp_f32 v118, v118
    v_exp_f32 v119, v119
    v_exp_f32 v120, v120
    v_exp_f32 v121, v121
    v_smfmac_f32_32x32x32_bf16 v[72:87], v[168:171], v[112:119], v251
    v_exp_f32 v122, v122
    v_exp_f32 v123, v123
    v_exp_f32 v124, v124
    v_exp_f32 v125, v125
    v_exp_f32 v126, v126
    v_exp_f32 v127, v127
    v_exp_f32 v128, v128
    v_exp_f32 v129, v129
    v_smfmac_f32_32x32x32_bf16 v[88:103], v[164:167], v[120:127], v251
    v_exp_f32 v130, v130
    v_exp_f32 v131, v131
    v_exp_f32 v132, v132
    v_exp_f32 v133, v133
    v_exp_f32 v134, v134
    v_exp_f32 v135, v135
    s_nop 1
    v_smfmac_f32_32x32x32_bf16 v[88:103], v[168:171], v[128:135], v251
    s_branch L_tail
L_attA:
    s_mov_b32 s73, 0
    s_lshl_b32 s74, s7, 17
    v_add_u32 v8, s74, v0
    v_lshrrev_b32 v2, 5, v1
    v_and_b32 v14, 15, v1
    v_lshlrev_b32 v14, 4, v14
    v_lshl_add_u32 v250, v2, 8, v14
    v_add_u32 v250, s74, v250
    v_mov_b32 v251, 0xdddd
    s_mov_b32 s66, 0xffff
    s_mov_b32 s67, 0xffff
    s_mov_b32 s83, 40
    s_and_b32 s79, s5, 7
    s_lshl_b32 s79, s79, 14
    s_add_u32 s79, s79, 49152
    s_and_b32 s79, s79, 0x1ffff
    v_lshrrev_b32 v2, 3, v1
    v_bfe_u32 v14, v1, 4, 1
    v_lshlrev_b32 v14, 2, v14
    v_and_b32 v15, 7, v1
    v_xor_b32 v14, v14, v15
    v_lshlrev_b32 v14, 4, v14
    v_lshl_add_u32 v5, v2, 10, v14
    s_lshl_b32 s74, s6, 7
    s_lshl_b32 s75, s4, 17
    s_add_u32 s74, s74, s75
    v_add_u32 v5, s74, v5
    s_and_b32 s71, s5, 7
    s_lshl_b32 s71, s71, 1
    s_lshl_b32 s72, s4, 14
    s_mov_b32 s69, s79
    v_and_b32 v2, 27, v1
    v_cmp_eq_u32 vcc, 16, v2
    v_mov_b32 v2, 0x3f803f80
    s_nop 0
    v_cndmask_b32 v2, 0, v2, vcc
    v_mov_b32 v140, v2
    v_mov_b32 v141, v2
    v_mov_b32 v142, v2
    v_mov_b32 v143, v2
    v_mov_b32 v144, v2
    v_mov_b32 v145, v2
    v_mov_b32 v146, v2
    v_mov_b32 v147, v2
    v_mov_b32 v152, v2
    v_mov_b32 v153, v2
    v_mov_b32 v154, v2
    v_mov_b32 v155, v2
    v_mov_b32 v156, v2
    v_mov_b32 v157, v2
    v_mov_b32 v158, v2
    v_mov_b32 v159, v2
    v_mov_b32 v164, v2
    v_mov_b32 v165, v2
    v_mov_b32 v166, v2
    v_mov_b32 v167, v2
    v_mov_b32 v168, v2
    v_mov_b32 v169, v2
    v_mov_b32 v170, v2
    v_mov_b32 v171, v2
    v_mov_b32 v176, v2
    v_mov_b32 v177, v2
    v_mov_b32 v178, v2
    v_mov_b32 v179, v2
    v_mov_b32 v180, v2
    v_mov_b32 v181, v2
    v_mov_b32 v182, v2
    v_mov_b32 v183, v2
    buffer_load_dwordx4 v[136:139], v8, s[24:27], s69 offen offset:0 sc1
    s_mov_b64 exec, s[66:67]
    buffer_load_dwordx4 v[140:143], v250, s[24:27], s69 offen offset:1024 sc1
    buffer_load_dwordx4 v[144:147], v250, s[24:27], s69 offen offset:1536 sc1
    s_mov_b64 exec, -1
    buffer_load_dwordx4 v[148:151], v8, s[24:27], s69 offen offset:2048 sc1
    s_mov_b64 exec, s[66:67]
    buffer_load_dwordx4 v[152:155], v250, s[24:27], s69 offen offset:3072 sc1
    buffer_load_dwordx4 v[156:159], v250, s[24:27], s69 offen offset:3584 sc1
    s_mov_b64 exec, -1
    s_add_u32 s69, s69, 4096
    s_and_b32 s69, s69, 0x1ffff
    buffer_load_dwordx4 v[160:163], v8, s[24:27], s69 offen offset:0 sc1
    s_mov_b64 exec, s[66:67]
    buffer_load_dwordx4 v[164:167], v250, s[24:27], s69 offen offset:1024 sc1
    buffer_load_dwordx4 v[168:171], v250, s[24:27], s69 offen offset:1536 sc1
    s_mov_b64 exec, -1
    v_mov_b32 v72, 0
    v_mov_b32 v73, 0
    v_mov_b32 v74, 0
    v_mov_b32 v75, 0
    v_mov_b32 v76, 0
    v_mov_b32 v77, 0
    v_mov_b32 v78, 0
    v_mov_b32 v79, 0
    v_mov_b32 v80, 0
    v_mov_b32 v81, 0
    v_mov_b32 v82, 0
    v_mov_b32 v83, 0
    v_mov_b32 v84, 0
    v_mov_b32 v85, 0
    v_mov_b32 v86, 0
    v_mov_b32 v87, 0
    v_mov_b32 v88, 0
    v_mov_b32 v89, 0
    v_mov_b32 v90, 0
    v_mov_b32 v91, 0
    v_mov_b32 v92, 0
    v_mov_b32 v93, 0
    v_mov_b32 v94, 0
    v_mov_b32 v95, 0
    v_mov_b32 v96, 0
    v_mov_b32 v97, 0
    v_mov_b32 v98, 0
    v_mov_b32 v99, 0
    v_mov_b32 v100, 0
    v_mov_b32 v101, 0
    v_mov_b32 v102, 0
    v_mov_b32 v103, 0
    s_waitcnt vmcnt(6)
    v_mfma_f32_32x32x16_bf16 v[104:119], v[136:139], v[16:19], v[40:55]
    s_setprio 3
    s_nop 10
    v_exp_f32 v104, v104
    v_exp_f32 v105, v105
    v_exp_f32 v106, v106
    buffer_load_dwordx4 v[172:175], v8, s[24:27], s69 offen offset:2048 sc1
    s_mov_b64 exec, s[66:67]
    buffer_load_dwordx4 v[176:179], v250, s[24:27], s69 offen offset:3072 sc1
    buffer_load_dwordx4 v[180:183], v250, s[24:27], s69 offen offset:3584 sc1
    s_mov_b64 exec, -1
    s_add_u32 s69, s69, 4096
    s_and_b32 s69, s69, 0x1ffff
    v_exp_f32 v107, v107
    v_exp_f32 v108, v108
    v_mfma_f32_32x32x16_bf16 v[120:135], v[136:139], v[20:23], v[56:71]
    v_exp_f32 v109, v109
    v_exp_f32 v110, v110
    v_exp_f32 v111, v111
    v_exp_f32 v112, v112
    v_exp_f32 v113, v113
    v_smfmac_f32_32x32x32_bf16 v[72:87], v[140:143], v[104:111], v251
    v_exp_f32 v114, v114
    v_exp_f32 v115, v115
    v_exp_f32 v116, v116
    v_exp_f32 v117, v117
    v_exp_f32 v118, v118
    v_exp_f32 v119, v119
    v_exp_f32 v120, v120
    v_exp_f32 v121, v121
    v_smfmac_f32_32x32x32_bf16 v[72:87], v[144:147], v[112:119], v251
    v_exp_f32 v122, v122
    v_exp_f32 v123, v123
    s_waitcnt vmcnt(6)
    v_exp_f32 v124, v124
    v_mfma_f32_32x32x16_bf16 v[104:119], v[148:151], v[16:19], v[40:55]
    v_exp_f32 v125, v125
    v_exp_f32 v126, v126
    v_exp_f32 v127, v127
    v_exp_f32 v128, v128
    v_exp_f32 v129, v129
    v_smfmac_f32_32x32x32_bf16 v[88:103], v[140:143], v[120:127], v251
    v_exp_f32 v130, v130
    s_lshl_b32 s74, s7, 7
    s_lshl_b32 s75, s5, 2
    s_add_u32 s74, s74, s75
    s_add_u32 s74, s74, 11599872
    v_mov_b32 v9, s74
    v_mov_b32 v15, 1
    s_mov_b32 exec_lo, 1
    s_mov_b32 exec_hi, 0
    buffer_store_dword v15, v9, s[24:27], 0 offen sc1
    s_mov_b64 exec, -1
    v_exp_f32 v131, v131
    v_exp_f32 v132, v132
    v_exp_f32 v133, v133
    v_exp_f32 v134, v134
    v_exp_f32 v135, v135
    v_exp_f32 v104, v104
    v_exp_f32 v105, v105
    v_smfmac_f32_32x32x32_bf16 v[88:103], v[144:147], v[128:135], v251
    v_exp_f32 v106, v106
    buffer_load_dwordx4 v[136:139], v8, s[24:27], s69 offen offset:0 sc1
    s_mov_b64 exec, s[66:67]
    buffer_load_dwordx4 v[140:143], v250, s[24:27], s69 offen offset:1024 sc1
    buffer_load_dwordx4 v[144:147], v250, s[24:27], s69 offen offset:1536 sc1
    s_mov_b64 exec, -1
    v_exp_f32 v107, v107
    v_exp_f32 v108, v108
    v_mfma_f32_32x32x16_bf16 v[120:135], v[148:151], v[20:23], v[56:71]
    v_exp_f32 v109, v109
    v_exp_f32 v110, v110
    v_exp_f32 v111, v111
    v_exp_f32 v112, v112
    v_exp_f32 v113, v113
    v_smfmac_f32_32x32x32_bf16 v[72:87], v[152:155], v[104:111], v251
    v_exp_f32 v114, v114
    v_exp_f32 v115, v115
    v_exp_f32 v116, v116
    v_exp_f32 v117, v117
    v_exp_f32 v118, v118
    v_exp_f32 v119, v119
    v_exp_f32 v120, v120
    v_exp_f32 v121, v121
    v_smfmac_f32_32x32x32_bf16 v[72:87], v[156:159], v[112:119], v251
    v_exp_f32 v122, v122
    v_exp_f32 v123, v123
    s_waitcnt vmcnt(7)
    v_exp_f32 v124, v124
    v_mfma_f32_32x32x16_bf16 v[104:119], v[160:163], v[16:19], v[40:55]
    v_exp_f32 v125, v125
    v_exp_f32 v126, v126
    v_exp_f32 v127, v127
    v_exp_f32 v128, v128
    v_exp_f32 v129, v129
    v_smfmac_f32_32x32x32_bf16 v[88:103], v[152:155], v[120:127], v251
    v_exp_f32 v130, v130
    s_lshl_b32 s74, s71, 10
    s_add_u32 m0, s74, s72
    s_lshl_b32 s75, s71, 13
    s_add_u32 s74, s74, 65536
    buffer_load_dwordx4 v5, s[32:35], s75 offen lds
    s_add_u32 m0, s74, s72
    s_add_u32 s71, s71, 1
    s_and_b32 s71, s71, 15
    buffer_load_dwordx4 v5, s[8:11], s75 offen lds
    v_exp_f32 v131, v131
    v_exp_f32 v132, v132
    v_exp_f32 v133, v133
    v_exp_f32 v134, v134
    v_exp_f32 v135, v135
    v_exp_f32 v104, v104
    v_exp_f32 v105, v105
    v_smfmac_f32_32x32x32_bf16 v[88:103], v[156:159], v[128:135], v251
    v_exp_f32 v106, v106
    buffer_load_dwordx4 v[148:151], v8, s[24:27], s69 offen offset:2048 sc1
    s_mov_b64 exec, s[66:67]
    buffer_load_dwordx4 v[152:155], v250, s[24:27], s69 offen offset:3072 sc1
    buffer_load_dwordx4 v[156:159], v250, s[24:27], s69 offen offset:3584 sc1
    s_mov_b64 exec, -1
    s_add_u32 s69, s69, 4096
    s_and_b32 s69, s69, 0x1ffff
    v_exp_f32 v107, v107
    v_exp_f32 v108, v108
    v_mfma_f32_32x32x16_bf16 v[120:135], v[160:163], v[20:23], v[56:71]
    v_exp_f32 v109, v109
    v_exp_f32 v110, v110
    v_exp_f32 v111, v111
    v_exp_f32 v112, v112
    v_exp_f32 v113, v113
    v_smfmac_f32_32x32x32_bf16 v[72:87], v[164:167], v[104:111], v251
    v_exp_f32 v114, v114
    v_exp_f32 v115, v115
    v_exp_f32 v116, v116
    v_exp_f32 v117, v117
    v_exp_f32 v118, v118
    v_exp_f32 v119, v119
    v_exp_f32 v120, v120
    v_exp_f32 v121, v121
    v_smfmac_f32_32x32x32_bf16 v[72:87], v[168:171], v[112:119], v251
    v_exp_f32 v122, v122
    v_exp_f32 v123, v123
    s_waitcnt vmcnt(9)
    v_exp_f32 v124, v124
    v_mfma_f32_32x32x16_bf16 v[104:119], v[172:175], v[16:19], v[40:55]
    v_exp_f32 v125, v125
    v_exp_f32 v126, v126
    v_exp_f32 v127, v127
    v_exp_f32 v128, v128
    v_exp_f32 v129, v129
    v_smfmac_f32_32x32x32_bf16 v[88:103], v[164:167], v[120:127], v251
    v_exp_f32 v130, v130
    s_lshl_b32 s74, s71, 10
    s_add_u32 m0, s74, s72
    s_lshl_b32 s75, s71, 13
    s_add_u32 s74, s74, 65536
    buffer_load_dwordx4 v5, s[32:35], s75 offen lds
    s_add_u32 m0, s74, s72
    s_add_u32 s71, s71, 1
    s_and_b32 s71, s71, 15
    buffer_load_dwordx4 v5, s[8:11], s75 offen lds
    v_exp_f32 v131, v131
    v_exp_f32 v132, v132
    v_exp_f32 v133, v133
    v_exp_f32 v134, v134
    v_exp_f32 v135, v135
    v_exp_f32 v104, v104
    v_exp_f32 v105, v105
    v_smfmac_f32_32x32x32_bf16 v[88:103], v[168:171], v[128:135], v251
    v_exp_f32 v106, v106
    buffer_load_dwordx4 v[160:163], v8, s[24:27], s69 offen offset:0 sc1
    s_mov_b64 exec, s[66:67]
    buffer_load_dwordx4 v[164:167], v250, s[24:27], s69 offen offset:1024 sc1
    buffer_load_dwordx4 v[168:171], v250, s[24:27], s69 offen offset:1536 sc1
    s_mov_b64 exec, -1
    v_exp_f32 v107, v107
    v_exp_f32 v108, v108
    v_mfma_f32_32x32x16_bf16 v[120:135], v[172:175], v[20:23], v[56:71]
    v_exp_f32 v109, v109
    v_exp_f32 v110, v110
    v_exp_f32 v111, v111
    v_exp_f32 v112, v112
    v_exp_f32 v113, v113
    v_smfmac_f32_32x32x32_bf16 v[72:87], v[176:179], v[104:111], v251
    v_exp_f32 v114, v114
    v_exp_f32 v115, v115
    v_exp_f32 v116, v116
    v_exp_f32 v117, v117
    v_exp_f32 v118, v118
    v_exp_f32 v119, v119
    v_exp_f32 v120, v120
    v_exp_f32 v121, v121
    v_smfmac_f32_32x32x32_bf16 v[72:87], v[180:183], v[112:119], v251
    v_exp_f32 v122, v122
    v_exp_f32 v123, v123
    s_waitcnt vmcnt(10)
    v_exp_f32 v124, v124
    v_mfma_f32_32x32x16_bf16 v[104:119], v[136:139], v[16:19], v[40:55]
    v_exp_f32 v125, v125
    v_exp_f32 v126, v126
    v_exp_f32 v127, v127
    v_exp_f32 v128, v128
    v_exp_f32 v129, v129
    v_smfmac_f32_32x32x32_bf16 v[88:103], v[176:179], v[120:127], v251
    v_exp_f32 v130, v130
    s_lshl_b32 s74, s71, 10
    s_add_u32 m0, s74, s72
    s_lshl_b32 s75, s71, 13
    s_add_u32 s74, s74, 65536
    buffer_load_dwordx4 v5, s[32:35], s75 offen lds
    s_add_u32 m0, s74, s72
    s_add_u32 s71, s71, 1
    s_and_b32 s71, s71, 15
    buffer_load_dwordx4 v5, s[8:11], s75 offen lds
    v_exp_f32 v131, v131
    v_exp_f32 v132, v132
    v_exp_f32 v133, v133
    v_exp_f32 v134, v134
    v_exp_f32 v135, v135
    v_exp_f32 v104, v104
    v_exp_f32 v105, v105
    v_smfmac_f32_32x32x32_bf16 v[88:103], v[180:183], v[128:135], v251
    v_exp_f32 v106, v106
    buffer_load_dwordx4 v[172:175], v8, s[24:27], s69 offen offset:2048 sc1
    s_mov_b64 exec, s[66:67]
    buffer_load_dwordx4 v[176:179], v250, s[24:27], s69 offen offset:3072 sc1
    buffer_load_dwordx4 v[180:183], v250, s[24:27], s69 offen offset:3584 sc1
    s_mov_b64 exec, -1
    s_add_u32 s69, s69, 4096
    s_and_b32 s69, s69, 0x1ffff
    v_exp_f32 v107, v107
    v_exp_f32 v108, v108
    v_mfma_f32_32x32x16_bf16 v[120:135], v[136:139], v[20:23], v[56:71]
    v_exp_f32 v109, v109
    v_exp_f32 v110, v110
    v_exp_f32 v111, v111
    v_exp_f32 v112, v112
    v_exp_f32 v113, v113
    v_smfmac_f32_32x32x32_bf16 v[72:87], v[140:143], v[104:111], v251
    v_exp_f32 v114, v114
    v_exp_f32 v115, v115
    v_exp_f32 v116, v116
    v_exp_f32 v117, v117
    v_exp_f32 v118, v118
    v_exp_f32 v119, v119
    v_exp_f32 v120, v120
    v_exp_f32 v121, v121
    v_smfmac_f32_32x32x32_bf16 v[72:87], v[144:147], v[112:119], v251
    v_exp_f32 v122, v122
    v_exp_f32 v123, v123
    s_waitcnt vmcnt(10)
    v_exp_f32 v124, v124
    v_mfma_f32_32x32x16_bf16 v[104:119], v[148:151], v[16:19], v[40:55]
    v_exp_f32 v125, v125
    v_exp_f32 v126, v126
    v_exp_f32 v127, v127
    v_exp_f32 v128, v128
    v_exp_f32 v129, v129
    v_smfmac_f32_32x32x32_bf16 v[88:103], v[140:143], v[120:127], v251
    v_exp_f32 v130, v130
    s_lshl_b32 s74, s71, 10
    s_add_u32 m0, s74, s72
    s_lshl_b32 s75, s71, 13
    s_add_u32 s74, s74, 65536
    buffer_load_dwordx4 v5, s[32:35], s75 offen lds
    s_add_u32 m0, s74, s72
    s_add_u32 s71, s71, 1
    s_and_b32 s71, s71, 15
    buffer_load_dwordx4 v5, s[8:11], s75 offen lds
    v_exp_f32 v131, v131
    v_exp_f32 v132, v132
    v_exp_f32 v133, v133
    v_exp_f32 v134, v134
    v_exp_f32 v135, v135
    v_exp_f32 v104, v104
    v_exp_f32 v105, v105
    v_smfmac_f32_32x32x32_bf16 v[88:103], v[144:147], v[128:135], v251
    v_exp_f32 v106, v106
    buffer_load_dwordx4 v[136:139], v8, s[24:27], s69 offen offset:0 sc1
    s_mov_b64 exec, s[66:67]
    buffer_load_dwordx4 v[140:143], v250, s[24:27], s69 offen offset:1024 sc1
    buffer_load_dwordx4 v[144:147], v250, s[24:27], s69 offen offset:1536 sc1
    s_mov_b64 exec, -1
    v_exp_f32 v107, v107
    v_exp_f32 v108, v108
    v_mfma_f32_32x32x16_bf16 v[120:135], v[148:151], v[20:23], v[56:71]
    v_exp_f32 v109, v109
    v_exp_f32 v110, v110
    v_exp_f32 v111, v111
    v_exp_f32 v112, v112
    v_exp_f32 v113, v113
    v_smfmac_f32_32x32x32_bf16 v[72:87], v[152:155], v[104:111], v251
    v_exp_f32 v114, v114
    v_exp_f32 v115, v115
    v_exp_f32 v116, v116
    v_exp_f32 v117, v117
    v_exp_f32 v118, v118
    v_exp_f32 v119, v119
    v_exp_f32 v120, v120
    v_exp_f32 v121, v121
    v_smfmac_f32_32x32x32_bf16 v[72:87], v[156:159], v[112:119], v251
    v_exp_f32 v122, v122
    v_exp_f32 v123, v123
    s_waitcnt vmcnt(10)
    v_exp_f32 v124, v124
    v_mfma_f32_32x32x16_bf16 v[104:119], v[160:163], v[16:19], v[40:55]
    v_exp_f32 v125, v125
    v_exp_f32 v126, v126
    v_exp_f32 v127, v127
    v_exp_f32 v128, v128
    v_exp_f32 v129, v129
    v_smfmac_f32_32x32x32_bf16 v[88:103], v[152:155], v[120:127], v251
    v_exp_f32 v130, v130
    s_lshl_b32 s74, s71, 10
    s_add_u32 m0, s74, s72
    s_lshl_b32 s75, s71, 13
    s_add_u32 s74, s74, 65536
    buffer_load_dwordx4 v5, s[32:35], s75 offen lds
    s_add_u32 m0, s74, s72
    s_add_u32 s71, s71, 1
    s_and_b32 s71, s71, 15
    buffer_load_dwordx4 v5, s[8:11], s75 offen lds
    v_exp_f32 v131, v131
    v_exp_f32 v132, v132
    v_exp_f32 v133, v133
    v_exp_f32 v134, v134
    v_exp_f32 v135, v135
    v_exp_f32 v104, v104
    v_exp_f32 v105, v105
    v_smfmac_f32_32x32x32_bf16 v[88:103], v[156:159], v[128:135], v251
    v_exp_f32 v106, v106
    buffer_load_dwordx4 v[148:151], v8, s[24:27], s69 offen offset:2048 sc1
    s_mov_b64 exec, s[66:67]
    buffer_load_dwordx4 v[152:155], v250, s[24:27], s69 offen offset:3072 sc1
    buffer_load_dwordx4 v[156:159], v250, s[24:27], s69 offen offset:3584 sc1
    s_mov_b64 exec, -1
    s_add_u32 s69, s69, 4096
    s_and_b32 s69, s69, 0x1ffff
    v_exp_f32 v107, v107
    v_exp_f32 v108, v108
    v_mfma_f32_32x32x16_bf16 v[120:135], v[160:163], v[20:23], v[56:71]
    v_exp_f32 v109, v109
    v_exp_f32 v110, v110
    v_exp_f32 v111, v111
    v_exp_f32 v112, v112
    v_exp_f32 v113, v113
    v_smfmac_f32_32x32x32_bf16 v[72:87], v[164:167], v[104:111], v251
    v_exp_f32 v114, v114
    v_exp_f32 v115, v115
    v_exp_f32 v116, v116
    v_exp_f32 v117, v117
    v_exp_f32 v118, v118
    v_exp_f32 v119, v119
    v_exp_f32 v120, v120
    v_exp_f32 v121, v121
    v_smfmac_f32_32x32x32_bf16 v[72:87], v[168:171], v[112:119], v251
    v_exp_f32 v122, v122
    v_exp_f32 v123, v123
    s_waitcnt vmcnt(10)
    v_exp_f32 v124, v124
    v_mfma_f32_32x32x16_bf16 v[104:119], v[172:175], v[16:19], v[40:55]
    v_exp_f32 v125, v125
    v_exp_f32 v126, v126
    v_exp_f32 v127, v127
    v_exp_f32 v128, v128
    v_exp_f32 v129, v129
    v_smfmac_f32_32x32x32_bf16 v[88:103], v[164:167], v[120:127], v251
    v_exp_f32 v130, v130
    s_lshl_b32 s74, s71, 10
    s_add_u32 m0, s74, s72
    s_lshl_b32 s75, s71, 13
    s_add_u32 s74, s74, 65536
    buffer_load_dwordx4 v5, s[32:35], s75 offen lds
    s_add_u32 m0, s74, s72
    s_add_u32 s71, s71, 1
    s_and_b32 s71, s71, 15
    buffer_load_dwordx4 v5, s[8:11], s75 offen lds
    v_exp_f32 v131, v131
    v_exp_f32 v132, v132
    v_exp_f32 v133, v133
    v_exp_f32 v134, v134
    v_exp_f32 v135, v135
    v_exp_f32 v104, v104
    v_exp_f32 v105, v105
    v_smfmac_f32_32x32x32_bf16 v[88:103], v[168:171], v[128:135], v251
    v_exp_f32 v106, v106
    buffer_load_dwordx4 v[160:163], v8, s[24:27], s69 offen offset:0 sc1
    s_mov_b64 exec, s[66:67]
    buffer_load_dwordx4 v[164:167], v250, s[24:27], s69 offen offset:1024 sc1
    buffer_load_dwordx4 v[168:171], v250, s[24:27], s69 offen offset:1536 sc1
    s_mov_b64 exec, -1
    v_exp_f32 v107, v107
    v_exp_f32 v108, v108
    v_mfma_f32_32x32x16_bf16 v[120:135], v[172:175], v[20:23], v[56:71]
    v_exp_f32 v109, v109
    v_exp_f32 v110, v110
    v_exp_f32 v111, v111
    v_exp_f32 v112, v112
    v_exp_f32 v113, v113
    v_smfmac_f32_32x32x32_bf16 v[72:87], v[176:179], v[104:111], v251
    v_exp_f32 v114, v114
    v_exp_f32 v115, v115
    v_exp_f32 v116, v116
    v_exp_f32 v117, v117
    v_exp_f32 v118, v118
    v_exp_f32 v119, v119
    v_exp_f32 v120, v120
    v_exp_f32 v121, v121
    v_smfmac_f32_32x32x32_bf16 v[72:87], v[180:183], v[112:119], v251
    v_exp_f32 v122, v122
    v_exp_f32 v123, v123
    s_waitcnt vmcnt(10)
    v_exp_f32 v124, v124
    v_mfma_f32_32x32x16_bf16 v[104:119], v[136:139], v[16:19], v[40:55]
    v_exp_f32 v125, v125
    v_exp_f32 v126, v126
    v_exp_f32 v127, v127
    v_exp_f32 v128, v128
    v_exp_f32 v129, v129
    v_smfmac_f32_32x32x32_bf16 v[88:103], v[176:179], v[120:127], v251
    v_exp_f32 v130, v130
    s_lshl_b32 s74, s71, 10
    s_add_u32 m0, s74, s72
    s_lshl_b32 s75, s71, 13
    s_add_u32 s74, s74, 65536
    buffer_load_dwordx4 v5, s[32:35], s75 offen lds
    s_add_u32 m0, s74, s72
    s_add_u32 s71, s71, 1
    s_and_b32 s71, s71, 15
    buffer_load_dwordx4 v5, s[8:11], s75 offen lds
    v_exp_f32 v131, v131
    v_exp_f32 v132, v132
    v_exp_f32 v133, v133
    v_exp_f32 v134, v134
    v_exp_f32 v135, v135
    v_exp_f32 v104, v104
    v_exp_f32 v105, v105
    v_smfmac_f32_32x32x32_bf16 v[88:103], v[180:183], v[128:135], v251
    v_exp_f32 v106, v106
    buffer_load_dwordx4 v[172:175], v8, s[24:27], s69 offen offset:2048 sc1
    s_mov_b64 exec, s[66:67]
    buffer_load_dwordx4 v[176:179], v250, s[24:27], s69 offen offset:3072 sc1
    buffer_load_dwordx4 v[180:183], v250, s[24:27], s69 offen offset:3584 sc1
    s_mov_b64 exec, -1
    s_add_u32 s69, s69, 4096
    s_and_b32 s69, s69, 0x1ffff
    v_exp_f32 v107, v107
    v_exp_f32 v108, v108
    v_mfma_f32_32x32x16_bf16 v[120:135], v[136:139], v[20:23], v[56:71]
    v_exp_f32 v109, v109
    v_exp_f32 v110, v110
    v_exp_f32 v111, v111
    v_exp_f32 v112, v112
    v_exp_f32 v113, v113
    v_smfmac_f32_32x32x32_bf16 v[72:87], v[140:143], v[104:111], v251
    v_exp_f32 v114, v114
    v_exp_f32 v115, v115
    v_exp_f32 v116, v116
    v_exp_f32 v117, v117
    v_exp_f32 v118, v118
    v_exp_f32 v119, v119
    v_exp_f32 v120, v120
    v_exp_f32 v121, v121
    v_smfmac_f32_32x32x32_bf16 v[72:87], v[144:147], v[112:119], v251
    v_exp_f32 v122, v122
    v_exp_f32 v123, v123
    s_waitcnt vmcnt(10)
    v_exp_f32 v124, v124
    v_mfma_f32_32x32x16_bf16 v[104:119], v[148:151], v[16:19], v[40:55]
    v_exp_f32 v125, v125
    v_exp_f32 v126, v126
    v_exp_f32 v127, v127
    v_exp_f32 v128, v128
    v_exp_f32 v129, v129
    v_smfmac_f32_32x32x32_bf16 v[88:103], v[140:143], v[120:127], v251
    v_exp_f32 v130, v130
    s_lshr_b32 s74, s5, 3
    s_lshl_b32 s75, s6, 2
    s_add_u32 s90, s74, s75
    s_lshl_b32 s75, s90, 7
    s_lshl_b32 s74, s4, 5
    s_add_u32 s75, s75, s74
    s_add_u32 s75, s75, 11599872
    v_lshl_add_u32 v9, v1, 2, s75
    s_mov_b64 exec, 0xff
    buffer_load_dword v10, v9, s[24:27], 0 offen sc1
    s_mov_b64 exec, -1
    s_lshl_b32 s74, s71, 10
    s_add_u32 m0, s74, s72
    s_lshl_b32 s75, s71, 13
    s_add_u32 s74, s74, 65536
    buffer_load_dwordx4 v5, s[32:35], s75 offen lds
    s_add_u32 m0, s74, s72
    s_add_u32 s71, s71, 1
    s_and_b32 s71, s71, 15
    buffer_load_dwordx4 v5, s[8:11], s75 offen lds
    v_exp_f32 v131, v131
    v_exp_f32 v132, v132
    v_exp_f32 v133, v133
    v_exp_f32 v134, v134
    v_exp_f32 v135, v135
    v_exp_f32 v104, v104
    v_exp_f32 v105, v105
    v_smfmac_f32_32x32x32_bf16 v[88:103], v[144:147], v[128:135], v251
    v_exp_f32 v106, v106
    buffer_load_dwordx4 v[136:139], v8, s[24:27], s69 offen offset:0 sc1
    s_mov_b64 exec, s[66:67]
    buffer_load_dwordx4 v[140:143], v250, s[24:27], s69 offen offset:1024 sc1
    buffer_load_dwordx4 v[144:147], v250, s[24:27], s69 offen offset:1536 sc1
    s_mov_b64 exec, -1
    v_exp_f32 v107, v107
    v_exp_f32 v108, v108
    v_mfma_f32_32x32x16_bf16 v[120:135], v[148:151], v[20:23], v[56:71]
    v_exp_f32 v109, v109
    v_exp_f32 v110, v110
    v_exp_f32 v111, v111
    v_exp_f32 v112, v112
    v_exp_f32 v113, v113
    v_smfmac_f32_32x32x32_bf16 v[72:87], v[152:155], v[104:111], v251
    v_exp_f32 v114, v114
    v_exp_f32 v115, v115
    v_exp_f32 v116, v116
    v_exp_f32 v117, v117
    v_exp_f32 v118, v118
    v_exp_f32 v119, v119
    v_exp_f32 v120, v120
    v_exp_f32 v121, v121
    v_smfmac_f32_32x32x32_bf16 v[72:87], v[156:159], v[112:119], v251
    v_exp_f32 v122, v122
    v_exp_f32 v123, v123
    s_waitcnt vmcnt(11)
    v_exp_f32 v124, v124
    v_mfma_f32_32x32x16_bf16 v[104:119], v[160:163], v[16:19], v[40:55]
    v_exp_f32 v125, v125
    v_exp_f32 v126, v126
    v_exp_f32 v127, v127
    v_exp_f32 v128, v128
    v_exp_f32 v129, v129
    v_smfmac_f32_32x32x32_bf16 v[88:103], v[152:155], v[120:127], v251
    v_exp_f32 v130, v130
    s_lshl_b32 s74, s71, 10
    s_add_u32 m0, s74, s72
    s_lshl_b32 s75, s71, 13
    s_add_u32 s74, s74, 65536
    buffer_load_dwordx4 v5, s[32:35], s75 offen lds
    s_add_u32 m0, s74, s72
    s_add_u32 s71, s71, 1
    s_and_b32 s71, s71, 15
    buffer_load_dwordx4 v5, s[8:11], s75 offen lds
    v_exp_f32 v131, v131
    v_exp_f32 v132, v132
    v_exp_f32 v133, v133
    v_exp_f32 v134, v134
    v_exp_f32 v135, v135
    v_exp_f32 v104, v104
    v_exp_f32 v105, v105
    v_smfmac_f32_32x32x32_bf16 v[88:103], v[156:159], v[128:135], v251
    v_exp_f32 v106, v106
    buffer_load_dwordx4 v[148:151], v8, s[24:27], s69 offen offset:2048 sc1
    s_mov_b64 exec, s[66:67]
    buffer_load_dwordx4 v[152:155], v250, s[24:27], s69 offen offset:3072 sc1
    buffer_load_dwordx4 v[156:159], v250, s[24:27], s69 offen offset:3584 sc1
    s_mov_b64 exec, -1
    s_add_u32 s69, s69, 4096
    s_and_b32 s69, s69, 0x1ffff
    v_exp_f32 v107, v107
    v_exp_f32 v108, v108
    v_mfma_f32_32x32x16_bf16 v[120:135], v[160:163], v[20:23], v[56:71]
    v_exp_f32 v109, v109
    v_exp_f32 v110, v110
    v_exp_f32 v111, v111
    v_exp_f32 v112, v112
    v_exp_f32 v113, v113
    v_smfmac_f32_32x32x32_bf16 v[72:87], v[164:167], v[104:111], v251
    v_exp_f32 v114, v114
    v_exp_f32 v115, v115
    v_exp_f32 v116, v116
    v_exp_f32 v117, v117
    v_exp_f32 v118, v118
    v_exp_f32 v119, v119
    v_exp_f32 v120, v120
    v_exp_f32 v121, v121
    v_smfmac_f32_32x32x32_bf16 v[72:87], v[168:171], v[112:119], v251
    v_exp_f32 v122, v122
    v_exp_f32 v123, v123
    s_waitcnt vmcnt(11)
    v_exp_f32 v124, v124
    v_mfma_f32_32x32x16_bf16 v[104:119], v[172:175], v[16:19], v[40:55]
    v_exp_f32 v125, v125
    v_exp_f32 v126, v126
    v_exp_f32 v127, v127
    v_exp_f32 v128, v128
    v_exp_f32 v129, v129
    v_smfmac_f32_32x32x32_bf16 v[88:103], v[164:167], v[120:127], v251
    v_exp_f32 v130, v130
    s_waitcnt vmcnt(10)
    s_mov_b32 exec_lo, 255
    s_mov_b32 exec_hi, 0
    s_mov_b32 s78, 2097152
    v_cmp_eq_u32 vcc, 0, v10
    s_nop 0
    s_cbranch_vccz L_polld_13
L_poll_12:
    buffer_load_dword v10, v9, s[24:27], 0 offen sc1
    s_sub_u32 s78, s78, 1
    s_cbranch_scc1 L_polld_13
    s_waitcnt vmcnt(0)
    v_cmp_eq_u32 vcc, 0, v10
    s_nop 0
    s_cbranch_vccnz L_poll_12
L_polld_13:
    s_mov_b64 exec, -1
    s_lshl_b32 s90, s90, 3
    s_and_b32 s75, s5, 7
    s_add_u32 s90, s90, s75
    s_mul_i32 s75, s90, 12288
    s_mul_i32 s74, s4, 3072
    s_add_u32 s75, s75, s74
    s_add_u32 s75, s75, 8388608
    v_lshrrev_b32 v10, 5, v1
    v_mul_u32_u24 v9, 384, v10
    v_and_b32 v11, 31, v1
    v_lshl_add_u32 v9, v11, 4, v9
    v_lshlrev_b32 v10, 2, v10
    v_lshl_add_u32 v10, v11, 3, v10
    s_mov_b32 exec_lo, 0x1ffff
    s_mov_b32 exec_hi, 0x1ffff
    buffer_load_dwordx4 v[184:187], v9, s[24:27], s75 offen offset:0 sc1
    buffer_load_dwordx4 v[188:191], v9, s[24:27], s75 offen offset:768 sc1
    buffer_load_dwordx4 v[192:195], v9, s[24:27], s75 offen offset:1536 sc1
    buffer_load_dwordx4 v[196:199], v9, s[24:27], s75 offen offset:2304 sc1
    s_mov_b64 exec, -1
    s_lshl_b32 s74, s71, 10
    s_add_u32 m0, s74, s72
    s_lshl_b32 s75, s71, 13
    s_add_u32 s74, s74, 65536
    buffer_load_dwordx4 v5, s[32:35], s75 offen lds
    s_add_u32 m0, s74, s72
    s_add_u32 s71, s71, 1
    s_and_b32 s71, s71, 15
    buffer_load_dwordx4 v5, s[8:11], s75 offen lds
    v_exp_f32 v131, v131
    v_exp_f32 v132, v132
    v_exp_f32 v133, v133
    v_exp_f32 v134, v134
    v_exp_f32 v135, v135
    v_exp_f32 v104, v104
    v_exp_f32 v105, v105
    v_smfmac_f32_32x32x32_bf16 v[88:103], v[168:171], v[128:135], v251
    v_exp_f32 v106, v106
    buffer_load_dwordx4 v[160:163], v8, s[24:27], s69 offen offset:0 sc1
    s_mov_b64 exec, s[66:67]
    buffer_load_dwordx4 v[164:167], v250, s[24:27], s69 offen offset:1024 sc1
    buffer_load_dwordx4 v[168:171], v250, s[24:27], s69 offen offset:1536 sc1
    s_mov_b64 exec, -1
    v_exp_f32 v107, v107
    v_exp_f32 v108, v108
    v_mfma_f32_32x32x16_bf16 v[120:135], v[172:175], v[20:23], v[56:71]
    v_exp_f32 v109, v109
    v_exp_f32 v110, v110
    v_exp_f32 v111, v111
    v_exp_f32 v112, v112
    v_exp_f32 v113, v113
    v_smfmac_f32_32x32x32_bf16 v[72:87], v[176:179], v[104:111], v251
    v_exp_f32 v114, v114
    v_exp_f32 v115, v115
    v_exp_f32 v116, v116
    v_exp_f32 v117, v117
    v_exp_f32 v118, v118
    v_exp_f32 v119, v119
    v_exp_f32 v120, v120
    v_exp_f32 v121, v121
    v_smfmac_f32_32x32x32_bf16 v[72:87], v[180:183], v[112:119], v251
    v_exp_f32 v122, v122
    v_exp_f32 v123, v123
    s_waitcnt vmcnt(14)
    v_exp_f32 v124, v124
    v_mfma_f32_32x32x16_bf16 v[104:119], v[136:139], v[16:19], v[40:55]
    v_exp_f32 v125, v125
    v_exp_f32 v126, v126
    v_exp_f32 v127, v127
    v_exp_f32 v128, v128
    v_exp_f32 v129, v129
    v_smfmac_f32_32x32x32_bf16 v[88:103], v[176:179], v[120:127], v251
    v_exp_f32 v130, v130
    s_lshl_b32 s74, s71, 10
    s_add_u32 m0, s74, s72
    s_lshl_b32 s75, s71, 13
    s_add_u32 s74, s74, 65536
    buffer_load_dwordx4 v5, s[32:35], s75 offen lds
    s_add_u32 m0, s74, s72
    s_add_u32 s71, s71, 1
    s_and_b32 s71, s71, 15
    buffer_load_dwordx4 v5, s[8:11], s75 offen lds
    v_exp_f32 v131, v131
    v_exp_f32 v132, v132
    v_exp_f32 v133, v133
    v_exp_f32 v134, v134
    v_exp_f32 v135, v135
    v_exp_f32 v104, v104
    v_exp_f32 v105, v105
    v_smfmac_f32_32x32x32_bf16 v[88:103], v[180:183], v[128:135], v251
    v_exp_f32 v106, v106
    buffer_load_dwordx4 v[172:175], v8, s[24:27], s69 offen offset:2048 sc1
    s_mov_b64 exec, s[66:67]
    buffer_load_dwordx4 v[176:179], v250, s[24:27], s69 offen offset:3072 sc1
    buffer_load_dwordx4 v[180:183], v250, s[24:27], s69 offen offset:3584 sc1
    s_mov_b64 exec, -1
    s_add_u32 s69, s69, 4096
    s_and_b32 s69, s69, 0x1ffff
    v_exp_f32 v107, v107
    v_exp_f32 v108, v108
    v_mfma_f32_32x32x16_bf16 v[120:135], v[136:139], v[20:23], v[56:71]
    v_exp_f32 v109, v109
    v_exp_f32 v110, v110
    v_exp_f32 v111, v111
    v_exp_f32 v112, v112
    v_exp_f32 v113, v113
    v_smfmac_f32_32x32x32_bf16 v[72:87], v[140:143], v[104:111], v251
    v_exp_f32 v114, v114
    v_exp_f32 v115, v115
    v_exp_f32 v116, v116
    v_exp_f32 v117, v117
    v_exp_f32 v118, v118
    v_exp_f32 v119, v119
    v_exp_f32 v120, v120
    v_exp_f32 v121, v121
    v_smfmac_f32_32x32x32_bf16 v[72:87], v[144:147], v[112:119], v251
    v_exp_f32 v122, v122
    v_exp_f32 v123, v123
    s_waitcnt vmcnt(14)
    v_exp_f32 v124, v124
    v_mfma_f32_32x32x16_bf16 v[104:119], v[148:151], v[16:19], v[40:55]
    v_exp_f32 v125, v125
    v_exp_f32 v126, v126
    v_exp_f32 v127, v127
    v_exp_f32 v128, v128
    v_exp_f32 v129, v129
    v_smfmac_f32_32x32x32_bf16 v[88:103], v[140:143], v[120:127], v251
    v_exp_f32 v130, v130
    s_waitcnt vmcnt(10)
    v_pk_add_f32 v[184:185], v[184:185], v[188:189]
    v_pk_add_f32 v[186:187], v[186:187], v[190:191]
    v_pk_add_f32 v[192:193], v[192:193], v[196:197]
    v_pk_add_f32 v[194:195], v[194:195], v[198:199]
    v_pk_add_f32 v[184:185], v[184:185], v[192:193]
    v_pk_add_f32 v[186:187], v[186:187], v[194:195]
    s_mul_i32 s74, s4, 800
    s_add_u32 s74, s74, 159744
    v_add_u32 v9, s74, v0
    s_mov_b32 exec_lo, 0x1ffff
    s_mov_b32 exec_hi, 0x1ffff
    ds_write_b128 v9, v[184:187]
    s_mov_b32 s91, 0
    s_waitcnt lgkmcnt(0)
    s_mov_b64 exec, 1
    ds_add_rtn_u32 v11, v254, v253 offset:16
    s_waitcnt lgkmcnt(0)
    v_cmp_eq_u32 vcc, 3, v11
    s_mov_b64 exec, -1
    s_cbranch_vccz L_notlast_14
    s_mov_b32 s91, 1
    v_add_u32 v9, 159744, v0
    ds_read_b128 v[184:187], v9 offset:0
    ds_read_b128 v[188:191], v9 offset:800
    ds_read_b128 v[192:195], v9 offset:1600
    ds_read_b128 v[196:199], v9 offset:2400
    s_waitcnt lgkmcnt(0)
    v_pk_add_f32 v[184:185], v[184:185], v[188:189]
    v_pk_add_f32 v[186:187], v[186:187], v[190:191]
    v_pk_add_f32 v[192:193], v[192:193], v[196:197]
    v_pk_add_f32 v[194:195], v[194:195], v[198:199]
    v_pk_add_f32 v[184:185], v[184:185], v[192:193]
    v_pk_add_f32 v[186:187], v[186:187], v[194:195]
    s_nop 1
    v_permlane32_swap_b32 v184, v186
    v_permlane32_swap_b32 v185, v187
    v_pk_add_f32 v[184:185], v[184:185], v[186:187]
    v_cvt_pk_bf16_f32 v184, v184, v185
    s_lshl_b32 s75, s90, 8
    s_add_u32 s75, s75, 11534336
    s_mov_b32 exec_lo, 0x1ffff
    s_mov_b32 exec_hi, 0x1ffff
    buffer_store_dword v184, v10, s[24:27], s75 offen sc1
    s_mov_b64 exec, -1
L_notlast_14:
    s_lshl_b32 s74, s71, 10
    s_add_u32 m0, s74, s72
    s_lshl_b32 s75, s71, 13
    s_add_u32 s74, s74, 65536
    buffer_load_dwordx4 v5, s[32:35], s75 offen lds
    s_add_u32 m0, s74, s72
    s_add_u32 s71, s71, 1
    s_and_b32 s71, s71, 15
    buffer_load_dwordx4 v5, s[8:11], s75 offen lds
    v_exp_f32 v131, v131
    v_exp_f32 v132, v132
    v_exp_f32 v133, v133
    v_exp_f32 v134, v134
    v_exp_f32 v135, v135
    v_exp_f32 v104, v104
    v_exp_f32 v105, v105
    v_smfmac_f32_32x32x32_bf16 v[88:103], v[144:147], v[128:135], v251
    v_exp_f32 v106, v106
    buffer_load_dwordx4 v[136:139], v8, s[24:27], s69 offen offset:0 sc1
    s_mov_b64 exec, s[66:67]
    buffer_load_dwordx4 v[140:143], v250, s[24:27], s69 offen offset:1024 sc1
    buffer_load_dwordx4 v[144:147], v250, s[24:27], s69 offen offset:1536 sc1
    s_mov_b64 exec, -1
    v_exp_f32 v107, v107
    v_exp_f32 v108, v108
    v_mfma_f32_32x32x16_bf16 v[120:135], v[148:151], v[20:23], v[56:71]
    v_exp_f32 v109, v109
    v_exp_f32 v110, v110
    v_exp_f32 v111, v111
    v_exp_f32 v112, v112
    v_exp_f32 v113, v113
    v_smfmac_f32_32x32x32_bf16 v[72:87], v[152:155], v[104:111], v251
    v_exp_f32 v114, v114
    v_exp_f32 v115, v115
    v_exp_f32 v116, v116
    v_exp_f32 v117, v117
    v_exp_f32 v118, v118
    v_exp_f32 v119, v119
    v_exp_f32 v120, v120
    v_exp_f32 v121, v121
    v_smfmac_f32_32x32x32_bf16 v[72:87], v[156:159], v[112:119], v251
    v_exp_f32 v122, v122
    v_exp_f32 v123, v123
    s_waitcnt vmcnt(10)
    v_exp_f32 v124, v124
    v_mfma_f32_32x32x16_bf16 v[104:119], v[160:163], v[16:19], v[40:55]
    v_exp_f32 v125, v125
    v_exp_f32 v126, v126
    v_exp_f32 v127, v127
    v_exp_f32 v128, v128
    v_exp_f32 v129, v129
    v_smfmac_f32_32x32x32_bf16 v[88:103], v[152:155], v[120:127], v251
    v_exp_f32 v130, v130
    s_lshl_b32 s74, s71, 10
    s_add_u32 m0, s74, s72
    s_lshl_b32 s75, s71, 13
    s_add_u32 s74, s74, 65536
    buffer_load_dwordx4 v5, s[32:35], s75 offen lds
    s_add_u32 m0, s74, s72
    s_add_u32 s71, s71, 1
    s_and_b32 s71, s71, 15
    buffer_load_dwordx4 v5, s[8:11], s75 offen lds
    v_exp_f32 v131, v131
    v_exp_f32 v132, v132
    v_exp_f32 v133, v133
    v_exp_f32 v134, v134
    v_exp_f32 v135, v135
    v_exp_f32 v104, v104
    v_exp_f32 v105, v105
    v_smfmac_f32_32x32x32_bf16 v[88:103], v[156:159], v[128:135], v251
    v_exp_f32 v106, v106
    buffer_load_dwordx4 v[148:151], v8, s[24:27], s69 offen offset:2048 sc1
    s_mov_b64 exec, s[66:67]
    buffer_load_dwordx4 v[152:155], v250, s[24:27], s69 offen offset:3072 sc1
    buffer_load_dwordx4 v[156:159], v250, s[24:27], s69 offen offset:3584 sc1
    s_mov_b64 exec, -1
    s_add_u32 s69, s69, 4096
    s_and_b32 s69, s69, 0x1ffff
    v_exp_f32 v107, v107
    v_exp_f32 v108, v108
    v_mfma_f32_32x32x16_bf16 v[120:135], v[160:163], v[20:23], v[56:71]
    v_exp_f32 v109, v109
    v_exp_f32 v110, v110
    v_exp_f32 v111, v111
    v_exp_f32 v112, v112
    v_exp_f32 v113, v113
    v_smfmac_f32_32x32x32_bf16 v[72:87], v[164:167], v[104:111], v251
    v_exp_f32 v114, v114
    v_exp_f32 v115, v115
    v_exp_f32 v116, v116
    v_exp_f32 v117, v117
    v_exp_f32 v118, v118
    v_exp_f32 v119, v119
    v_exp_f32 v120, v120
    v_exp_f32 v121, v121
    v_smfmac_f32_32x32x32_bf16 v[72:87], v[168:171], v[112:119], v251
    v_exp_f32 v122, v122
    v_exp_f32 v123, v123
    s_waitcnt vmcnt(10)
    v_exp_f32 v124, v124
    v_mfma_f32_32x32x16_bf16 v[104:119], v[172:175], v[16:19], v[40:55]
    v_exp_f32 v125, v125
    v_exp_f32 v126, v126
    v_exp_f32 v127, v127
    v_exp_f32 v128, v128
    v_exp_f32 v129, v129
    v_smfmac_f32_32x32x32_bf16 v[88:103], v[164:167], v[120:127], v251
    v_exp_f32 v130, v130
    s_lshl_b32 s74, s71, 10
    s_add_u32 m0, s74, s72
    s_lshl_b32 s75, s71, 13
    s_add_u32 s74, s74, 65536
    buffer_load_dwordx4 v5, s[32:35], s75 offen lds
    s_add_u32 m0, s74, s72
    s_add_u32 s71, s71, 1
    s_and_b32 s71, s71, 15
    buffer_load_dwordx4 v5, s[8:11], s75 offen lds
    v_exp_f32 v131, v131
    v_exp_f32 v132, v132
    v_exp_f32 v133, v133
    v_exp_f32 v134, v134
    v_exp_f32 v135, v135
    v_exp_f32 v104, v104
    v_exp_f32 v105, v105
    v_smfmac_f32_32x32x32_bf16 v[88:103], v[168:171], v[128:135], v251
    v_exp_f32 v106, v106
    buffer_load_dwordx4 v[160:163], v8, s[24:27], s69 offen offset:0 sc1
    s_mov_b64 exec, s[66:67]
    buffer_load_dwordx4 v[164:167], v250, s[24:27], s69 offen offset:1024 sc1
    buffer_load_dwordx4 v[168:171], v250, s[24:27], s69 offen offset:1536 sc1
    s_mov_b64 exec, -1
    v_exp_f32 v107, v107
    v_exp_f32 v108, v108
    v_mfma_f32_32x32x16_bf16 v[120:135], v[172:175], v[20:23], v[56:71]
    v_exp_f32 v109, v109
    v_exp_f32 v110, v110
    v_exp_f32 v111, v111
    v_exp_f32 v112, v112
    v_exp_f32 v113, v113
    v_smfmac_f32_32x32x32_bf16 v[72:87], v[176:179], v[104:111], v251
    v_exp_f32 v114, v114
    v_exp_f32 v115, v115
    v_exp_f32 v116, v116
    v_exp_f32 v117, v117
    v_exp_f32 v118, v118
    v_exp_f32 v119, v119
    v_exp_f32 v120, v120
    v_exp_f32 v121, v121
    v_smfmac_f32_32x32x32_bf16 v[72:87], v[180:183], v[112:119], v251
    v_exp_f32 v122, v122
    v_exp_f32 v123, v123
    s_waitcnt vmcnt(10)
    v_exp_f32 v124, v124
    v_mfma_f32_32x32x16_bf16 v[104:119], v[136:139], v[16:19], v[40:55]
    v_exp_f32 v125, v125
    v_exp_f32 v126, v126
    v_exp_f32 v127, v127
    v_exp_f32 v128, v128
    v_exp_f32 v129, v129
    v_smfmac_f32_32x32x32_bf16 v[88:103], v[176:179], v[120:127], v251
    v_exp_f32 v130, v130
    s_cmp_lg_u32 s91, 1
    s_cbranch_scc1 L_noffl_15
    s_lshr_b32 s75, s90, 3
    s_lshl_b32 s75, s75, 7
    s_and_b32 s74, s90, 7
    s_lshl_b32 s74, s74, 2
    s_add_u32 s74, s74, s75
    s_add_u32 s74, s74, 11603968
    v_mov_b32 v9, s74
    s_waitcnt vmcnt(6)
    v_mov_b32 v15, 1
    s_mov_b32 exec_lo, 1
    s_mov_b32 exec_hi, 0
    buffer_store_dword v15, v9, s[24:27], 0 offen sc1
    s_mov_b64 exec, -1
L_noffl_15:
    s_lshl_b32 s74, s71, 10
    s_add_u32 m0, s74, s72
    s_lshl_b32 s75, s71, 13
    s_add_u32 s74, s74, 65536
    buffer_load_dwordx4 v5, s[32:35], s75 offen lds
    s_add_u32 m0, s74, s72
    s_add_u32 s71, s71, 1
    s_and_b32 s71, s71, 15
    buffer_load_dwordx4 v5, s[8:11], s75 offen lds
    v_exp_f32 v131, v131
    v_exp_f32 v132, v132
    v_exp_f32 v133, v133
    v_exp_f32 v134, v134
    v_exp_f32 v135, v135
    v_exp_f32 v104, v104
    v_exp_f32 v105, v105
    v_smfmac_f32_32x32x32_bf16 v[88:103], v[180:183], v[128:135], v251
    v_exp_f32 v106, v106
    buffer_load_dwordx4 v[172:175], v8, s[24:27], s69 offen offset:2048 sc1
    s_mov_b64 exec, s[66:67]
    buffer_load_dwordx4 v[176:179], v250, s[24:27], s69 offen offset:3072 sc1
    buffer_load_dwordx4 v[180:183], v250, s[24:27], s69 offen offset:3584 sc1
    s_mov_b64 exec, -1
    s_add_u32 s69, s69, 4096
    s_and_b32 s69, s69, 0x1ffff
    v_exp_f32 v107, v107
    v_exp_f32 v108, v108
    v_mfma_f32_32x32x16_bf16 v[120:135], v[136:139], v[20:23], v[56:71]
    v_exp_f32 v109, v109
    v_exp_f32 v110, v110
    v_exp_f32 v111, v111
    v_exp_f32 v112, v112
    v_exp_f32 v113, v113
    v_smfmac_f32_32x32x32_bf16 v[72:87], v[140:143], v[104:111], v251
    v_exp_f32 v114, v114
    v_exp_f32 v115, v115
    v_exp_f32 v116, v116
    v_exp_f32 v117, v117
    v_exp_f32 v118, v118
    v_exp_f32 v119, v119
    v_exp_f32 v120, v120
    v_exp_f32 v121, v121
    v_smfmac_f32_32x32x32_bf16 v[72:87], v[144:147], v[112:119], v251
    v_exp_f32 v122, v122
    v_exp_f32 v123, v123
    s_waitcnt vmcnt(10)
    v_exp_f32 v124, v124
    v_mfma_f32_32x32x16_bf16 v[104:119], v[148:151], v[16:19], v[40:55]
    v_exp_f32 v125, v125
    v_exp_f32 v126, v126
    v_exp_f32 v127, v127
    v_exp_f32 v128, v128
    v_exp_f32 v129, v129
    v_smfmac_f32_32x32x32_bf16 v[88:103], v[140:143], v[120:127], v251
    v_exp_f32 v130, v130
    s_lshl_b32 s74, s71, 10
    s_add_u32 m0, s74, s72
    s_lshl_b32 s75, s71, 13
    s_add_u32 s74, s74, 65536
    buffer_load_dwordx4 v5, s[32:35], s75 offen lds
    s_add_u32 m0, s74, s72
    s_add_u32 s71, s71, 1
    s_and_b32 s71, s71, 15
    buffer_load_dwordx4 v5, s[8:11], s75 offen lds
    v_exp_f32 v131, v131
    v_exp_f32 v132, v132
    v_exp_f32 v133, v133
    v_exp_f32 v134, v134
    v_exp_f32 v135, v135
    v_exp_f32 v104, v104
    v_exp_f32 v105, v105
    v_smfmac_f32_32x32x32_bf16 v[88:103], v[144:147], v[128:135], v251
    v_exp_f32 v106, v106
    buffer_load_dwordx4 v[136:139], v8, s[24:27], s69 offen offset:0 sc1
    s_mov_b64 exec, s[66:67]
    buffer_load_dwordx4 v[140:143], v250, s[24:27], s69 offen offset:1024 sc1
    buffer_load_dwordx4 v[144:147], v250, s[24:27], s69 offen offset:1536 sc1
    s_mov_b64 exec, -1
    v_exp_f32 v107, v107
    v_exp_f32 v108, v108
    v_mfma_f32_32x32x16_bf16 v[120:135], v[148:151], v[20:23], v[56:71]
    v_exp_f32 v109, v109
    v_exp_f32 v110, v110
    v_exp_f32 v111, v111
    v_exp_f32 v112, v112
    v_exp_f32 v113, v113
    v_smfmac_f32_32x32x32_bf16 v[72:87], v[152:155], v[104:111], v251
    v_exp_f32 v114, v114
    v_exp_f32 v115, v115
    v_exp_f32 v116, v116
    v_exp_f32 v117, v117
    v_exp_f32 v118, v118
    v_exp_f32 v119, v119
    v_exp_f32 v120, v120
    v_exp_f32 v121, v121
    v_smfmac_f32_32x32x32_bf16 v[72:87], v[156:159], v[112:119], v251
    v_exp_f32 v122, v122
    v_exp_f32 v123, v123
    s_waitcnt vmcnt(10)
    v_exp_f32 v124, v124
    v_mfma_f32_32x32x16_bf16 v[104:119], v[160:163], v[16:19], v[40:55]
    v_exp_f32 v125, v125
    v_exp_f32 v126, v126
    v_exp_f32 v127, v127
    v_exp_f32 v128, v128
    v_exp_f32 v129, v129
    v_smfmac_f32_32x32x32_bf16 v[88:103], v[152:155], v[120:127], v251
    v_exp_f32 v130, v130
    v_exp_f32 v131, v131
    v_exp_f32 v132, v132
    v_exp_f32 v133, v133
    v_exp_f32 v134, v134
    v_exp_f32 v135, v135
    v_exp_f32 v104, v104
    v_exp_f32 v105, v105
    v_smfmac_f32_32x32x32_bf16 v[88:103], v[156:159], v[128:135], v251
    v_exp_f32 v106, v106
    buffer_load_dwordx4 v[148:151], v8, s[24:27], s69 offen offset:2048 sc1
    s_mov_b64 exec, s[66:67]
    buffer_load_dwordx4 v[152:155], v250, s[24:27], s69 offen offset:3072 sc1
    buffer_load_dwordx4 v[156:159], v250, s[24:27], s69 offen offset:3584 sc1
    s_mov_b64 exec, -1
    s_add_u32 s69, s69, 4096
    s_and_b32 s69, s69, 0x1ffff
    v_exp_f32 v107, v107
    v_exp_f32 v108, v108
    v_mfma_f32_32x32x16_bf16 v[120:135], v[160:163], v[20:23], v[56:71]
    v_exp_f32 v109, v109
    v_exp_f32 v110, v110
    v_exp_f32 v111, v111
    v_exp_f32 v112, v112
    v_exp_f32 v113, v113
    v_smfmac_f32_32x32x32_bf16 v[72:87], v[164:167], v[104:111], v251
    v_exp_f32 v114, v114
    v_exp_f32 v115, v115
    v_exp_f32 v116, v116
    v_exp_f32 v117, v117
    v_exp_f32 v118, v118
    v_exp_f32 v119, v119
    v_exp_f32 v120, v120
    v_exp_f32 v121, v121
    v_smfmac_f32_32x32x32_bf16 v[72:87], v[168:171], v[112:119], v251
    v_exp_f32 v122, v122
    v_exp_f32 v123, v123
    s_waitcnt vmcnt(8)
    v_exp_f32 v124, v124
    v_mfma_f32_32x32x16_bf16 v[104:119], v[172:175], v[16:19], v[40:55]
    v_exp_f32 v125, v125
    v_exp_f32 v126, v126
    v_exp_f32 v127, v127
    v_exp_f32 v128, v128
    v_exp_f32 v129, v129
    v_smfmac_f32_32x32x32_bf16 v[88:103], v[164:167], v[120:127], v251
    v_exp_f32 v130, v130
    v_mov_b32 v240, -1
    v_mov_b32 v241, -1
    v_mov_b32 v242, -1
    v_mov_b32 v243, -1
    s_lshl_b32 s74, s5, 6
    s_add_u32 s74, s74, s7
    s_lshl_b32 s74, s74, 10
    s_add_u32 s74, s74, 6291456
    s_add_u32 s75, s74, 32768
    buffer_store_dwordx4 v[240:243], v0, s[24:27], s74 offen sc1
    buffer_store_dwordx4 v[240:243], v0, s[24:27], s75 offen sc1
    v_exp_f32 v131, v131
    v_exp_f32 v132, v132
    v_exp_f32 v133, v133
    v_exp_f32 v134, v134
    v_exp_f32 v135, v135
    v_exp_f32 v104, v104
    v_exp_f32 v105, v105
    v_smfmac_f32_32x32x32_bf16 v[88:103], v[168:171], v[128:135], v251
    v_exp_f32 v106, v106
    buffer_load_dwordx4 v[160:163], v8, s[24:27], s69 offen offset:0 sc1
    s_mov_b64 exec, s[66:67]
    buffer_load_dwordx4 v[164:167], v250, s[24:27], s69 offen offset:1024 sc1
    buffer_load_dwordx4 v[168:171], v250, s[24:27], s69 offen offset:1536 sc1
    s_mov_b64 exec, -1
    v_exp_f32 v107, v107
    v_exp_f32 v108, v108
    v_mfma_f32_32x32x16_bf16 v[120:135], v[172:175], v[20:23], v[56:71]
    v_exp_f32 v109, v109
    v_exp_f32 v110, v110
    v_exp_f32 v111, v111
    v_exp_f32 v112, v112
    v_exp_f32 v113, v113
    v_smfmac_f32_32x32x32_bf16 v[72:87], v[176:179], v[104:111], v251
    v_exp_f32 v114, v114
    v_exp_f32 v115, v115
    v_exp_f32 v116, v116
    v_exp_f32 v117, v117
    v_exp_f32 v118, v118
    v_exp_f32 v119, v119
    v_exp_f32 v120, v120
    v_exp_f32 v121, v121
    v_smfmac_f32_32x32x32_bf16 v[72:87], v[180:183], v[112:119], v251
    v_exp_f32 v122, v122
    v_exp_f32 v123, v123
    s_waitcnt vmcnt(8)
    v_exp_f32 v124, v124
    v_mfma_f32_32x32x16_bf16 v[104:119], v[136:139], v[16:19], v[40:55]
    v_exp_f32 v125, v125
    v_exp_f32 v126, v126
    v_exp_f32 v127, v127
    v_exp_f32 v128, v128
    v_exp_f32 v129, v129
    v_smfmac_f32_32x32x32_bf16 v[88:103], v[176:179], v[120:127], v251
    v_exp_f32 v130, v130
    s_mov_b64 exec, 1
    ds_add_u32 v254, v253 offset:8
    s_mov_b64 exec, -1
    v_exp_f32 v131, v131
    v_exp_f32 v132, v132
    v_exp_f32 v133, v133
    v_exp_f32 v134, v134
    v_exp_f32 v135, v135
    v_exp_f32 v104, v104
    v_exp_f32 v105, v105
    v_smfmac_f32_32x32x32_bf16 v[88:103], v[180:183], v[128:135], v251
    v_exp_f32 v106, v106
    buffer_load_dwordx4 v[172:175], v8, s[24:27], s69 offen offset:2048 sc1
    s_mov_b64 exec, s[66:67]
    buffer_load_dwordx4 v[176:179], v250, s[24:27], s69 offen offset:3072 sc1
    buffer_load_dwordx4 v[180:183], v250, s[24:27], s69 offen offset:3584 sc1
    s_mov_b64 exec, -1
    s_add_u32 s69, s69, 4096
    s_and_b32 s69, s69, 0x1ffff
    v_exp_f32 v107, v107
    v_exp_f32 v108, v108
    v_mfma_f32_32x32x16_bf16 v[120:135], v[136:139], v[20:23], v[56:71]
    v_exp_f32 v109, v109
    v_exp_f32 v110, v110
    v_exp_f32 v111, v111
    v_exp_f32 v112, v112
    v_exp_f32 v113, v113
    v_smfmac_f32_32x32x32_bf16 v[72:87], v[140:143], v[104:111], v251
    v_exp_f32 v114, v114
    v_exp_f32 v115, v115
    v_exp_f32 v116, v116
    v_exp_f32 v117, v117
    v_exp_f32 v118, v118
    v_exp_f32 v119, v119
    v_exp_f32 v120, v120
    v_exp_f32 v121, v121
    v_smfmac_f32_32x32x32_bf16 v[72:87], v[144:147], v[112:119], v251
    v_exp_f32 v122, v122
    v_exp_f32 v123, v123
    s_waitcnt vmcnt(8)
    v_exp_f32 v124, v124
    v_mfma_f32_32x32x16_bf16 v[104:119], v[148:151], v[16:19], v[40:55]
    v_exp_f32 v125, v125
    v_exp_f32 v126, v126
    v_exp_f32 v127, v127
    v_exp_f32 v128, v128
    v_exp_f32 v129, v129
    v_smfmac_f32_32x32x32_bf16 v[88:103], v[140:143], v[120:127], v251
    v_exp_f32 v130, v130
    s_lshl_b32 s74, s7, 7
    s_add_u32 s74, s74, 11603968
    v_lshl_add_u32 v9, v1, 2, s74
    s_mov_b64 exec, 0xff
    buffer_load_dword v10, v9, s[24:27], 0 offen sc1
    s_mov_b64 exec, -1
    v_exp_f32 v131, v131
    v_exp_f32 v132, v132
    v_exp_f32 v133, v133
    v_exp_f32 v134, v134
    v_exp_f32 v135, v135
    v_exp_f32 v104, v104
    v_exp_f32 v105, v105
    v_smfmac_f32_32x32x32_bf16 v[88:103], v[144:147], v[128:135], v251
    v_exp_f32 v106, v106
    buffer_load_dwordx4 v[136:139], v8, s[24:27], s69 offen offset:0 sc1
    s_mov_b64 exec, s[66:67]
    buffer_load_dwordx4 v[140:143], v250, s[24:27], s69 offen offset:1024 sc1
    buffer_load_dwordx4 v[144:147], v250, s[24:27], s69 offen offset:1536 sc1
    s_mov_b64 exec, -1
    v_exp_f32 v107, v107
    v_exp_f32 v108, v108
    v_mfma_f32_32x32x16_bf16 v[120:135], v[148:151], v[20:23], v[56:71]
    v_exp_f32 v109, v109
    v_exp_f32 v110, v110
    v_exp_f32 v111, v111
    v_exp_f32 v112, v112
    v_exp_f32 v113, v113
    v_smfmac_f32_32x32x32_bf16 v[72:87], v[152:155], v[104:111], v251
    v_exp_f32 v114, v114
    v_exp_f32 v115, v115
    v_exp_f32 v116, v116
    v_exp_f32 v117, v117
    v_exp_f32 v118, v118
    v_exp_f32 v119, v119
    v_exp_f32 v120, v120
    v_exp_f32 v121, v121
    v_smfmac_f32_32x32x32_bf16 v[72:87], v[156:159], v[112:119], v251
    v_exp_f32 v122, v122
    v_exp_f32 v123, v123
    s_waitcnt vmcnt(7)
    v_exp_f32 v124, v124
    v_mfma_f32_32x32x16_bf16 v[104:119], v[160:163], v[16:19], v[40:55]
    v_exp_f32 v125, v125
    v_exp_f32 v126, v126
    v_exp_f32 v127, v127
    v_exp_f32 v128, v128
    v_exp_f32 v129, v129
    v_smfmac_f32_32x32x32_bf16 v[88:103], v[152:155], v[120:127], v251
    v_exp_f32 v130, v130
    v_exp_f32 v131, v131
    v_exp_f32 v132, v132
    v_exp_f32 v133, v133
    v_exp_f32 v134, v134
    v_exp_f32 v135, v135
    v_exp_f32 v104, v104
    v_exp_f32 v105, v105
    v_smfmac_f32_32x32x32_bf16 v[88:103], v[156:159], v[128:135], v251
    v_exp_f32 v106, v106
    buffer_load_dwordx4 v[148:151], v8, s[24:27], s69 offen offset:2048 sc1
    s_mov_b64 exec, s[66:67]
    buffer_load_dwordx4 v[152:155], v250, s[24:27], s69 offen offset:3072 sc1
    buffer_load_dwordx4 v[156:159], v250, s[24:27], s69 offen offset:3584 sc1
    s_mov_b64 exec, -1
    s_add_u32 s69, s69, 4096
    s_and_b32 s69, s69, 0x1ffff
    v_exp_f32 v107, v107
    v_exp_f32 v108, v108
    v_mfma_f32_32x32x16_bf16 v[120:135], v[160:163], v[20:23], v[56:71]
    v_exp_f32 v109, v109
    v_exp_f32 v110, v110
    v_exp_f32 v111, v111
    v_exp_f32 v112, v112
    v_exp_f32 v113, v113
    v_smfmac_f32_32x32x32_bf16 v[72:87], v[164:167], v[104:111], v251
    v_exp_f32 v114, v114
    v_exp_f32 v115, v115
    v_exp_f32 v116, v116
    v_exp_f32 v117, v117
    v_exp_f32 v118, v118
    v_exp_f32 v119, v119
    v_exp_f32 v120, v120
    v_exp_f32 v121, v121
    v_smfmac_f32_32x32x32_bf16 v[72:87], v[168:171], v[112:119], v251
    v_exp_f32 v122, v122
    v_exp_f32 v123, v123
    s_waitcnt vmcnt(7)
    v_exp_f32 v124, v124
    v_mfma_f32_32x32x16_bf16 v[104:119], v[172:175], v[16:19], v[40:55]
    v_exp_f32 v125, v125
    v_exp_f32 v126, v126
    v_exp_f32 v127, v127
    v_exp_f32 v128, v128
    v_exp_f32 v129, v129
    v_smfmac_f32_32x32x32_bf16 v[88:103], v[164:167], v[120:127], v251
    v_exp_f32 v130, v130
    s_waitcnt vmcnt(6)
    s_mov_b32 exec_lo, 255
    s_mov_b32 exec_hi, 0
    s_mov_b32 s78, 2097152
    v_cmp_eq_u32 vcc, 0, v10
    s_nop 0
    s_cbranch_vccz L_polld_17
L_poll_16:
    buffer_load_dword v10, v9, s[24:27], 0 offen sc1
    s_sub_u32 s78, s78, 1
    s_cbranch_scc1 L_polld_17
    s_waitcnt vmcnt(0)
    v_cmp_eq_u32 vcc, 0, v10
    s_nop 0
    s_cbranch_vccnz L_poll_16
L_polld_17:
    s_mov_b64 exec, -1
    v_and_b32 v9, 31, v1
    v_min_u32 v9, 16, v9
    v_lshlrev_b32 v9, 3, v9
    v_lshrrev_b32 v10, 5, v1
    v_lshl_add_u32 v9, v10, 8, v9
    s_lshl_b32 s74, s7, 11
    s_add_u32 s74, s74, 11534336
    buffer_load_dwordx2 v[216:217], v9, s[24:27], s74 offen offset:0 sc1
    buffer_load_dwordx2 v[218:219], v9, s[24:27], s74 offen offset:512 sc1
    buffer_load_dwordx2 v[220:221], v9, s[24:27], s74 offen offset:1024 sc1
    buffer_load_dwordx2 v[222:223], v9, s[24:27], s74 offen offset:1536 sc1
    v_exp_f32 v131, v131
    v_exp_f32 v132, v132
    v_exp_f32 v133, v133
    v_exp_f32 v134, v134
    v_exp_f32 v135, v135
    v_exp_f32 v104, v104
    v_exp_f32 v105, v105
    v_smfmac_f32_32x32x32_bf16 v[88:103], v[168:171], v[128:135], v251
    v_exp_f32 v106, v106
    buffer_load_dwordx4 v[160:163], v8, s[24:27], s69 offen offset:0 sc1
    s_mov_b64 exec, s[66:67]
    buffer_load_dwordx4 v[164:167], v250, s[24:27], s69 offen offset:1024 sc1
    buffer_load_dwordx4 v[168:171], v250, s[24:27], s69 offen offset:1536 sc1
    s_mov_b64 exec, -1
    v_exp_f32 v107, v107
    v_exp_f32 v108, v108
    v_mfma_f32_32x32x16_bf16 v[120:135], v[172:175], v[20:23], v[56:71]
    v_exp_f32 v109, v109
    v_exp_f32 v110, v110
    v_exp_f32 v111, v111
    v_exp_f32 v112, v112
    v_exp_f32 v113, v113
    v_smfmac_f32_32x32x32_bf16 v[72:87], v[176:179], v[104:111], v251
    v_exp_f32 v114, v114
    v_exp_f32 v115, v115
    v_exp_f32 v116, v116
    v_exp_f32 v117, v117
    v_exp_f32 v118, v118
    v_exp_f32 v119, v119
    v_exp_f32 v120, v120
    v_exp_f32 v121, v121
    v_smfmac_f32_32x32x32_bf16 v[72:87], v[180:183], v[112:119], v251
    v_exp_f32 v122, v122
    v_exp_f32 v123, v123
    s_waitcnt vmcnt(10)
    v_exp_f32 v124, v124
    v_mfma_f32_32x32x16_bf16 v[104:119], v[136:139], v[16:19], v[40:55]
    v_exp_f32 v125, v125
    v_exp_f32 v126, v126
    v_exp_f32 v127, v127
    v_exp_f32 v128, v128
    v_exp_f32 v129, v129
    v_smfmac_f32_32x32x32_bf16 v[88:103], v[176:179], v[120:127], v251
    v_exp_f32 v130, v130
    v_exp_f32 v131, v131
    v_exp_f32 v132, v132
    v_exp_f32 v133, v133
    v_exp_f32 v134, v134
    v_exp_f32 v135, v135
    v_exp_f32 v104, v104
    v_exp_f32 v105, v105
    v_smfmac_f32_32x32x32_bf16 v[88:103], v[180:183], v[128:135], v251
    v_exp_f32 v106, v106
    buffer_load_dwordx4 v[172:175], v8, s[24:27], s69 offen offset:2048 sc1
    s_mov_b64 exec, s[66:67]
    buffer_load_dwordx4 v[176:179], v250, s[24:27], s69 offen offset:3072 sc1
    buffer_load_dwordx4 v[180:183], v250, s[24:27], s69 offen offset:3584 sc1
    s_mov_b64 exec, -1
    s_add_u32 s69, s69, 4096
    s_and_b32 s69, s69, 0x1ffff
    v_exp_f32 v107, v107
    v_exp_f32 v108, v108
    v_mfma_f32_32x32x16_bf16 v[120:135], v[136:139], v[20:23], v[56:71]
    v_exp_f32 v109, v109
    v_exp_f32 v110, v110
    v_exp_f32 v111, v111
    v_exp_f32 v112, v112
    v_exp_f32 v113, v113
    v_smfmac_f32_32x32x32_bf16 v[72:87], v[140:143], v[104:111], v251
    v_exp_f32 v114, v114
    v_exp_f32 v115, v115
    v_exp_f32 v116, v116
    v_exp_f32 v117, v117
    v_exp_f32 v118, v118
    v_exp_f32 v119, v119
    v_exp_f32 v120, v120
    v_exp_f32 v121, v121
    v_smfmac_f32_32x32x32_bf16 v[72:87], v[144:147], v[112:119], v251
    v_exp_f32 v122, v122
    v_exp_f32 v123, v123
    s_waitcnt vmcnt(10)
    v_exp_f32 v124, v124
    v_mfma_f32_32x32x16_bf16 v[104:119], v[148:151], v[16:19], v[40:55]
    v_exp_f32 v125, v125
    v_exp_f32 v126, v126
    v_exp_f32 v127, v127
    v_exp_f32 v128, v128
    v_exp_f32 v129, v129
    v_smfmac_f32_32x32x32_bf16 v[88:103], v[140:143], v[120:127], v251
    v_exp_f32 v130, v130
    s_waitcnt vmcnt(6)
    v_mfma_f32_32x32x16_bf16 v[184:199], v[216:219], v[24:27], 0
    v_mfma_f32_32x32x16_bf16 v[200:215], v[216:219], v[32:35], 0
    v_mfma_f32_32x32x16_bf16 v[184:199], v[220:223], v[28:31], v[184:199]
    v_mfma_f32_32x32x16_bf16 v[200:215], v[220:223], v[36:39], v[200:215]
    v_exp_f32 v131, v131
    v_exp_f32 v132, v132
    v_exp_f32 v133, v133
    v_exp_f32 v134, v134
    v_exp_f32 v135, v135
    v_exp_f32 v104, v104
    v_exp_f32 v105, v105
    v_smfmac_f32_32x32x32_bf16 v[88:103], v[144:147], v[128:135], v251
    v_exp_f32 v106, v106
    buffer_load_dwordx4 v[136:139], v8, s[24:27], s69 offen offset:0 sc1
    s_mov_b64 exec, s[66:67]
    buffer_load_dwordx4 v[140:143], v250, s[24:27], s69 offen offset:1024 sc1
    buffer_load_dwordx4 v[144:147], v250, s[24:27], s69 offen offset:1536 sc1
    s_mov_b64 exec, -1
    v_exp_f32 v107, v107
    v_exp_f32 v108, v108
    v_mfma_f32_32x32x16_bf16 v[120:135], v[148:151], v[20:23], v[56:71]
    v_exp_f32 v109, v109
    v_exp_f32 v110, v110
    v_exp_f32 v111, v111
    v_exp_f32 v112, v112
    v_exp_f32 v113, v113
    v_smfmac_f32_32x32x32_bf16 v[72:87], v[152:155], v[104:111], v251
    v_exp_f32 v114, v114
    v_exp_f32 v115, v115
    v_exp_f32 v116, v116
    v_exp_f32 v117, v117
    v_exp_f32 v118, v118
    v_exp_f32 v119, v119
    v_exp_f32 v120, v120
    v_exp_f32 v121, v121
    v_smfmac_f32_32x32x32_bf16 v[72:87], v[156:159], v[112:119], v251
    v_exp_f32 v122, v122
    v_exp_f32 v123, v123
    s_waitcnt vmcnt(6)
    v_exp_f32 v124, v124
    v_mfma_f32_32x32x16_bf16 v[104:119], v[160:163], v[16:19], v[40:55]
    v_exp_f32 v125, v125
    v_exp_f32 v126, v126
    v_exp_f32 v127, v127
    v_exp_f32 v128, v128
    v_exp_f32 v129, v129
    v_smfmac_f32_32x32x32_bf16 v[88:103], v[152:155], v[120:127], v251
    v_exp_f32 v130, v130
    s_lshl_b32 s74, s5, 6
    s_add_u32 s74, s74, s7
    s_lshl_b32 s74, s74, 10
    s_add_u32 s74, s74, 4194304
    s_add_u32 s75, s74, 32768
    v_add_f32 v192, 897988541, v192
    v_rcp_f32 v192, v192
    v_add_f32 v208, 897988541, v208
    v_rcp_f32 v208, v208
    v_pk_mul_f32 v[184:185], v[184:185], v[192:193] op_sel:[0,0] op_sel_hi:[1,0]
    v_pk_mul_f32 v[186:187], v[186:187], v[192:193] op_sel:[0,0] op_sel_hi:[1,0]
    v_pk_mul_f32 v[188:189], v[188:189], v[192:193] op_sel:[0,0] op_sel_hi:[1,0]
    v_pk_mul_f32 v[190:191], v[190:191], v[192:193] op_sel:[0,0] op_sel_hi:[1,0]
    v_cvt_pk_bf16_f32 v196, v184, v185
    v_cvt_pk_bf16_f32 v197, v186, v187
    v_cvt_pk_bf16_f32 v198, v188, v189
    v_cvt_pk_bf16_f32 v199, v190, v191
    buffer_store_dwordx4 v[196:199], v0, s[24:27], s74 offen sc1
    v_pk_mul_f32 v[200:201], v[200:201], v[208:209] op_sel:[0,0] op_sel_hi:[1,0]
    v_pk_mul_f32 v[202:203], v[202:203], v[208:209] op_sel:[0,0] op_sel_hi:[1,0]
    v_pk_mul_f32 v[204:205], v[204:205], v[208:209] op_sel:[0,0] op_sel_hi:[1,0]
    v_pk_mul_f32 v[206:207], v[206:207], v[208:209] op_sel:[0,0] op_sel_hi:[1,0]
    v_cvt_pk_bf16_f32 v212, v200, v201
    v_cvt_pk_bf16_f32 v213, v202, v203
    v_cvt_pk_bf16_f32 v214, v204, v205
    v_cvt_pk_bf16_f32 v215, v206, v207
    buffer_store_dwordx4 v[212:215], v0, s[24:27], s75 offen sc1
    v_exp_f32 v131, v131
    v_exp_f32 v132, v132
    v_exp_f32 v133, v133
    v_exp_f32 v134, v134
    v_exp_f32 v135, v135
    v_exp_f32 v104, v104
    v_exp_f32 v105, v105
    v_smfmac_f32_32x32x32_bf16 v[88:103], v[156:159], v[128:135], v251
    v_exp_f32 v106, v106
    buffer_load_dwordx4 v[148:151], v8, s[24:27], s69 offen offset:2048 sc1
    s_mov_b64 exec, s[66:67]
    buffer_load_dwordx4 v[152:155], v250, s[24:27], s69 offen offset:3072 sc1
    buffer_load_dwordx4 v[156:159], v250, s[24:27], s69 offen offset:3584 sc1
    s_mov_b64 exec, -1
    s_add_u32 s69, s69, 4096
    s_and_b32 s69, s69, 0x1ffff
    v_exp_f32 v107, v107
    v_exp_f32 v108, v108
    v_mfma_f32_32x32x16_bf16 v[120:135], v[160:163], v[20:23], v[56:71]
    v_exp_f32 v109, v109
    v_exp_f32 v110, v110
    v_exp_f32 v111, v111
    v_exp_f32 v112, v112
    v_exp_f32 v113, v113
    v_smfmac_f32_32x32x32_bf16 v[72:87], v[164:167], v[104:111], v251
    v_exp_f32 v114, v114
    v_exp_f32 v115, v115
    v_exp_f32 v116, v116
    v_exp_f32 v117, v117
    v_exp_f32 v118, v118
    v_exp_f32 v119, v119
    v_exp_f32 v120, v120
    v_exp_f32 v121, v121
    v_smfmac_f32_32x32x32_bf16 v[72:87], v[168:171], v[112:119], v251
    v_exp_f32 v122, v122
    v_exp_f32 v123, v123
    s_waitcnt vmcnt(8)
    v_exp_f32 v124, v124
    v_mfma_f32_32x32x16_bf16 v[104:119], v[172:175], v[16:19], v[40:55]
    v_exp_f32 v125, v125
    v_exp_f32 v126, v126
    v_exp_f32 v127, v127
    v_exp_f32 v128, v128
    v_exp_f32 v129, v129
    v_smfmac_f32_32x32x32_bf16 v[88:103], v[164:167], v[120:127], v251
    v_exp_f32 v130, v130
    v_exp_f32 v131, v131
    v_exp_f32 v132, v132
    v_exp_f32 v133, v133
    v_exp_f32 v134, v134
    v_exp_f32 v135, v135
    v_exp_f32 v104, v104
    v_exp_f32 v105, v105
    v_smfmac_f32_32x32x32_bf16 v[88:103], v[168:171], v[128:135], v251
    v_exp_f32 v106, v106
    buffer_load_dwordx4 v[160:163], v8, s[24:27], s69 offen offset:0 sc1
    s_mov_b64 exec, s[66:67]
    buffer_load_dwordx4 v[164:167], v250, s[24:27], s69 offen offset:1024 sc1
    buffer_load_dwordx4 v[168:171], v250, s[24:27], s69 offen offset:1536 sc1
    s_mov_b64 exec, -1
    v_exp_f32 v107, v107
    v_exp_f32 v108, v108
    v_mfma_f32_32x32x16_bf16 v[120:135], v[172:175], v[20:23], v[56:71]
    v_exp_f32 v109, v109
    v_exp_f32 v110, v110
    v_exp_f32 v111, v111
    v_exp_f32 v112, v112
    v_exp_f32 v113, v113
    v_smfmac_f32_32x32x32_bf16 v[72:87], v[176:179], v[104:111], v251
    v_exp_f32 v114, v114
    v_exp_f32 v115, v115
    v_exp_f32 v116, v116
    v_exp_f32 v117, v117
    v_exp_f32 v118, v118
    v_exp_f32 v119, v119
    v_exp_f32 v120, v120
    v_exp_f32 v121, v121
    v_smfmac_f32_32x32x32_bf16 v[72:87], v[180:183], v[112:119], v251
    v_exp_f32 v122, v122
    v_exp_f32 v123, v123
    s_waitcnt vmcnt(8)
    v_exp_f32 v124, v124
    v_mfma_f32_32x32x16_bf16 v[104:119], v[136:139], v[16:19], v[40:55]
    v_exp_f32 v125, v125
    v_exp_f32 v126, v126
    v_exp_f32 v127, v127
    v_exp_f32 v128, v128
    v_exp_f32 v129, v129
    v_smfmac_f32_32x32x32_bf16 v[88:103], v[176:179], v[120:127], v251
    v_exp_f32 v130, v130
    s_waitcnt vmcnt(6)
    s_lshl_b32 s74, s5, 7
    s_lshl_b32 s75, s7, 2
    s_add_u32 s74, s74, s75
    s_add_u32 s74, s74, 11608064
    v_mov_b32 v9, s74
    v_mov_b32 v15, 1
    s_mov_b32 exec_lo, 1
    s_mov_b32 exec_hi, 0
    buffer_store_dword v15, v9, s[24:27], 0 offen sc1
    s_mov_b64 exec, -1
    v_exp_f32 v131, v131
    v_exp_f32 v132, v132
    v_exp_f32 v133, v133
    v_exp_f32 v134, v134
    v_exp_f32 v135, v135
    v_exp_f32 v104, v104
    v_exp_f32 v105, v105
    v_smfmac_f32_32x32x32_bf16 v[88:103], v[180:183], v[128:135], v251
    v_exp_f32 v106, v106
    buffer_load_dwordx4 v[172:175], v8, s[24:27], s69 offen offset:2048 sc1
    s_mov_b64 exec, s[66:67]
    buffer_load_dwordx4 v[176:179], v250, s[24:27], s69 offen offset:3072 sc1
    buffer_load_dwordx4 v[180:183], v250, s[24:27], s69 offen offset:3584 sc1
    s_mov_b64 exec, -1
    s_add_u32 s69, s69, 4096
    s_and_b32 s69, s69, 0x1ffff
    v_exp_f32 v107, v107
    v_exp_f32 v108, v108
    v_mfma_f32_32x32x16_bf16 v[120:135], v[136:139], v[20:23], v[56:71]
    v_exp_f32 v109, v109
    v_exp_f32 v110, v110
    v_exp_f32 v111, v111
    v_exp_f32 v112, v112
    v_exp_f32 v113, v113
    v_smfmac_f32_32x32x32_bf16 v[72:87], v[140:143], v[104:111], v251
    v_exp_f32 v114, v114
    v_exp_f32 v115, v115
    v_exp_f32 v116, v116
    v_exp_f32 v117, v117
    v_exp_f32 v118, v118
    v_exp_f32 v119, v119
    v_exp_f32 v120, v120
    v_exp_f32 v121, v121
    v_smfmac_f32_32x32x32_bf16 v[72:87], v[144:147], v[112:119], v251
    v_exp_f32 v122, v122
    v_exp_f32 v123, v123
    s_waitcnt vmcnt(7)
    v_exp_f32 v124, v124
    v_mfma_f32_32x32x16_bf16 v[104:119], v[148:151], v[16:19], v[40:55]
    v_exp_f32 v125, v125
    v_exp_f32 v126, v126
    v_exp_f32 v127, v127
    v_exp_f32 v128, v128
    v_exp_f32 v129, v129
    v_smfmac_f32_32x32x32_bf16 v[88:103], v[140:143], v[120:127], v251
    v_exp_f32 v130, v130
    v_exp_f32 v131, v131
    v_exp_f32 v132, v132
    v_exp_f32 v133, v133
    v_exp_f32 v134, v134
    v_exp_f32 v135, v135
    v_exp_f32 v104, v104
    v_exp_f32 v105, v105
    v_smfmac_f32_32x32x32_bf16 v[88:103], v[144:147], v[128:135], v251
    v_exp_f32 v106, v106
    buffer_load_dwordx4 v[136:139], v8, s[24:27], s69 offen offset:0 sc1
    s_mov_b64 exec, s[66:67]
    buffer_load_dwordx4 v[140:143], v250, s[24:27], s69 offen offset:1024 sc1
    buffer_load_dwordx4 v[144:147], v250, s[24:27], s69 offen offset:1536 sc1
    s_mov_b64 exec, -1
    v_exp_f32 v107, v107
    v_exp_f32 v108, v108
    v_mfma_f32_32x32x16_bf16 v[120:135], v[148:151], v[20:23], v[56:71]
    v_exp_f32 v109, v109
    v_exp_f32 v110, v110
    v_exp_f32 v111, v111
    v_exp_f32 v112, v112
    v_exp_f32 v113, v113
    v_smfmac_f32_32x32x32_bf16 v[72:87], v[152:155], v[104:111], v251
    v_exp_f32 v114, v114
    v_exp_f32 v115, v115
    v_exp_f32 v116, v116
    v_exp_f32 v117, v117
    v_exp_f32 v118, v118
    v_exp_f32 v119, v119
    v_exp_f32 v120, v120
    v_exp_f32 v121, v121
    v_smfmac_f32_32x32x32_bf16 v[72:87], v[156:159], v[112:119], v251
    v_exp_f32 v122, v122
    v_exp_f32 v123, v123
    s_waitcnt vmcnt(7)
    v_exp_f32 v124, v124
    v_mfma_f32_32x32x16_bf16 v[104:119], v[160:163], v[16:19], v[40:55]
    v_exp_f32 v125, v125
    v_exp_f32 v126, v126
    v_exp_f32 v127, v127
    v_exp_f32 v128, v128
    v_exp_f32 v129, v129
    v_smfmac_f32_32x32x32_bf16 v[88:103], v[152:155], v[120:127], v251
    v_exp_f32 v130, v130
    v_exp_f32 v131, v131
    v_exp_f32 v132, v132
    v_exp_f32 v133, v133
    v_exp_f32 v134, v134
    v_exp_f32 v135, v135
    v_exp_f32 v104, v104
    v_exp_f32 v105, v105
    v_smfmac_f32_32x32x32_bf16 v[88:103], v[156:159], v[128:135], v251
    v_exp_f32 v106, v106
    buffer_load_dwordx4 v[148:151], v8, s[24:27], s69 offen offset:2048 sc1
    s_mov_b64 exec, s[66:67]
    buffer_load_dwordx4 v[152:155], v250, s[24:27], s69 offen offset:3072 sc1
    buffer_load_dwordx4 v[156:159], v250, s[24:27], s69 offen offset:3584 sc1
    s_mov_b64 exec, -1
    s_add_u32 s69, s69, 4096
    s_and_b32 s69, s69, 0x1ffff
    v_exp_f32 v107, v107
    v_exp_f32 v108, v108
    v_mfma_f32_32x32x16_bf16 v[120:135], v[160:163], v[20:23], v[56:71]
    v_exp_f32 v109, v109
    v_exp_f32 v110, v110
    v_exp_f32 v111, v111
    v_exp_f32 v112, v112
    v_exp_f32 v113, v113
    v_smfmac_f32_32x32x32_bf16 v[72:87], v[164:167], v[104:111], v251
    v_exp_f32 v114, v114
    v_exp_f32 v115, v115
    v_exp_f32 v116, v116
    v_exp_f32 v117, v117
    v_exp_f32 v118, v118
    v_exp_f32 v119, v119
    v_exp_f32 v120, v120
    v_exp_f32 v121, v121
    v_smfmac_f32_32x32x32_bf16 v[72:87], v[168:171], v[112:119], v251
    v_exp_f32 v122, v122
    v_exp_f32 v123, v123
    s_waitcnt vmcnt(6)
    v_exp_f32 v124, v124
    v_mfma_f32_32x32x16_bf16 v[104:119], v[172:175], v[16:19], v[40:55]
    v_exp_f32 v125, v125
    v_exp_f32 v126, v126
    v_exp_f32 v127, v127
    v_exp_f32 v128, v128
    v_exp_f32 v129, v129
    v_smfmac_f32_32x32x32_bf16 v[88:103], v[164:167], v[120:127], v251
    v_exp_f32 v130, v130
    v_exp_f32 v131, v131
    v_exp_f32 v132, v132
    v_exp_f32 v133, v133
    v_exp_f32 v134, v134
    v_exp_f32 v135, v135
    v_exp_f32 v104, v104
    v_exp_f32 v105, v105
    v_smfmac_f32_32x32x32_bf16 v[88:103], v[168:171], v[128:135], v251
    v_exp_f32 v106, v106
    buffer_load_dwordx4 v[160:163], v8, s[24:27], s69 offen offset:0 sc1
    s_mov_b64 exec, s[66:67]
    buffer_load_dwordx4 v[164:167], v250, s[24:27], s69 offen offset:1024 sc1
    buffer_load_dwordx4 v[168:171], v250, s[24:27], s69 offen offset:1536 sc1
    s_mov_b64 exec, -1
    v_exp_f32 v107, v107
    v_exp_f32 v108, v108
    v_mfma_f32_32x32x16_bf16 v[120:135], v[172:175], v[20:23], v[56:71]
    v_exp_f32 v109, v109
    v_exp_f32 v110, v110
    v_exp_f32 v111, v111
    v_exp_f32 v112, v112
    v_exp_f32 v113, v113
    v_smfmac_f32_32x32x32_bf16 v[72:87], v[176:179], v[104:111], v251
    v_exp_f32 v114, v114
    v_exp_f32 v115, v115
    v_exp_f32 v116, v116
    v_exp_f32 v117, v117
    v_exp_f32 v118, v118
    v_exp_f32 v119, v119
    v_exp_f32 v120, v120
    v_exp_f32 v121, v121
    v_smfmac_f32_32x32x32_bf16 v[72:87], v[180:183], v[112:119], v251
    v_exp_f32 v122, v122
    v_exp_f32 v123, v123
    s_waitcnt vmcnt(6)
    v_exp_f32 v124, v124
    v_mfma_f32_32x32x16_bf16 v[104:119], v[136:139], v[16:19], v[40:55]
    v_exp_f32 v125, v125
    v_exp_f32 v126, v126
    v_exp_f32 v127, v127
    v_exp_f32 v128, v128
    v_exp_f32 v129, v129
    v_smfmac_f32_32x32x32_bf16 v[88:103], v[176:179], v[120:127], v251
    v_exp_f32 v130, v130
    v_exp_f32 v131, v131
    v_exp_f32 v132, v132
    v_exp_f32 v133, v133
    v_exp_f32 v134, v134
    v_exp_f32 v135, v135
    v_exp_f32 v104, v104
    v_exp_f32 v105, v105
    v_smfmac_f32_32x32x32_bf16 v[88:103], v[180:183], v[128:135], v251
    v_exp_f32 v106, v106
    buffer_load_dwordx4 v[172:175], v8, s[24:27], s69 offen offset:2048 sc1
    s_mov_b64 exec, s[66:67]
    buffer_load_dwordx4 v[176:179], v250, s[24:27], s69 offen offset:3072 sc1
    buffer_load_dwordx4 v[180:183], v250, s[24:27], s69 offen offset:3584 sc1
    s_mov_b64 exec, -1
    s_add_u32 s69, s69, 4096
    s_and_b32 s69, s69, 0x1ffff
    v_exp_f32 v107, v107
    v_exp_f32 v108, v108
    v_mfma_f32_32x32x16_bf16 v[120:135], v[136:139], v[20:23], v[56:71]
    v_exp_f32 v109, v109
    v_exp_f32 v110, v110
    v_exp_f32 v111, v111
    v_exp_f32 v112, v112
    v_exp_f32 v113, v113
    v_smfmac_f32_32x32x32_bf16 v[72:87], v[140:143], v[104:111], v251
    v_exp_f32 v114, v114
    v_exp_f32 v115, v115
    v_exp_f32 v116, v116
    v_exp_f32 v117, v117
    v_exp_f32 v118, v118
    v_exp_f32 v119, v119
    v_exp_f32 v120, v120
    v_exp_f32 v121, v121
    v_smfmac_f32_32x32x32_bf16 v[72:87], v[144:147], v[112:119], v251
    v_exp_f32 v122, v122
    v_exp_f32 v123, v123
    s_waitcnt vmcnt(6)
    v_exp_f32 v124, v124
    v_mfma_f32_32x32x16_bf16 v[104:119], v[148:151], v[16:19], v[40:55]
    v_exp_f32 v125, v125
    v_exp_f32 v126, v126
    v_exp_f32 v127, v127
    v_exp_f32 v128, v128
    v_exp_f32 v129, v129
    v_smfmac_f32_32x32x32_bf16 v[88:103], v[140:143], v[120:127], v251
    v_exp_f32 v130, v130
    v_exp_f32 v131, v131
    v_exp_f32 v132, v132
    v_exp_f32 v133, v133
    v_exp_f32 v134, v134
    v_exp_f32 v135, v135
    v_exp_f32 v104, v104
    v_exp_f32 v105, v105
    v_smfmac_f32_32x32x32_bf16 v[88:103], v[144:147], v[128:135], v251
    v_exp_f32 v106, v106
    buffer_load_dwordx4 v[136:139], v8, s[24:27], s69 offen offset:0 sc1
    s_mov_b64 exec, s[66:67]
    buffer_load_dwordx4 v[140:143], v250, s[24:27], s69 offen offset:1024 sc1
    buffer_load_dwordx4 v[144:147], v250, s[24:27], s69 offen offset:1536 sc1
    s_mov_b64 exec, -1
    v_exp_f32 v107, v107
    v_exp_f32 v108, v108
    v_mfma_f32_32x32x16_bf16 v[120:135], v[148:151], v[20:23], v[56:71]
    v_exp_f32 v109, v109
    v_exp_f32 v110, v110
    v_exp_f32 v111, v111
    v_exp_f32 v112, v112
    v_exp_f32 v113, v113
    v_smfmac_f32_32x32x32_bf16 v[72:87], v[152:155], v[104:111], v251
    v_exp_f32 v114, v114
    v_exp_f32 v115, v115
    v_exp_f32 v116, v116
    v_exp_f32 v117, v117
    v_exp_f32 v118, v118
    v_exp_f32 v119, v119
    v_exp_f32 v120, v120
    v_exp_f32 v121, v121
    v_smfmac_f32_32x32x32_bf16 v[72:87], v[156:159], v[112:119], v251
    v_exp_f32 v122, v122
    v_exp_f32 v123, v123
    s_waitcnt vmcnt(6)
    v_exp_f32 v124, v124
    v_mfma_f32_32x32x16_bf16 v[104:119], v[160:163], v[16:19], v[40:55]
    v_exp_f32 v125, v125
    v_exp_f32 v126, v126
    v_exp_f32 v127, v127
    v_exp_f32 v128, v128
    v_exp_f32 v129, v129
    v_smfmac_f32_32x32x32_bf16 v[88:103], v[152:155], v[120:127], v251
    v_exp_f32 v130, v130
    v_exp_f32 v131, v131
    v_exp_f32 v132, v132
    v_exp_f32 v133, v133
    v_exp_f32 v134, v134
    v_exp_f32 v135, v135
    v_exp_f32 v104, v104
    v_exp_f32 v105, v105
    v_smfmac_f32_32x32x32_bf16 v[88:103], v[156:159], v[128:135], v251
    v_exp_f32 v106, v106
    buffer_load_dwordx4 v[148:151], v8, s[24:27], s69 offen offset:2048 sc1
    s_mov_b64 exec, s[66:67]
    buffer_load_dwordx4 v[152:155], v250, s[24:27], s69 offen offset:3072 sc1
    buffer_load_dwordx4 v[156:159], v250, s[24:27], s69 offen offset:3584 sc1
    s_mov_b64 exec, -1
    s_add_u32 s69, s69, 4096
    s_and_b32 s69, s69, 0x1ffff
    v_exp_f32 v107, v107
    v_exp_f32 v108, v108
    v_mfma_f32_32x32x16_bf16 v[120:135], v[160:163], v[20:23], v[56:71]
    v_exp_f32 v109, v109
    v_exp_f32 v110, v110
    v_exp_f32 v111, v111
    v_exp_f32 v112, v112
    v_exp_f32 v113, v113
    v_smfmac_f32_32x32x32_bf16 v[72:87], v[164:167], v[104:111], v251
    v_exp_f32 v114, v114
    v_exp_f32 v115, v115
    v_exp_f32 v116, v116
    v_exp_f32 v117, v117
    v_exp_f32 v118, v118
    v_exp_f32 v119, v119
    v_exp_f32 v120, v120
    v_exp_f32 v121, v121
    v_smfmac_f32_32x32x32_bf16 v[72:87], v[168:171], v[112:119], v251
    v_exp_f32 v122, v122
    v_exp_f32 v123, v123
    s_waitcnt vmcnt(6)
    v_exp_f32 v124, v124
    v_mfma_f32_32x32x16_bf16 v[104:119], v[172:175], v[16:19], v[40:55]
    v_exp_f32 v125, v125
    v_exp_f32 v126, v126
    v_exp_f32 v127, v127
    v_exp_f32 v128, v128
    v_exp_f32 v129, v129
    v_smfmac_f32_32x32x32_bf16 v[88:103], v[164:167], v[120:127], v251
    v_exp_f32 v130, v130
    v_exp_f32 v131, v131
    v_exp_f32 v132, v132
    v_exp_f32 v133, v133
    v_exp_f32 v134, v134
    v_exp_f32 v135, v135
    v_exp_f32 v104, v104
    v_exp_f32 v105, v105
    v_smfmac_f32_32x32x32_bf16 v[88:103], v[168:171], v[128:135], v251
    v_exp_f32 v106, v106
    buffer_load_dwordx4 v[160:163], v8, s[24:27], s69 offen offset:0 sc1
    s_mov_b64 exec, s[66:67]
    buffer_load_dwordx4 v[164:167], v250, s[24:27], s69 offen offset:1024 sc1
    buffer_load_dwordx4 v[168:171], v250, s[24:27], s69 offen offset:1536 sc1
    s_mov_b64 exec, -1
    v_exp_f32 v107, v107
    v_exp_f32 v108, v108
    v_mfma_f32_32x32x16_bf16 v[120:135], v[172:175], v[20:23], v[56:71]
    v_exp_f32 v109, v109
    v_exp_f32 v110, v110
    v_exp_f32 v111, v111
    v_exp_f32 v112, v112
    v_exp_f32 v113, v113
    v_smfmac_f32_32x32x32_bf16 v[72:87], v[176:179], v[104:111], v251
    v_exp_f32 v114, v114
    v_exp_f32 v115, v115
    v_exp_f32 v116, v116
    v_exp_f32 v117, v117
    v_exp_f32 v118, v118
    v_exp_f32 v119, v119
    v_exp_f32 v120, v120
    v_exp_f32 v121, v121
    v_smfmac_f32_32x32x32_bf16 v[72:87], v[180:183], v[112:119], v251
    v_exp_f32 v122, v122
    v_exp_f32 v123, v123
    s_waitcnt vmcnt(6)
    v_exp_f32 v124, v124
    v_mfma_f32_32x32x16_bf16 v[104:119], v[136:139], v[16:19], v[40:55]
    v_exp_f32 v125, v125
    v_exp_f32 v126, v126
    v_exp_f32 v127, v127
    v_exp_f32 v128, v128
    v_exp_f32 v129, v129
    v_smfmac_f32_32x32x32_bf16 v[88:103], v[176:179], v[120:127], v251
    v_exp_f32 v130, v130
    s_lshl_b32 s74, s5, 7
    s_lshl_b32 s75, s4, 5
    s_add_u32 s74, s74, s75
    s_add_u32 s74, s74, 11608064
    v_lshl_add_u32 v9, v1, 2, s74
    s_mov_b64 exec, 0xff
    buffer_load_dword v10, v9, s[24:27], 0 offen sc1
    s_mov_b64 exec, -1
    v_exp_f32 v131, v131
    v_exp_f32 v132, v132
    v_exp_f32 v133, v133
    v_exp_f32 v134, v134
    v_exp_f32 v135, v135
    v_exp_f32 v104, v104
    v_exp_f32 v105, v105
    v_smfmac_f32_32x32x32_bf16 v[88:103], v[180:183], v[128:135], v251
    v_exp_f32 v106, v106
    buffer_load_dwordx4 v[172:175], v8, s[24:27], s69 offen offset:2048 sc1
    s_mov_b64 exec, s[66:67]
    buffer_load_dwordx4 v[176:179], v250, s[24:27], s69 offen offset:3072 sc1
    buffer_load_dwordx4 v[180:183], v250, s[24:27], s69 offen offset:3584 sc1
    s_mov_b64 exec, -1
    s_add_u32 s69, s69, 4096
    s_and_b32 s69, s69, 0x1ffff
    v_exp_f32 v107, v107
    v_exp_f32 v108, v108
    v_mfma_f32_32x32x16_bf16 v[120:135], v[136:139], v[20:23], v[56:71]
    v_exp_f32 v109, v109
    v_exp_f32 v110, v110
    v_exp_f32 v111, v111
    v_exp_f32 v112, v112
    v_exp_f32 v113, v113
    v_smfmac_f32_32x32x32_bf16 v[72:87], v[140:143], v[104:111], v251
    v_exp_f32 v114, v114
    v_exp_f32 v115, v115
    v_exp_f32 v116, v116
    v_exp_f32 v117, v117
    v_exp_f32 v118, v118
    v_exp_f32 v119, v119
    v_exp_f32 v120, v120
    v_exp_f32 v121, v121
    v_smfmac_f32_32x32x32_bf16 v[72:87], v[144:147], v[112:119], v251
    v_exp_f32 v122, v122
    v_exp_f32 v123, v123
    s_waitcnt vmcnt(7)
    v_exp_f32 v124, v124
    v_mfma_f32_32x32x16_bf16 v[104:119], v[148:151], v[16:19], v[40:55]
    v_exp_f32 v125, v125
    v_exp_f32 v126, v126
    v_exp_f32 v127, v127
    v_exp_f32 v128, v128
    v_exp_f32 v129, v129
    v_smfmac_f32_32x32x32_bf16 v[88:103], v[140:143], v[120:127], v251
    v_exp_f32 v130, v130
    s_waitcnt vmcnt(3)
    s_mov_b32 exec_lo, 255
    s_mov_b32 exec_hi, 0
    s_mov_b32 s78, 2097152
    v_cmp_eq_u32 vcc, 0, v10
    s_nop 0
    s_cbranch_vccz L_polld_19
L_poll_18:
    buffer_load_dword v10, v9, s[24:27], 0 offen sc1
    s_sub_u32 s78, s78, 1
    s_cbranch_scc1 L_polld_19
    s_waitcnt vmcnt(0)
    v_cmp_eq_u32 vcc, 0, v10
    s_nop 0
    s_cbranch_vccnz L_poll_18
L_polld_19:
    s_mov_b64 exec, -1
    s_mov_b64 exec, 1
    s_mov_b32 s78, 33554432
L_cw_20:
    ds_read_b32 v15, v254 offset:28
    s_sub_u32 s78, s78, 1
    s_cbranch_scc1 L_cwd_21
    s_waitcnt lgkmcnt(0)
    v_cmp_gt_u32 vcc, 4, v15
    s_nop 0
    s_cbranch_vccnz L_cw_20
L_cwd_21:
    s_mov_b64 exec, -1
    s_lshl_b32 s74, s5, 16
    s_lshl_b32 s75, s4, 13
    s_add_u32 s74, s74, s75
    s_add_u32 s74, s74, 4194304
    s_add_u32 m0, s75, 65536
    s_nop 0
    buffer_load_dwordx4 v0, s[24:27], s74 offen offset:0 sc1 lds
    buffer_load_dwordx4 v0, s[24:27], s74 offen offset:1024 sc1 lds
    buffer_load_dwordx4 v0, s[24:27], s74 offen offset:2048 sc1 lds
    buffer_load_dwordx4 v0, s[24:27], s74 offen offset:3072 sc1 lds
    v_exp_f32 v131, v131
    v_exp_f32 v132, v132
    v_exp_f32 v133, v133
    v_exp_f32 v134, v134
    v_exp_f32 v135, v135
    v_exp_f32 v104, v104
    v_exp_f32 v105, v105
    v_smfmac_f32_32x32x32_bf16 v[88:103], v[144:147], v[128:135], v251
    v_exp_f32 v106, v106
    v_exp_f32 v107, v107
    v_exp_f32 v108, v108
    v_mfma_f32_32x32x16_bf16 v[120:135], v[148:151], v[20:23], v[56:71]
    v_exp_f32 v109, v109
    v_exp_f32 v110, v110
    v_exp_f32 v111, v111
    v_exp_f32 v112, v112
    v_exp_f32 v113, v113
    v_smfmac_f32_32x32x32_bf16 v[72:87], v[152:155], v[104:111], v251
    v_exp_f32 v114, v114
    v_exp_f32 v115, v115
    v_exp_f32 v116, v116
    v_exp_f32 v117, v117
    v_exp_f32 v118, v118
    v_exp_f32 v119, v119
    v_exp_f32 v120, v120
    v_exp_f32 v121, v121
    v_smfmac_f32_32x32x32_bf16 v[72:87], v[156:159], v[112:119], v251
    v_exp_f32 v122, v122
    v_exp_f32 v123, v123
    v_exp_f32 v124, v124
    v_mfma_f32_32x32x16_bf16 v[104:119], v[160:163], v[16:19], v[40:55]
    v_exp_f32 v125, v125
    v_exp_f32 v126, v126
    v_exp_f32 v127, v127
    v_exp_f32 v128, v128
    v_exp_f32 v129, v129
    v_smfmac_f32_32x32x32_bf16 v[88:103], v[152:155], v[120:127], v251
    v_exp_f32 v130, v130
    s_lshl_b32 s74, s5, 16
    s_lshl_b32 s75, s4, 13
    s_add_u32 s74, s74, s75
    s_add_u32 s74, s74, 4198400
    s_add_u32 m0, s75, 69632
    s_nop 0
    buffer_load_dwordx4 v0, s[24:27], s74 offen offset:0 sc1 lds
    buffer_load_dwordx4 v0, s[24:27], s74 offen offset:1024 sc1 lds
    buffer_load_dwordx4 v0, s[24:27], s74 offen offset:2048 sc1 lds
    buffer_load_dwordx4 v0, s[24:27], s74 offen offset:3072 sc1 lds
    v_exp_f32 v131, v131
    v_exp_f32 v132, v132
    v_exp_f32 v133, v133
    v_exp_f32 v134, v134
    v_exp_f32 v135, v135
    v_exp_f32 v104, v104
    v_exp_f32 v105, v105
    v_smfmac_f32_32x32x32_bf16 v[88:103], v[156:159], v[128:135], v251
    v_exp_f32 v106, v106
    v_exp_f32 v107, v107
    v_exp_f32 v108, v108
    v_mfma_f32_32x32x16_bf16 v[120:135], v[160:163], v[20:23], v[56:71]
    v_exp_f32 v109, v109
    v_exp_f32 v110, v110
    v_exp_f32 v111, v111
    v_exp_f32 v112, v112
    v_exp_f32 v113, v113
    v_smfmac_f32_32x32x32_bf16 v[72:87], v[164:167], v[104:111], v251
    v_exp_f32 v114, v114
    v_exp_f32 v115, v115
    v_exp_f32 v116, v116
    v_exp_f32 v117, v117
    v_exp_f32 v118, v118
    v_exp_f32 v119, v119
    v_exp_f32 v120, v120
    v_exp_f32 v121, v121
    v_smfmac_f32_32x32x32_bf16 v[72:87], v[168:171], v[112:119], v251
    v_exp_f32 v122, v122
    v_exp_f32 v123, v123
    s_waitcnt vmcnt(8)
    v_exp_f32 v124, v124
    v_mfma_f32_32x32x16_bf16 v[104:119], v[172:175], v[16:19], v[40:55]
    v_exp_f32 v125, v125
    v_exp_f32 v126, v126
    v_exp_f32 v127, v127
    v_exp_f32 v128, v128
    v_exp_f32 v129, v129
    v_smfmac_f32_32x32x32_bf16 v[88:103], v[164:167], v[120:127], v251
    v_exp_f32 v130, v130
    s_mul_i32 s74, s4, 4608
    s_add_u32 s74, s74, 141312
    v_add_u32 v6, s74, v0
    v_lshl_add_u32 v7, v1, 2, s74
    s_lshl_b32 s74, s5, 6
    s_add_u32 s74, s74, s7
    s_lshl_b32 s74, s74, 10
    s_add_u32 s61, s74, 6291456
    s_add_u32 s62, s61, 0x8000
    s_mul_i32 s74, s5, 1024
    s_lshr_b32 s75, s6, 1
    s_mul_i32 s75, s75, 32
    s_add_u32 s74, s74, s75
    s_and_b32 s75, s6, 1
    s_lshl_b32 s75, s75, 2
    s_add_u32 s74, s74, s75
    s_add_u32 s74, s74, 11620352
    v_mul_u32_u24 v249, 128, v1
    v_add_u32 v249, s74, v249
    s_lshl_b32 s74, s5, 16
    s_lshl_b32 s75, s4, 13
    s_add_u32 s74, s74, s75
    s_add_u32 s74, s74, 4227072
    s_add_u32 m0, s75, 98304
    s_nop 0
    buffer_load_dwordx4 v0, s[24:27], s74 offen offset:0 sc1 lds
    buffer_load_dwordx4 v0, s[24:27], s74 offen offset:1024 sc1 lds
    buffer_load_dwordx4 v0, s[24:27], s74 offen offset:2048 sc1 lds
    buffer_load_dwordx4 v0, s[24:27], s74 offen offset:3072 sc1 lds
    v_exp_f32 v131, v131
    v_exp_f32 v132, v132
    v_exp_f32 v133, v133
    v_exp_f32 v134, v134
    v_exp_f32 v135, v135
    v_exp_f32 v104, v104
    v_exp_f32 v105, v105
    v_smfmac_f32_32x32x32_bf16 v[88:103], v[168:171], v[128:135], v251
    v_exp_f32 v106, v106
    v_exp_f32 v107, v107
    v_exp_f32 v108, v108
    v_mfma_f32_32x32x16_bf16 v[120:135], v[172:175], v[20:23], v[56:71]
    v_exp_f32 v109, v109
    v_exp_f32 v110, v110
    v_exp_f32 v111, v111
    v_exp_f32 v112, v112
    v_exp_f32 v113, v113
    v_smfmac_f32_32x32x32_bf16 v[72:87], v[176:179], v[104:111], v251
    v_exp_f32 v114, v114
    v_exp_f32 v115, v115
    v_exp_f32 v116, v116
    v_exp_f32 v117, v117
    v_exp_f32 v118, v118
    v_exp_f32 v119, v119
    v_exp_f32 v120, v120
    v_exp_f32 v121, v121
    v_smfmac_f32_32x32x32_bf16 v[72:87], v[180:183], v[112:119], v251
    v_exp_f32 v122, v122
    v_exp_f32 v123, v123
    v_exp_f32 v124, v124
    v_exp_f32 v125, v125
    v_exp_f32 v126, v126
    v_exp_f32 v127, v127
    v_exp_f32 v128, v128
    v_exp_f32 v129, v129
    v_smfmac_f32_32x32x32_bf16 v[88:103], v[176:179], v[120:127], v251
    v_exp_f32 v130, v130
    s_lshl_b32 s74, s5, 16
    s_lshl_b32 s75, s4, 13
    s_add_u32 s74, s74, s75
    s_add_u32 s74, s74, 4231168
    s_add_u32 m0, s75, 102400
    s_nop 0
    buffer_load_dwordx4 v0, s[24:27], s74 offen offset:0 sc1 lds
    buffer_load_dwordx4 v0, s[24:27], s74 offen offset:1024 sc1 lds
    buffer_load_dwordx4 v0, s[24:27], s74 offen offset:2048 sc1 lds
    buffer_load_dwordx4 v0, s[24:27], s74 offen offset:3072 sc1 lds
    v_exp_f32 v131, v131
    v_exp_f32 v132, v132
    v_exp_f32 v133, v133
    v_exp_f32 v134, v134
    v_exp_f32 v135, v135
    s_nop 1
    v_smfmac_f32_32x32x32_bf16 v[88:103], v[180:183], v[128:135], v251
    s_waitcnt vmcnt(0)
L_tail:
    s_cmp_lt_u32 s3, 4
    s_cbranch_scc1 L_tailB
    v_maximum3_f32 v40, abs(v72), abs(v73), abs(v74)
    v_maximum3_f32 v42, abs(v75), abs(v76), abs(v77)
    v_maximum3_f32 v40, v40, abs(v78), abs(v79)
    v_maximum3_f32 v40, v40, v42, v42
    s_nop 4
    v_maximum3_f32 v41, abs(v88), abs(v89), abs(v90)
    v_maximum3_f32 v43, abs(v91), abs(v92), abs(v93)
    v_maximum3_f32 v41, v41, abs(v94), abs(v95)
    v_maximum3_f32 v41, v41, v43, v43
    s_mov_b32 s76, 209715200
    s_mov_b32 s77, 125829120
    v_maximum3_f32 v44, v40, v41, v80
    v_cmp_le_f32 s[84:85], s76, v80
    v_cmp_gt_f32 s[86:87], s77, v40
    v_maximum3_f32 v44, v44, v96, v96
    v_cmp_le_f32 s[88:89], s76, v96
    v_cmp_gt_f32 s[90:91], s77, v41
    v_cmp_ngt_f32 vcc, 2113929216, v44
    s_and_b64 s[84:85], s[84:85], s[86:87]
    s_and_b64 s[88:89], s[88:89], s[90:91]
    s_or_b64 s[84:85], s[84:85], s[88:89]
    s_or_b64 vcc, vcc, s[84:85]
    s_cbranch_vccz L_good_22
    ds_write_b32 v254, v253
L_good_22:
    s_waitcnt lgkmcnt(0)
    s_barrier
    ds_read_b32 v120, v7 offset:4096
    ds_read_b32 v121, v7 offset:4352
    ds_read_b32 v40, v254
    ds_read_b128 v[104:107], v6
    ds_read_b128 v[108:111], v6 offset:1024
    ds_read_b128 v[112:115], v6 offset:2048
    ds_read_b128 v[116:119], v6 offset:3072
    s_waitcnt lgkmcnt(4)
    v_add_f32 v80, v80, v120
    v_add_f32 v96, v96, v121
    v_readfirstlane_b32 s75, v40
    v_rcp_f32 v82, v80
    v_rcp_f32 v98, v96
    s_andn2_b32 s75, s75, s73
    s_cmp_lg_u32 s75, 0
    s_cbranch_scc1 L_slow
    s_waitcnt lgkmcnt(2)
    v_pk_add_f32 v[72:73], v[72:73], v[104:105]
    v_pk_add_f32 v[74:75], v[74:75], v[106:107]
    v_pk_add_f32 v[76:77], v[76:77], v[108:109]
    v_pk_add_f32 v[78:79], v[78:79], v[110:111]
    v_pk_mul_f32 v[72:73], v[72:73], v[82:83] op_sel:[0,0] op_sel_hi:[1,0]
    v_pk_mul_f32 v[74:75], v[74:75], v[82:83] op_sel:[0,0] op_sel_hi:[1,0]
    v_pk_mul_f32 v[76:77], v[76:77], v[82:83] op_sel:[0,0] op_sel_hi:[1,0]
    v_pk_mul_f32 v[78:79], v[78:79], v[82:83] op_sel:[0,0] op_sel_hi:[1,0]
    v_cvt_pk_bf16_f32 v124, v72, v73
    v_cvt_pk_bf16_f32 v125, v74, v75
    v_cvt_pk_bf16_f32 v126, v76, v77
    v_cvt_pk_bf16_f32 v127, v78, v79
    v_min_u32 v124, -2, v124
    v_min_u32 v125, -2, v125
    v_min_u32 v126, -2, v126
    v_min_u32 v127, -2, v127
    buffer_store_dwordx4 v[124:127], v0, s[24:27], s61 offen sc1
    s_waitcnt lgkmcnt(0)
    v_pk_add_f32 v[88:89], v[88:89], v[112:113]
    v_pk_add_f32 v[90:91], v[90:91], v[114:115]
    v_pk_add_f32 v[92:93], v[92:93], v[116:117]
    v_pk_add_f32 v[94:95], v[94:95], v[118:119]
    v_pk_mul_f32 v[88:89], v[88:89], v[98:99] op_sel:[0,0] op_sel_hi:[1,0]
    v_pk_mul_f32 v[90:91], v[90:91], v[98:99] op_sel:[0,0] op_sel_hi:[1,0]
    v_pk_mul_f32 v[92:93], v[92:93], v[98:99] op_sel:[0,0] op_sel_hi:[1,0]
    v_pk_mul_f32 v[94:95], v[94:95], v[98:99] op_sel:[0,0] op_sel_hi:[1,0]
    v_cvt_pk_bf16_f32 v128, v88, v89
    v_cvt_pk_bf16_f32 v129, v90, v91
    v_cvt_pk_bf16_f32 v130, v92, v93
    v_cvt_pk_bf16_f32 v131, v94, v95
    v_min_u32 v128, -2, v128
    v_min_u32 v129, -2, v129
    v_min_u32 v130, -2, v130
    v_min_u32 v131, -2, v131
    buffer_store_dwordx4 v[128:131], v0, s[24:27], s62 offen sc1
    s_cmp_lg_u32 s3, 7
    s_cbranch_scc1 L_nohint_23
    v_mov_b32 v15, 1
    s_mov_b32 exec_lo, 255
    s_mov_b32 exec_hi, 0
    buffer_store_dword v15, v249, s[24:27], 0 offen sc1
    s_mov_b64 exec, -1
L_nohint_23:
    s_and_b32 s76, s4, 1
    s_lshl_b32 s74, s4, 10
    s_add_u32 s74, s74, 131072
    v_add_u32 v2, s74, v0
    ds_write_b128 v2, v[124:127]
    v_xor_b32 v2, 0x1000, v2
    ds_write_b128 v2, v[128:131]
    v_bfe_u32 v14, v1, 2, 2
    v_lshrrev_b32 v15, 5, v1
    v_lshl_add_u32 v14, v15, 2, v14
    v_lshlrev_b32 v12, 7, v14
    s_lshr_b32 s75, s4, 1
    v_bfe_u32 v14, v1, 3, 1
    v_xor_b32 v14, s75, v14
    v_lshl_add_u32 v12, v14, 6, v12
    v_and_b32 v14, 1, v1
    v_lshl_add_u32 v12, v14, 5, v12
    v_bfe_u32 v14, v1, 4, 1
    v_lshl_add_u32 v12, v14, 4, v12
    v_bfe_u32 v14, v1, 1, 1
    v_lshl_add_u32 v12, v14, 3, v12
    s_lshl_b32 s74, s76, 15
    s_add_u32 s74, s74, 65536
    v_add_u32 v5, s74, v0
    s_waitcnt lgkmcnt(0)
    s_mov_b64 exec, 1
    ds_add_u32 v254, v253 offset:24
    s_mov_b64 exec, -1
    s_setprio 0
    ds_read_b64_tr_b16 v[136:137], v12 offset:0
    ds_read_b64_tr_b16 v[138:139], v12 offset:1024
    ds_read_b128 v[16:19], v5 offset:0
    ds_read_b64_tr_b16 v[140:141], v12 offset:2048
    ds_read_b64_tr_b16 v[142:143], v12 offset:3072
    ds_read_b128 v[20:23], v5 offset:1024
    ds_read_b64_tr_b16 v[144:145], v12 offset:4096
    ds_read_b64_tr_b16 v[146:147], v12 offset:5120
    ds_read_b128 v[24:27], v5 offset:2048
    ds_read_b64_tr_b16 v[148:149], v12 offset:6144
    ds_read_b64_tr_b16 v[150:151], v12 offset:7168
    ds_read_b128 v[28:31], v5 offset:3072
    s_waitcnt lgkmcnt(9)
    v_mfma_f32_32x32x16_bf16 v[80:95], v[136:139], v[16:19], 0
    ds_read_b64_tr_b16 v[152:153], v12 offset:8192
    ds_read_b64_tr_b16 v[154:155], v12 offset:9216
    ds_read_b128 v[32:35], v5 offset:4096
    s_waitcnt lgkmcnt(9)
    v_mfma_f32_32x32x16_bf16 v[80:95], v[140:143], v[20:23], v[80:95]
    ds_read_b64_tr_b16 v[156:157], v12 offset:10240
    ds_read_b64_tr_b16 v[158:159], v12 offset:11264
    ds_read_b128 v[36:39], v5 offset:5120
    s_waitcnt lgkmcnt(9)
    v_mfma_f32_32x32x16_bf16 v[80:95], v[144:147], v[24:27], v[80:95]
    ds_read_b64_tr_b16 v[160:161], v12 offset:12288
    ds_read_b64_tr_b16 v[162:163], v12 offset:13312
    ds_read_b128 v[40:43], v5 offset:6144
    s_waitcnt lgkmcnt(9)
    v_mfma_f32_32x32x16_bf16 v[80:95], v[148:151], v[28:31], v[80:95]
    ds_read_b64_tr_b16 v[164:165], v12 offset:14336
    ds_read_b64_tr_b16 v[166:167], v12 offset:15360
    ds_read_b128 v[44:47], v5 offset:7168
    s_waitcnt lgkmcnt(9)
    v_mfma_f32_32x32x16_bf16 v[80:95], v[152:155], v[32:35], v[80:95]
    ds_read_b64_tr_b16 v[136:137], v12 offset:16384
    ds_read_b64_tr_b16 v[138:139], v12 offset:17408
    ds_read_b128 v[16:19], v5 offset:8192
    s_waitcnt lgkmcnt(9)
    v_mfma_f32_32x32x16_bf16 v[80:95], v[156:159], v[36:39], v[80:95]
    ds_read_b64_tr_b16 v[140:141], v12 offset:18432
    ds_read_b64_tr_b16 v[142:143], v12 offset:19456
    ds_read_b128 v[20:23], v5 offset:9216
    s_waitcnt lgkmcnt(9)
    v_mfma_f32_32x32x16_bf16 v[80:95], v[160:163], v[40:43], v[80:95]
    ds_read_b64_tr_b16 v[144:145], v12 offset:20480
    ds_read_b64_tr_b16 v[146:147], v12 offset:21504
    ds_read_b128 v[24:27], v5 offset:10240
    s_waitcnt lgkmcnt(9)
    v_mfma_f32_32x32x16_bf16 v[80:95], v[164:167], v[44:47], v[80:95]
    ds_read_b64_tr_b16 v[148:149], v12 offset:22528
    ds_read_b64_tr_b16 v[150:151], v12 offset:23552
    ds_read_b128 v[28:31], v5 offset:11264
    s_waitcnt lgkmcnt(9)
    v_mfma_f32_32x32x16_bf16 v[80:95], v[136:139], v[16:19], v[80:95]
    ds_read_b64_tr_b16 v[152:153], v12 offset:24576
    ds_read_b64_tr_b16 v[154:155], v12 offset:25600
    ds_read_b128 v[32:35], v5 offset:12288
    s_waitcnt lgkmcnt(9)
    v_mfma_f32_32x32x16_bf16 v[80:95], v[140:143], v[20:23], v[80:95]
    ds_read_b64_tr_b16 v[156:157], v12 offset:26624
    ds_read_b64_tr_b16 v[158:159], v12 offset:27648
    ds_read_b128 v[36:39], v5 offset:13312
    s_waitcnt lgkmcnt(9)
    v_mfma_f32_32x32x16_bf16 v[80:95], v[144:147], v[24:27], v[80:95]
    ds_read_b64_tr_b16 v[160:161], v12 offset:28672
    ds_read_b64_tr_b16 v[162:163], v12 offset:29696
    ds_read_b128 v[40:43], v5 offset:14336
    s_waitcnt lgkmcnt(9)
    v_mfma_f32_32x32x16_bf16 v[80:95], v[148:151], v[28:31], v[80:95]
    ds_read_b64_tr_b16 v[164:165], v12 offset:30720
    ds_read_b64_tr_b16 v[166:167], v12 offset:31744
    ds_read_b128 v[44:47], v5 offset:15360
    s_waitcnt lgkmcnt(9)
    v_mfma_f32_32x32x16_bf16 v[80:95], v[152:155], v[32:35], v[80:95]
    ds_read_b64_tr_b16 v[136:137], v12 offset:32768
    ds_read_b64_tr_b16 v[138:139], v12 offset:33792
    ds_read_b128 v[16:19], v5 offset:16384
    s_waitcnt lgkmcnt(9)
    v_mfma_f32_32x32x16_bf16 v[80:95], v[156:159], v[36:39], v[80:95]
    ds_read_b64_tr_b16 v[140:141], v12 offset:34816
    ds_read_b64_tr_b16 v[142:143], v12 offset:35840
    ds_read_b128 v[20:23], v5 offset:17408
    s_waitcnt lgkmcnt(9)
    v_mfma_f32_32x32x16_bf16 v[80:95], v[160:163], v[40:43], v[80:95]
    ds_read_b64_tr_b16 v[144:145], v12 offset:36864
    ds_read_b64_tr_b16 v[146:147], v12 offset:37888
    ds_read_b128 v[24:27], v5 offset:18432
    s_waitcnt lgkmcnt(9)
    v_mfma_f32_32x32x16_bf16 v[80:95], v[164:167], v[44:47], v[80:95]
    ds_read_b64_tr_b16 v[148:149], v12 offset:38912
    ds_read_b64_tr_b16 v[150:151], v12 offset:39936
    ds_read_b128 v[28:31], v5 offset:19456
    s_waitcnt lgkmcnt(9)
    v_mfma_f32_32x32x16_bf16 v[80:95], v[136:139], v[16:19], v[80:95]
    ds_read_b64_tr_b16 v[152:153], v12 offset:40960
    ds_read_b64_tr_b16 v[154:155], v12 offset:41984
    ds_read_b128 v[32:35], v5 offset:20480
    s_waitcnt lgkmcnt(9)
    v_mfma_f32_32x32x16_bf16 v[80:95], v[140:143], v[20:23], v[80:95]
    ds_read_b64_tr_b16 v[156:157], v12 offset:43008
    ds_read_b64_tr_b16 v[158:159], v12 offset:44032
    ds_read_b128 v[36:39], v5 offset:21504
    s_waitcnt lgkmcnt(9)
    v_mfma_f32_32x32x16_bf16 v[80:95], v[144:147], v[24:27], v[80:95]
    ds_read_b64_tr_b16 v[160:161], v12 offset:45056
    ds_read_b64_tr_b16 v[162:163], v12 offset:46080
    ds_read_b128 v[40:43], v5 offset:22528
    s_waitcnt lgkmcnt(9)
    v_mfma_f32_32x32x16_bf16 v[80:95], v[148:151], v[28:31], v[80:95]
    ds_read_b64_tr_b16 v[164:165], v12 offset:47104
    ds_read_b64_tr_b16 v[166:167], v12 offset:48128
    ds_read_b128 v[44:47], v5 offset:23552
    s_waitcnt lgkmcnt(9)
    v_mfma_f32_32x32x16_bf16 v[80:95], v[152:155], v[32:35], v[80:95]
    ds_read_b64_tr_b16 v[136:137], v12 offset:49152
    ds_read_b64_tr_b16 v[138:139], v12 offset:50176
    ds_read_b128 v[16:19], v5 offset:24576
    s_waitcnt lgkmcnt(9)
    v_mfma_f32_32x32x16_bf16 v[80:95], v[156:159], v[36:39], v[80:95]
    ds_read_b64_tr_b16 v[140:141], v12 offset:51200
    ds_read_b64_tr_b16 v[142:143], v12 offset:52224
    ds_read_b128 v[20:23], v5 offset:25600
    s_waitcnt lgkmcnt(9)
    v_mfma_f32_32x32x16_bf16 v[80:95], v[160:163], v[40:43], v[80:95]
    ds_read_b64_tr_b16 v[144:145], v12 offset:53248
    ds_read_b64_tr_b16 v[146:147], v12 offset:54272
    ds_read_b128 v[24:27], v5 offset:26624
    s_waitcnt lgkmcnt(9)
    v_mfma_f32_32x32x16_bf16 v[80:95], v[164:167], v[44:47], v[80:95]
    ds_read_b64_tr_b16 v[148:149], v12 offset:55296
    ds_read_b64_tr_b16 v[150:151], v12 offset:56320
    ds_read_b128 v[28:31], v5 offset:27648
    s_waitcnt lgkmcnt(9)
    v_mfma_f32_32x32x16_bf16 v[80:95], v[136:139], v[16:19], v[80:95]
    ds_read_b64_tr_b16 v[152:153], v12 offset:57344
    ds_read_b64_tr_b16 v[154:155], v12 offset:58368
    ds_read_b128 v[32:35], v5 offset:28672
    s_waitcnt lgkmcnt(9)
    v_mfma_f32_32x32x16_bf16 v[80:95], v[140:143], v[20:23], v[80:95]
    ds_read_b64_tr_b16 v[156:157], v12 offset:59392
    ds_read_b64_tr_b16 v[158:159], v12 offset:60416
    ds_read_b128 v[36:39], v5 offset:29696
    s_waitcnt lgkmcnt(9)
    v_mfma_f32_32x32x16_bf16 v[80:95], v[144:147], v[24:27], v[80:95]
    ds_read_b64_tr_b16 v[160:161], v12 offset:61440
    ds_read_b64_tr_b16 v[162:163], v12 offset:62464
    ds_read_b128 v[40:43], v5 offset:30720
    s_waitcnt lgkmcnt(9)
    v_mfma_f32_32x32x16_bf16 v[80:95], v[148:151], v[28:31], v[80:95]
    ds_read_b64_tr_b16 v[164:165], v12 offset:63488
    ds_read_b64_tr_b16 v[166:167], v12 offset:64512
    ds_read_b128 v[44:47], v5 offset:31744
    v_lshrrev_b32 v14, 2, v1
    s_lshl_b32 s74, s5, 1
    s_add_u32 s74, s74, s76
    s_lshl_b32 s74, s74, 5
    v_add_u32 v14, s74, v14
    v_lshlrev_b32 v7, 11, v14
    v_and_b32 v14, 3, v1
    v_lshl_add_u32 v7, v14, 4, v7
    v_and_b32 v14, 31, v1
    v_lshlrev_b32 v14, 6, v14
    v_lshrrev_b32 v15, 5, v1
    v_lshl_add_u32 v14, v15, 5, v14
    s_mul_i32 s74, s4, 4608
    s_add_u32 s74, s74, 141312
    v_add_u32 v9, s74, v14
    s_lshl_b32 s74, s6, 7
    s_lshr_b32 s75, s4, 1
    s_lshl_b32 s75, s75, 6
    s_add_u32 s74, s74, s75
    v_add_u32 v7, s74, v7
    s_waitcnt lgkmcnt(9)
    v_mfma_f32_32x32x16_bf16 v[80:95], v[152:155], v[32:35], v[80:95]
    s_waitcnt lgkmcnt(6)
    v_mfma_f32_32x32x16_bf16 v[80:95], v[156:159], v[36:39], v[80:95]
    s_waitcnt lgkmcnt(3)
    v_mfma_f32_32x32x16_bf16 v[80:95], v[160:163], v[40:43], v[80:95]
    s_waitcnt lgkmcnt(0)
    v_mfma_f32_32x32x16_bf16 v[80:95], v[164:167], v[44:47], v[80:95]
    s_mov_b64 exec, 1
    ds_add_u32 v254, v253 offset:20
    s_mov_b64 exec, -1
    s_nop 8
    v_cvt_pk_bf16_f32 v48, v80, v81
    v_cvt_pk_bf16_f32 v49, v82, v83
    v_cvt_pk_bf16_f32 v50, v84, v85
    v_cvt_pk_bf16_f32 v51, v86, v87
    v_cvt_pk_bf16_f32 v52, v88, v89
    v_cvt_pk_bf16_f32 v53, v90, v91
    v_cvt_pk_bf16_f32 v54, v92, v93
    v_cvt_pk_bf16_f32 v55, v94, v95
    ds_write_b128 v9, v[48:51]
    ds_write_b128 v9, v[52:55] offset:16
    v_add_u32 v10, 0x8000, v7
    s_waitcnt lgkmcnt(0)
    ds_read_b128 v[56:59], v6
    ds_read_b128 v[60:63], v6 offset:1024
    s_waitcnt lgkmcnt(1)
    buffer_store_dwordx4 v[56:59], v7, s[28:31], 0 offen sc1
    s_waitcnt lgkmcnt(0)
    buffer_store_dwordx4 v[60:63], v10, s[28:31], 0 offen sc1
    s_branch L_fin8
    s_branch L_fin
L_tailB:
    ds_write_b128 v6, v[72:75]
    ds_write_b128 v6, v[76:79] offset:1024
    ds_write_b32 v7, v80 offset:4096
    s_nop 5
    ds_write_b128 v6, v[88:91] offset:2048
    ds_write_b128 v6, v[92:95] offset:3072
    ds_write_b32 v7, v96 offset:4352
    v_maximum3_f32 v40, abs(v72), abs(v73), abs(v74)
    v_maximum3_f32 v42, abs(v75), abs(v76), abs(v77)
    v_maximum3_f32 v40, v40, abs(v78), abs(v79)
    v_maximum3_f32 v40, v40, v42, v42
    v_maximum3_f32 v41, abs(v88), abs(v89), abs(v90)
    v_maximum3_f32 v43, abs(v91), abs(v92), abs(v93)
    v_maximum3_f32 v41, v41, abs(v94), abs(v95)
    v_maximum3_f32 v41, v41, v43, v43
    s_mov_b32 s76, 209715200
    s_mov_b32 s77, 125829120
    v_maximum3_f32 v44, v40, v41, v80
    v_cmp_le_f32 s[84:85], s76, v80
    v_cmp_gt_f32 s[86:87], s77, v40
    v_maximum3_f32 v44, v44, v96, v96
    v_cmp_le_f32 s[88:89], s76, v96
    v_cmp_gt_f32 s[90:91], s77, v41
    v_cmp_ngt_f32 vcc, 2113929216, v44
    s_and_b64 s[84:85], s[84:85], s[86:87]
    s_and_b64 s[88:89], s[88:89], s[90:91]
    s_or_b64 s[84:85], s[84:85], s[88:89]
    s_or_b64 vcc, vcc, s[84:85]
    s_cbranch_vccz L_good_24
    ds_write_b32 v254, v253
L_good_24:
    s_waitcnt lgkmcnt(0)
    s_barrier
    ds_read_b32 v40, v254
    s_mov_b64 exec, 3
    buffer_load_dword v248, v249, s[24:27], 0 offen sc1
    s_mov_b64 exec, -1
    v_pk_mov_b32 v[168:169], 0, 0
    v_pk_mov_b32 v[170:171], 0, 0
    s_waitcnt lgkmcnt(0)
    v_readfirstlane_b32 s75, v40
    s_nop 0
    s_andn2_b32 s75, s75, s73
    s_cmp_lg_u32 s75, 0
    s_cbranch_scc1 L_slow
    s_setprio 2
    v_mfma_f32_32x32x16_bf16 v[104:119], v[168:171], v[168:171], 0
    v_mfma_f32_32x32x16_bf16 v[120:135], v[168:171], v[168:171], 0
    v_mfma_f32_32x32x16_bf16 v[136:151], v[168:171], v[168:171], 0
    v_mfma_f32_32x32x16_bf16 v[152:167], v[168:171], v[168:171], 0
    v_and_b32 v14, 31, v1
    s_lshl_b32 s74, s5, 1
    s_add_u32 s74, s74, 0
    s_lshl_b32 s74, s74, 5
    v_add_u32 v14, s74, v14
    v_lshlrev_b32 v7, 11, v14
    v_lshrrev_b32 v14, 5, v1
    v_lshl_add_u32 v7, v14, 5, v7
    s_lshl_b32 s74, s6, 7
    s_lshr_b32 s75, s4, 1
    s_lshl_b32 s75, s75, 6
    s_add_u32 s74, s74, s75
    s_and_b32 s75, s4, 1
    s_lshl_b32 s75, s75, 4
    s_add_u32 s74, s74, s75
    v_add_u32 v7, s74, v7
    v_add_u32 v11, 131072, v0
    s_lshr_b32 s74, s4, 1
    s_lshl_b32 s74, s74, 2
    s_and_b32 s75, s4, 1
    s_add_u32 s74, s74, s75
    v_lshrrev_b32 v14, 5, v1
    v_lshl_add_u32 v14, v14, 1, s74
    v_and_b32 v15, 7, v1
    v_xor_b32 v14, v14, v15
    v_and_b32 v15, 31, v1
    v_lshlrev_b32 v15, 7, v15
    v_lshl_add_u32 v10, v14, 4, v15
    s_lshl_b32 s74, s4, 14
    v_add_u32 v10, s74, v10
    s_andn2_b32 s84, 3, s63
    s_mov_b32 s85, 0
    s_mov_b32 s68, 2097152
    s_waitcnt vmcnt(0)
    s_mov_b64 exec, 3
    v_cmp_ne_u32 vcc, 0, v248
    s_mov_b64 exec, -1
    s_cmp_eq_u32 s68, 0
    s_cselect_b32 s88, 3, vcc_lo
    s_and_b32 s88, s88, s84
    s_andn2_b32 s88, s88, s85
    s_bitcmp1_b32 s88, 0
    s_cbranch_scc0 L_nol_25
    s_add_u32 s74, s61, 0
    buffer_load_dwordx4 v[16:19], v0, s[24:27], s74 offen offset:0 sc1
    buffer_load_dwordx4 v[20:23], v0, s[24:27], s74 offen offset:1024 sc1
    buffer_load_dwordx4 v[24:27], v0, s[24:27], s74 offen offset:2048 sc1
    buffer_load_dwordx4 v[28:31], v0, s[24:27], s74 offen offset:3072 sc1
    s_add_u32 s74, s61, 32768
    buffer_load_dwordx4 v[32:35], v0, s[24:27], s74 offen offset:0 sc1
    buffer_load_dwordx4 v[36:39], v0, s[24:27], s74 offen offset:1024 sc1
    buffer_load_dwordx4 v[40:43], v0, s[24:27], s74 offen offset:2048 sc1
    buffer_load_dwordx4 v[44:47], v0, s[24:27], s74 offen offset:3072 sc1
L_nol_25:
    s_bitcmp1_b32 s88, 1
    s_cbranch_scc0 L_nol_26
    s_add_u32 s74, s61, 4096
    buffer_load_dwordx4 v[48:51], v0, s[24:27], s74 offen offset:0 sc1
    buffer_load_dwordx4 v[52:55], v0, s[24:27], s74 offen offset:1024 sc1
    buffer_load_dwordx4 v[56:59], v0, s[24:27], s74 offen offset:2048 sc1
    buffer_load_dwordx4 v[60:63], v0, s[24:27], s74 offen offset:3072 sc1
    s_add_u32 s74, s61, 36864
    buffer_load_dwordx4 v[64:67], v0, s[24:27], s74 offen offset:0 sc1
    buffer_load_dwordx4 v[68:71], v0, s[24:27], s74 offen offset:1024 sc1
    buffer_load_dwordx4 v[72:75], v0, s[24:27], s74 offen offset:2048 sc1
    buffer_load_dwordx4 v[76:79], v0, s[24:27], s74 offen offset:3072 sc1
L_nol_26:
    s_mov_b32 s85, s88
    s_cmp_eq_u32 s63, 0
    s_cbranch_scc1 L_noown_27
    s_mov_b64 exec, 1
    s_mov_b32 s78, 33554432
L_cw_28:
    ds_read_b32 v15, v254 offset:24
    s_sub_u32 s78, s78, 1
    s_cbranch_scc1 L_cwd_29
    s_waitcnt lgkmcnt(0)
    v_cmp_gt_u32 vcc, 4, v15
    s_nop 0
    s_cbranch_vccnz L_cw_28
L_cwd_29:
    s_mov_b64 exec, -1
    s_bitcmp1_b32 s63, 0
    s_cbranch_scc0 L_own_30
    ds_read_b128 v[16:19], v11 offset:0
    ds_read_b128 v[20:23], v11 offset:1024
    ds_read_b128 v[24:27], v11 offset:2048
    ds_read_b128 v[28:31], v11 offset:3072
    ds_read_b128 v[32:35], v11 offset:4096
    ds_read_b128 v[36:39], v11 offset:5120
    ds_read_b128 v[40:43], v11 offset:6144
    ds_read_b128 v[44:47], v11 offset:7168
    s_waitcnt lgkmcnt(0)
    v_mfma_f32_32x32x16_bf16 v[104:119], v[184:187], v[16:19], v[104:119]
    v_mfma_f32_32x32x16_bf16 v[120:135], v[216:219], v[16:19], v[120:135]
    v_mfma_f32_32x32x16_bf16 v[104:119], v[188:191], v[20:23], v[104:119]
    v_mfma_f32_32x32x16_bf16 v[120:135], v[220:223], v[20:23], v[120:135]
    v_mfma_f32_32x32x16_bf16 v[104:119], v[192:195], v[24:27], v[104:119]
    v_mfma_f32_32x32x16_bf16 v[120:135], v[224:227], v[24:27], v[120:135]
    v_mfma_f32_32x32x16_bf16 v[104:119], v[196:199], v[28:31], v[104:119]
    v_mfma_f32_32x32x16_bf16 v[120:135], v[228:231], v[28:31], v[120:135]
    v_mfma_f32_32x32x16_bf16 v[136:151], v[184:187], v[32:35], v[136:151]
    v_mfma_f32_32x32x16_bf16 v[152:167], v[216:219], v[32:35], v[152:167]
    v_mfma_f32_32x32x16_bf16 v[136:151], v[188:191], v[36:39], v[136:151]
    v_mfma_f32_32x32x16_bf16 v[152:167], v[220:223], v[36:39], v[152:167]
    v_mfma_f32_32x32x16_bf16 v[136:151], v[192:195], v[40:43], v[136:151]
    v_mfma_f32_32x32x16_bf16 v[152:167], v[224:227], v[40:43], v[152:167]
    v_mfma_f32_32x32x16_bf16 v[136:151], v[196:199], v[44:47], v[136:151]
    v_mfma_f32_32x32x16_bf16 v[152:167], v[228:231], v[44:47], v[152:167]
L_own_30:
    s_bitcmp1_b32 s63, 1
    s_cbranch_scc0 L_own_31
    ds_read_b128 v[48:51], v11 offset:0
    ds_read_b128 v[52:55], v11 offset:1024
    ds_read_b128 v[56:59], v11 offset:2048
    ds_read_b128 v[60:63], v11 offset:3072
    ds_read_b128 v[64:67], v11 offset:4096
    ds_read_b128 v[68:71], v11 offset:5120
    ds_read_b128 v[72:75], v11 offset:6144
    ds_read_b128 v[76:79], v11 offset:7168
    s_waitcnt lgkmcnt(0)
    v_mfma_f32_32x32x16_bf16 v[104:119], v[200:203], v[48:51], v[104:119]
    v_mfma_f32_32x32x16_bf16 v[120:135], v[232:235], v[48:51], v[120:135]
    v_mfma_f32_32x32x16_bf16 v[104:119], v[204:207], v[52:55], v[104:119]
    v_mfma_f32_32x32x16_bf16 v[120:135], v[236:239], v[52:55], v[120:135]
    v_mfma_f32_32x32x16_bf16 v[104:119], v[208:211], v[56:59], v[104:119]
    v_mfma_f32_32x32x16_bf16 v[120:135], v[240:243], v[56:59], v[120:135]
    v_mfma_f32_32x32x16_bf16 v[104:119], v[212:215], v[60:63], v[104:119]
    v_mfma_f32_32x32x16_bf16 v[120:135], v[244:247], v[60:63], v[120:135]
    v_mfma_f32_32x32x16_bf16 v[136:151], v[200:203], v[64:67], v[136:151]
    v_mfma_f32_32x32x16_bf16 v[152:167], v[232:235], v[64:67], v[152:167]
    v_mfma_f32_32x32x16_bf16 v[136:151], v[204:207], v[68:71], v[136:151]
    v_mfma_f32_32x32x16_bf16 v[152:167], v[236:239], v[68:71], v[152:167]
    v_mfma_f32_32x32x16_bf16 v[136:151], v[208:211], v[72:75], v[136:151]
    v_mfma_f32_32x32x16_bf16 v[152:167], v[240:243], v[72:75], v[152:167]
    v_mfma_f32_32x32x16_bf16 v[136:151], v[212:215], v[76:79], v[136:151]
    v_mfma_f32_32x32x16_bf16 v[152:167], v[244:247], v[76:79], v[152:167]
L_own_31:
L_noown_27:
L_otry:
    ds_read_b32 v15, v254 offset:20
    s_cmp_lg_u32 s85, 3
    s_cbranch_scc1 L_oone
    s_waitcnt vmcnt(8)
    v_max3_u32 v2, v16, v17, v18
    v_max3_u32 v14, v19, v20, v21
    v_max3_u32 v2, v2, v22, v23
    v_max3_u32 v14, v14, v24, v25
    v_max3_u32 v2, v2, v26, v27
    v_max3_u32 v14, v14, v28, v29
    v_max3_u32 v2, v2, v30, v31
    v_max3_u32 v14, v14, v32, v33
    v_max3_u32 v2, v2, v34, v35
    v_max3_u32 v14, v14, v36, v37
    v_max3_u32 v2, v2, v38, v39
    v_max3_u32 v14, v14, v40, v41
    v_max3_u32 v2, v2, v42, v43
    v_max3_u32 v14, v14, v44, v45
    v_max3_u32 v2, v2, v46, v47
    v_max_u32 v2, v2, v14
    v_cmp_eq_u32 vcc, -1, v2
    s_cmp_eq_u32 s68, 0
    s_cbranch_scc1 L_og_33
    s_cbranch_vccnz L_og_32
L_og_33:
    v_mfma_f32_32x32x16_bf16 v[104:119], v[184:187], v[16:19], v[104:119]
    v_mfma_f32_32x32x16_bf16 v[120:135], v[216:219], v[16:19], v[120:135]
    v_mfma_f32_32x32x16_bf16 v[104:119], v[188:191], v[20:23], v[104:119]
    v_mfma_f32_32x32x16_bf16 v[120:135], v[220:223], v[20:23], v[120:135]
    v_mfma_f32_32x32x16_bf16 v[104:119], v[192:195], v[24:27], v[104:119]
    v_mfma_f32_32x32x16_bf16 v[120:135], v[224:227], v[24:27], v[120:135]
    v_mfma_f32_32x32x16_bf16 v[104:119], v[196:199], v[28:31], v[104:119]
    v_mfma_f32_32x32x16_bf16 v[120:135], v[228:231], v[28:31], v[120:135]
    v_mfma_f32_32x32x16_bf16 v[136:151], v[184:187], v[32:35], v[136:151]
    v_mfma_f32_32x32x16_bf16 v[152:167], v[216:219], v[32:35], v[152:167]
    v_mfma_f32_32x32x16_bf16 v[136:151], v[188:191], v[36:39], v[136:151]
    v_mfma_f32_32x32x16_bf16 v[152:167], v[220:223], v[36:39], v[152:167]
    v_mfma_f32_32x32x16_bf16 v[136:151], v[192:195], v[40:43], v[136:151]
    v_mfma_f32_32x32x16_bf16 v[152:167], v[224:227], v[40:43], v[152:167]
    v_mfma_f32_32x32x16_bf16 v[136:151], v[196:199], v[44:47], v[136:151]
    v_mfma_f32_32x32x16_bf16 v[152:167], v[228:231], v[44:47], v[152:167]
    s_bitset0_b32 s84, 0
L_og_32:
    s_waitcnt vmcnt(0)
    v_max3_u32 v2, v48, v49, v50
    v_max3_u32 v14, v51, v52, v53
    v_max3_u32 v2, v2, v54, v55
    v_max3_u32 v14, v14, v56, v57
    v_max3_u32 v2, v2, v58, v59
    v_max3_u32 v14, v14, v60, v61
    v_max3_u32 v2, v2, v62, v63
    v_max3_u32 v14, v14, v64, v65
    v_max3_u32 v2, v2, v66, v67
    v_max3_u32 v14, v14, v68, v69
    v_max3_u32 v2, v2, v70, v71
    v_max3_u32 v14, v14, v72, v73
    v_max3_u32 v2, v2, v74, v75
    v_max3_u32 v14, v14, v76, v77
    v_max3_u32 v2, v2, v78, v79
    v_max_u32 v2, v2, v14
    v_cmp_eq_u32 vcc, -1, v2
    s_cmp_eq_u32 s68, 0
    s_cbranch_scc1 L_og_35
    s_cbranch_vccnz L_og_34
L_og_35:
    v_mfma_f32_32x32x16_bf16 v[104:119], v[200:203], v[48:51], v[104:119]
    v_mfma_f32_32x32x16_bf16 v[120:135], v[232:235], v[48:51], v[120:135]
    v_mfma_f32_32x32x16_bf16 v[104:119], v[204:207], v[52:55], v[104:119]
    v_mfma_f32_32x32x16_bf16 v[120:135], v[236:239], v[52:55], v[120:135]
    v_mfma_f32_32x32x16_bf16 v[104:119], v[208:211], v[56:59], v[104:119]
    v_mfma_f32_32x32x16_bf16 v[120:135], v[240:243], v[56:59], v[120:135]
    v_mfma_f32_32x32x16_bf16 v[104:119], v[212:215], v[60:63], v[104:119]
    v_mfma_f32_32x32x16_bf16 v[120:135], v[244:247], v[60:63], v[120:135]
    v_mfma_f32_32x32x16_bf16 v[136:151], v[200:203], v[64:67], v[136:151]
    v_mfma_f32_32x32x16_bf16 v[152:167], v[232:235], v[64:67], v[152:167]
    v_mfma_f32_32x32x16_bf16 v[136:151], v[204:207], v[68:71], v[136:151]
    v_mfma_f32_32x32x16_bf16 v[152:167], v[236:239], v[68:71], v[152:167]
    v_mfma_f32_32x32x16_bf16 v[136:151], v[208:211], v[72:75], v[136:151]
    v_mfma_f32_32x32x16_bf16 v[152:167], v[240:243], v[72:75], v[152:167]
    v_mfma_f32_32x32x16_bf16 v[136:151], v[212:215], v[76:79], v[136:151]
    v_mfma_f32_32x32x16_bf16 v[152:167], v[244:247], v[76:79], v[152:167]
    s_bitset0_b32 s84, 1
L_og_34:
    s_mov_b32 s85, 0
    s_branch L_onext
L_oone:
    s_andn2_b32 s74, s84, s85
    s_cbranch_scc0 L_nopoll_36
    s_mov_b64 exec, 3
    buffer_load_dword v248, v249, s[24:27], 0 offen sc1
    s_mov_b64 exec, -1
    s_max_u32 s68, s68, 1
    s_sub_u32 s68, s68, 1
L_nopoll_36:
    s_waitcnt vmcnt(0)
    s_mov_b64 exec, 3
    v_cmp_ne_u32 vcc, 0, v248
    s_mov_b64 exec, -1
    s_cmp_eq_u32 s68, 0
    s_cselect_b32 s88, 3, vcc_lo
    s_and_b32 s88, s88, s84
    s_andn2_b32 s88, s88, s85
    s_bitcmp1_b32 s88, 0
    s_cbranch_scc0 L_nol_37
    s_add_u32 s74, s61, 0
    buffer_load_dwordx4 v[16:19], v0, s[24:27], s74 offen offset:0 sc1
    buffer_load_dwordx4 v[20:23], v0, s[24:27], s74 offen offset:1024 sc1
    buffer_load_dwordx4 v[24:27], v0, s[24:27], s74 offen offset:2048 sc1
    buffer_load_dwordx4 v[28:31], v0, s[24:27], s74 offen offset:3072 sc1
    s_add_u32 s74, s61, 32768
    buffer_load_dwordx4 v[32:35], v0, s[24:27], s74 offen offset:0 sc1
    buffer_load_dwordx4 v[36:39], v0, s[24:27], s74 offen offset:1024 sc1
    buffer_load_dwordx4 v[40:43], v0, s[24:27], s74 offen offset:2048 sc1
    buffer_load_dwordx4 v[44:47], v0, s[24:27], s74 offen offset:3072 sc1
L_nol_37:
    s_bitcmp1_b32 s88, 1
    s_cbranch_scc0 L_nol_38
    s_add_u32 s74, s61, 4096
    buffer_load_dwordx4 v[48:51], v0, s[24:27], s74 offen offset:0 sc1
    buffer_load_dwordx4 v[52:55], v0, s[24:27], s74 offen offset:1024 sc1
    buffer_load_dwordx4 v[56:59], v0, s[24:27], s74 offen offset:2048 sc1
    buffer_load_dwordx4 v[60:63], v0, s[24:27], s74 offen offset:3072 sc1
    s_add_u32 s74, s61, 36864
    buffer_load_dwordx4 v[64:67], v0, s[24:27], s74 offen offset:0 sc1
    buffer_load_dwordx4 v[68:71], v0, s[24:27], s74 offen offset:1024 sc1
    buffer_load_dwordx4 v[72:75], v0, s[24:27], s74 offen offset:2048 sc1
    buffer_load_dwordx4 v[76:79], v0, s[24:27], s74 offen offset:3072 sc1
L_nol_38:
    s_bitcmp1_b32 s85, 0
    s_cbranch_scc0 L_nouse_39
    v_max3_u32 v2, v16, v17, v18
    v_max3_u32 v14, v19, v20, v21
    v_max3_u32 v2, v2, v22, v23
    v_max3_u32 v14, v14, v24, v25
    v_max3_u32 v2, v2, v26, v27
    v_max3_u32 v14, v14, v28, v29
    v_max3_u32 v2, v2, v30, v31
    v_max3_u32 v14, v14, v32, v33
    v_max3_u32 v2, v2, v34, v35
    v_max3_u32 v14, v14, v36, v37
    v_max3_u32 v2, v2, v38, v39
    v_max3_u32 v14, v14, v40, v41
    v_max3_u32 v2, v2, v42, v43
    v_max3_u32 v14, v14, v44, v45
    v_max3_u32 v2, v2, v46, v47
    v_max_u32 v2, v2, v14
    v_cmp_eq_u32 vcc, -1, v2
    s_cmp_eq_u32 s68, 0
    s_cbranch_scc1 L_og_41
    s_cbranch_vccnz L_og_40
L_og_41:
    v_mfma_f32_32x32x16_bf16 v[104:119], v[184:187], v[16:19], v[104:119]
    v_mfma_f32_32x32x16_bf16 v[120:135], v[216:219], v[16:19], v[120:135]
    v_mfma_f32_32x32x16_bf16 v[104:119], v[188:191], v[20:23], v[104:119]
    v_mfma_f32_32x32x16_bf16 v[120:135], v[220:223], v[20:23], v[120:135]
    v_mfma_f32_32x32x16_bf16 v[104:119], v[192:195], v[24:27], v[104:119]
    v_mfma_f32_32x32x16_bf16 v[120:135], v[224:227], v[24:27], v[120:135]
    v_mfma_f32_32x32x16_bf16 v[104:119], v[196:199], v[28:31], v[104:119]
    v_mfma_f32_32x32x16_bf16 v[120:135], v[228:231], v[28:31], v[120:135]
    v_mfma_f32_32x32x16_bf16 v[136:151], v[184:187], v[32:35], v[136:151]
    v_mfma_f32_32x32x16_bf16 v[152:167], v[216:219], v[32:35], v[152:167]
    v_mfma_f32_32x32x16_bf16 v[136:151], v[188:191], v[36:39], v[136:151]
    v_mfma_f32_32x32x16_bf16 v[152:167], v[220:223], v[36:39], v[152:167]
    v_mfma_f32_32x32x16_bf16 v[136:151], v[192:195], v[40:43], v[136:151]
    v_mfma_f32_32x32x16_bf16 v[152:167], v[224:227], v[40:43], v[152:167]
    v_mfma_f32_32x32x16_bf16 v[136:151], v[196:199], v[44:47], v[136:151]
    v_mfma_f32_32x32x16_bf16 v[152:167], v[228:231], v[44:47], v[152:167]
    s_bitset0_b32 s84, 0
L_og_40:
L_nouse_39:
    s_bitcmp1_b32 s85, 1
    s_cbranch_scc0 L_nouse_42
    v_max3_u32 v2, v48, v49, v50
    v_max3_u32 v14, v51, v52, v53
    v_max3_u32 v2, v2, v54, v55
    v_max3_u32 v14, v14, v56, v57
    v_max3_u32 v2, v2, v58, v59
    v_max3_u32 v14, v14, v60, v61
    v_max3_u32 v2, v2, v62, v63
    v_max3_u32 v14, v14, v64, v65
    v_max3_u32 v2, v2, v66, v67
    v_max3_u32 v14, v14, v68, v69
    v_max3_u32 v2, v2, v70, v71
    v_max3_u32 v14, v14, v72, v73
    v_max3_u32 v2, v2, v74, v75
    v_max3_u32 v14, v14, v76, v77
    v_max3_u32 v2, v2, v78, v79
    v_max_u32 v2, v2, v14
    v_cmp_eq_u32 vcc, -1, v2
    s_cmp_eq_u32 s68, 0
    s_cbranch_scc1 L_og_44
    s_cbranch_vccnz L_og_43
L_og_44:
    v_mfma_f32_32x32x16_bf16 v[104:119], v[200:203], v[48:51], v[104:119]
    v_mfma_f32_32x32x16_bf16 v[120:135], v[232:235], v[48:51], v[120:135]
    v_mfma_f32_32x32x16_bf16 v[104:119], v[204:207], v[52:55], v[104:119]
    v_mfma_f32_32x32x16_bf16 v[120:135], v[236:239], v[52:55], v[120:135]
    v_mfma_f32_32x32x16_bf16 v[104:119], v[208:211], v[56:59], v[104:119]
    v_mfma_f32_32x32x16_bf16 v[120:135], v[240:243], v[56:59], v[120:135]
    v_mfma_f32_32x32x16_bf16 v[104:119], v[212:215], v[60:63], v[104:119]
    v_mfma_f32_32x32x16_bf16 v[120:135], v[244:247], v[60:63], v[120:135]
    v_mfma_f32_32x32x16_bf16 v[136:151], v[200:203], v[64:67], v[136:151]
    v_mfma_f32_32x32x16_bf16 v[152:167], v[232:235], v[64:67], v[152:167]
    v_mfma_f32_32x32x16_bf16 v[136:151], v[204:207], v[68:71], v[136:151]
    v_mfma_f32_32x32x16_bf16 v[152:167], v[236:239], v[68:71], v[152:167]
    v_mfma_f32_32x32x16_bf16 v[136:151], v[208:211], v[72:75], v[136:151]
    v_mfma_f32_32x32x16_bf16 v[152:167], v[240:243], v[72:75], v[152:167]
    v_mfma_f32_32x32x16_bf16 v[136:151], v[212:215], v[76:79], v[136:151]
    v_mfma_f32_32x32x16_bf16 v[152:167], v[244:247], v[76:79], v[152:167]
    s_bitset0_b32 s84, 1
L_og_43:
L_nouse_42:
    s_mov_b32 s85, s88
L_onext:
    s_cmp_lg_u32 s84, 0
    s_cbranch_scc1 L_otry
    s_waitcnt lgkmcnt(0)
    v_cmp_gt_u32 vcc, 4, v15
    s_nop 0
    s_cbranch_vccz L_seen_45
    s_mov_b64 exec, 1
    s_mov_b32 s78, 33554432
L_cw_46:
    ds_read_b32 v15, v254 offset:20
    s_sub_u32 s78, s78, 1
    s_cbranch_scc1 L_cwd_47
    s_waitcnt lgkmcnt(0)
    v_cmp_gt_u32 vcc, 4, v15
    s_nop 0
    s_cbranch_vccnz L_cw_46
L_cwd_47:
    s_mov_b64 exec, -1
L_seen_45:
    v_xor_b32 v169, 16, v10
    v_xor_b32 v170, 64, v10
    v_xor_b32 v171, 80, v10
    ds_write_b128 v10, v[104:107] offset:0
    ds_write_b128 v10, v[108:111] offset:8192
    ds_write_b128 v169, v[112:115] offset:0
    ds_write_b128 v169, v[116:119] offset:8192
    ds_write_b128 v170, v[120:123] offset:0
    ds_write_b128 v170, v[124:127] offset:8192
    ds_write_b128 v171, v[128:131] offset:0
    ds_write_b128 v171, v[132:135] offset:8192
    ds_write_b128 v10, v[136:139] offset:4096
    ds_write_b128 v10, v[140:143] offset:12288
    ds_write_b128 v169, v[144:147] offset:4096
    ds_write_b128 v169, v[148:151] offset:12288
    ds_write_b128 v170, v[152:155] offset:4096
    ds_write_b128 v170, v[156:159] offset:12288
    ds_write_b128 v171, v[160:163] offset:4096
    ds_write_b128 v171, v[164:167] offset:12288
L_fin8:
    v_lshrrev_b32 v14, 3, v1
    v_and_b32 v15, 7, v1
    v_lshlrev_b32 v7, 11, v14
    v_lshl_add_u32 v7, v15, 4, v7
    v_xor_b32 v15, v15, v14
    v_lshlrev_b32 v15, 4, v15
    v_lshl_add_u32 v15, v14, 7, v15
    s_lshl_b32 s74, s3, 10
    v_add_u32 v2, s74, v15
    s_lshl_b32 s74, s5, 3
    s_add_u32 s74, s74, s3
    s_lshl_b32 s74, s74, 14
    s_lshl_b32 s75, s6, 7
    s_add_u32 s74, s74, s75
    s_waitcnt lgkmcnt(0)
    s_barrier
    ds_read_b128 v[64:67], v2 offset:0
    ds_read_b128 v[68:71], v2 offset:8192
    ds_read_b128 v[72:75], v2 offset:16384
    ds_read_b128 v[76:79], v2 offset:24576
    ds_read_b128 v[80:83], v2 offset:32768
    ds_read_b128 v[84:87], v2 offset:40960
    ds_read_b128 v[88:91], v2 offset:49152
    ds_read_b128 v[92:95], v2 offset:57344
    s_waitcnt lgkmcnt(4)
    v_pk_add_f32 v[64:65], v[64:65], v[72:73]
    v_pk_add_f32 v[66:67], v[66:67], v[74:75]
    v_pk_add_f32 v[68:69], v[68:69], v[76:77]
    v_pk_add_f32 v[70:71], v[70:71], v[78:79]
    s_waitcnt lgkmcnt(2)
    v_pk_add_f32 v[64:65], v[64:65], v[80:81]
    v_pk_add_f32 v[66:67], v[66:67], v[82:83]
    v_pk_add_f32 v[68:69], v[68:69], v[84:85]
    v_pk_add_f32 v[70:71], v[70:71], v[86:87]
    s_waitcnt lgkmcnt(0)
    v_pk_add_f32 v[64:65], v[64:65], v[88:89]
    v_pk_add_f32 v[66:67], v[66:67], v[90:91]
    v_pk_add_f32 v[68:69], v[68:69], v[92:93]
    v_pk_add_f32 v[70:71], v[70:71], v[94:95]
    v_cvt_pk_bf16_f32 v96, v64, v65
    v_cvt_pk_bf16_f32 v97, v66, v67
    v_cvt_pk_bf16_f32 v98, v68, v69
    v_cvt_pk_bf16_f32 v99, v70, v71
    buffer_store_dwordx4 v[96:99], v7, s[28:31], s74 offen offset:1024 sc1
L_fin:
    s_endpgm
L_slow:
    s_waitcnt vmcnt(0) lgkmcnt(0)
    s_mov_b32 s73, 1
    s_mov_b32 s69, s79
    s_mov_b32 s68, s83
    v_mov_b32 v72, 0xff800000
    v_mov_b32 v73, 0xff800000
L_slow_loop:
    buffer_load_dwordx4 v[136:139], v8, s[24:27], s69 offen sc1
    s_add_u32 s69, s69, 2048
    s_and_b32 s69, s69, 0x1ffff
    s_waitcnt vmcnt(0)
    v_mfma_f32_32x32x16_bf16 v[104:119], v[136:139], v[16:19], 0
    v_mfma_f32_32x32x16_bf16 v[120:135], v[136:139], v[20:23], 0
    s_nop 10
    v_max3_f32 v72, v72, v104, v105
    v_max3_f32 v72, v72, v106, v107
    v_max3_f32 v72, v72, v108, v109
    v_max3_f32 v72, v72, v110, v111
    v_max3_f32 v72, v72, v112, v113
    v_max3_f32 v72, v72, v114, v115
    v_max3_f32 v72, v72, v116, v117
    v_max3_f32 v72, v72, v118, v119
    v_max3_f32 v73, v73, v120, v121
    v_max3_f32 v73, v73, v122, v123
    v_max3_f32 v73, v73, v124, v125
    v_max3_f32 v73, v73, v126, v127
    v_max3_f32 v73, v73, v128, v129
    v_max3_f32 v73, v73, v130, v131
    v_max3_f32 v73, v73, v132, v133
    v_max3_f32 v73, v73, v134, v135
    s_sub_u32 s68, s68, 1
    s_cmp_lg_u32 s68, 0
    s_cbranch_scc1 L_slow_loop
    v_permlane32_swap_b32 v72, v73
    v_max_f32 v72, v72, v73
    s_lshl_b32 s74, s3, 8
    s_add_u32 s74, s74, 159744
    v_lshl_add_u32 v2, v1, 2, s74
    ds_write_b32 v2, v72
    v_xor_b32 v2, 0x400, v2
    s_waitcnt lgkmcnt(0)
    s_barrier
    ds_read_b32 v73, v2
    s_waitcnt lgkmcnt(0)
    v_max_f32 v72, v72, v73
    v_sub_f32 v72, 0, v72
    v_mov_b32 v73, v72
    s_nop 1
    v_permlane32_swap_b32 v72, v73
    v_pk_mov_b32 v[40:41], v[72:73], v[72:73] op_sel:[0,0]
    v_pk_mov_b32 v[56:57], v[72:73], v[72:73] op_sel:[1,1]
    v_pk_mov_b32 v[42:43], v[72:73], v[72:73] op_sel:[0,0]
    v_pk_mov_b32 v[58:59], v[72:73], v[72:73] op_sel:[1,1]
    v_pk_mov_b32 v[44:45], v[72:73], v[72:73] op_sel:[0,0]
    v_pk_mov_b32 v[60:61], v[72:73], v[72:73] op_sel:[1,1]
    v_pk_mov_b32 v[46:47], v[72:73], v[72:73] op_sel:[0,0]
    v_pk_mov_b32 v[62:63], v[72:73], v[72:73] op_sel:[1,1]
    v_pk_mov_b32 v[48:49], v[72:73], v[72:73] op_sel:[0,0]
    v_pk_mov_b32 v[64:65], v[72:73], v[72:73] op_sel:[1,1]
    v_pk_mov_b32 v[50:51], v[72:73], v[72:73] op_sel:[0,0]
    v_pk_mov_b32 v[66:67], v[72:73], v[72:73] op_sel:[1,1]
    v_pk_mov_b32 v[52:53], v[72:73], v[72:73] op_sel:[0,0]
    v_pk_mov_b32 v[68:69], v[72:73], v[72:73] op_sel:[1,1]
    v_pk_mov_b32 v[54:55], v[72:73], v[72:73] op_sel:[0,0]
    v_pk_mov_b32 v[70:71], v[72:73], v[72:73] op_sel:[1,1]
    s_mov_b32 s69, s79
    v_and_b32 v2, 27, v1
    v_cmp_eq_u32 vcc, 16, v2
    v_mov_b32 v2, 0x3f803f80
    s_nop 0
    v_cndmask_b32 v2, 0, v2, vcc
    v_mov_b32 v140, v2
    v_mov_b32 v141, v2
    v_mov_b32 v142, v2
    v_mov_b32 v143, v2
    v_mov_b32 v144, v2
    v_mov_b32 v145, v2
    v_mov_b32 v146, v2
    v_mov_b32 v147, v2
    v_mov_b32 v152, v2
    v_mov_b32 v153, v2
    v_mov_b32 v154, v2
    v_mov_b32 v155, v2
    v_mov_b32 v156, v2
    v_mov_b32 v157, v2
    v_mov_b32 v158, v2
    v_mov_b32 v159, v2
    buffer_load_dwordx4 v[136:139], v8, s[24:27], s69 offen offset:0 sc1
    s_mov_b64 exec, s[66:67]
    buffer_load_dwordx4 v[140:143], v250, s[24:27], s69 offen offset:1024 sc1
    buffer_load_dwordx4 v[144:147], v250, s[24:27], s69 offen offset:1536 sc1
    s_mov_b64 exec, -1
    s_add_u32 s69, s69, 2048
    s_and_b32 s69, s69, 0x1ffff
    v_mov_b32 v72, 0
    v_mov_b32 v73, 0
    v_mov_b32 v74, 0
    v_mov_b32 v75, 0
    v_mov_b32 v76, 0
    v_mov_b32 v77, 0
    v_mov_b32 v78, 0
    v_mov_b32 v79, 0
    v_mov_b32 v80, 0
    v_mov_b32 v81, 0
    v_mov_b32 v82, 0
    v_mov_b32 v83, 0
    v_mov_b32 v84, 0
    v_mov_b32 v85, 0
    v_mov_b32 v86, 0
    v_mov_b32 v87, 0
    v_mov_b32 v88, 0
    v_mov_b32 v89, 0
    v_mov_b32 v90, 0
    v_mov_b32 v91, 0
    v_mov_b32 v92, 0
    v_mov_b32 v93, 0
    v_mov_b32 v94, 0
    v_mov_b32 v95, 0
    v_mov_b32 v96, 0
    v_mov_b32 v97, 0
    v_mov_b32 v98, 0
    v_mov_b32 v99, 0
    v_mov_b32 v100, 0
    v_mov_b32 v101, 0
    v_mov_b32 v102, 0
    v_mov_b32 v103, 0
    v_mov_b32 v128, 0
    v_mov_b32 v129, 0
    v_mov_b32 v130, 0
    v_mov_b32 v131, 0
    v_mov_b32 v132, 0
    v_mov_b32 v133, 0
    v_mov_b32 v134, 0
    v_mov_b32 v135, 0
    s_waitcnt vmcnt(0)
    v_mfma_f32_32x32x16_bf16 v[104:119], v[136:139], v[16:19], v[40:55]
    s_lshr_b32 s68, s83, 1
    s_nop 7
    s_nop 3
L_redo_loop:
    v_exp_f32 v104, v104
    v_exp_f32 v105, v105
    v_smfmac_f32_32x32x32_bf16 v[88:103], v[156:159], v[128:135], v251
    v_exp_f32 v106, v106
    buffer_load_dwordx4 v[148:151], v8, s[24:27], s69 offen offset:0 sc1
    s_mov_b64 exec, s[66:67]
    buffer_load_dwordx4 v[152:155], v250, s[24:27], s69 offen offset:1024 sc1
    buffer_load_dwordx4 v[156:159], v250, s[24:27], s69 offen offset:1536 sc1
    s_mov_b64 exec, -1
    s_add_u32 s69, s69, 2048
    s_and_b32 s69, s69, 0x1ffff
    v_exp_f32 v107, v107
    v_exp_f32 v108, v108
    v_mfma_f32_32x32x16_bf16 v[120:135], v[136:139], v[20:23], v[56:71]
    v_exp_f32 v109, v109
    v_exp_f32 v110, v110
    v_exp_f32 v111, v111
    v_exp_f32 v112, v112
    v_exp_f32 v113, v113
    v_smfmac_f32_32x32x32_bf16 v[72:87], v[140:143], v[104:111], v251
    v_exp_f32 v114, v114
    v_exp_f32 v115, v115
    v_exp_f32 v116, v116
    v_exp_f32 v117, v117
    v_exp_f32 v118, v118
    v_exp_f32 v119, v119
    v_exp_f32 v120, v120
    v_exp_f32 v121, v121
    v_smfmac_f32_32x32x32_bf16 v[72:87], v[144:147], v[112:119], v251
    v_exp_f32 v122, v122
    v_exp_f32 v123, v123
    s_waitcnt vmcnt(0)
    v_exp_f32 v124, v124
    v_mfma_f32_32x32x16_bf16 v[104:119], v[148:151], v[16:19], v[40:55]
    v_exp_f32 v125, v125
    v_exp_f32 v126, v126
    v_exp_f32 v127, v127
    v_exp_f32 v128, v128
    v_exp_f32 v129, v129
    v_smfmac_f32_32x32x32_bf16 v[88:103], v[140:143], v[120:127], v251
    v_exp_f32 v130, v130
    v_exp_f32 v131, v131
    v_exp_f32 v132, v132
    v_exp_f32 v133, v133
    v_exp_f32 v134, v134
    v_exp_f32 v135, v135
    v_exp_f32 v104, v104
    v_exp_f32 v105, v105
    v_smfmac_f32_32x32x32_bf16 v[88:103], v[144:147], v[128:135], v251
    v_exp_f32 v106, v106
    buffer_load_dwordx4 v[136:139], v8, s[24:27], s69 offen offset:0 sc1
    s_mov_b64 exec, s[66:67]
    buffer_load_dwordx4 v[140:143], v250, s[24:27], s69 offen offset:1024 sc1
    buffer_load_dwordx4 v[144:147], v250, s[24:27], s69 offen offset:1536 sc1
    s_mov_b64 exec, -1
    s_add_u32 s69, s69, 2048
    s_and_b32 s69, s69, 0x1ffff
    v_exp_f32 v107, v107
    v_exp_f32 v108, v108
    v_mfma_f32_32x32x16_bf16 v[120:135], v[148:151], v[20:23], v[56:71]
    v_exp_f32 v109, v109
    v_exp_f32 v110, v110
    v_exp_f32 v111, v111
    v_exp_f32 v112, v112
    v_exp_f32 v113, v113
    v_smfmac_f32_32x32x32_bf16 v[72:87], v[152:155], v[104:111], v251
    v_exp_f32 v114, v114
    v_exp_f32 v115, v115
    v_exp_f32 v116, v116
    v_exp_f32 v117, v117
    v_exp_f32 v118, v118
    v_exp_f32 v119, v119
    v_exp_f32 v120, v120
    v_exp_f32 v121, v121
    v_smfmac_f32_32x32x32_bf16 v[72:87], v[156:159], v[112:119], v251
    v_exp_f32 v122, v122
    v_exp_f32 v123, v123
    s_waitcnt vmcnt(0)
    v_exp_f32 v124, v124
    v_mfma_f32_32x32x16_bf16 v[104:119], v[136:139], v[16:19], v[40:55]
    v_exp_f32 v125, v125
    v_exp_f32 v126, v126
    v_exp_f32 v127, v127
    v_exp_f32 v128, v128
    v_exp_f32 v129, v129
    v_smfmac_f32_32x32x32_bf16 v[88:103], v[152:155], v[120:127], v251
    v_exp_f32 v130, v130
    v_exp_f32 v131, v131
    v_exp_f32 v132, v132
    v_exp_f32 v133, v133
    v_exp_f32 v134, v134
    v_exp_f32 v135, v135
    s_sub_u32 s68, s68, 1
    s_cmp_lg_u32 s68, 0
    s_cbranch_scc1 L_redo_loop
    v_smfmac_f32_32x32x32_bf16 v[88:103], v[156:159], v[128:135], v251
    s_waitcnt vmcnt(0)
    s_branch L_tail
L_end:
    s_endpgm
.section .rodata,"a"
.p2align 6
.amdhsa_kernel concat_heads__linear_kernel_hedgehog__softmax_full_mha__prompt_kernel
  .amdhsa_next_free_vgpr 256
  .amdhsa_next_free_sgpr 102
  .amdhsa_accum_offset 256
  .amdhsa_group_segment_fixed_size 0
  .amdhsa_kernarg_size 80
  .amdhsa_user_sgpr_count 2
  .amdhsa_user_sgpr_kernarg_segment_ptr 1
  .amdhsa_system_sgpr_workgroup_id_x 1
.end_amdhsa_kernel
```
